```python
import torch

def _softmax(x, axis=-1):
    return torch.softmax(x, dim=axis)
def _gelu(x):
    return torch.nn.functional.gelu(x, approximate="tanh")
def _silu(x):
    return torch.nn.functional.silu(x)
def _sigmoid(x):
    return torch.sigmoid(x)
def _layernorm(x, axis=-1, eps=1e-5):
    m = x.mean(dim=axis, keepdim=True)
    v = x.var(dim=axis, keepdim=True, unbiased=False)
    return (x - m) / torch.sqrt(v + eps)
def _scatter_add(tgt, idx, src, axis=0):
    return tgt.clone().index_add_(axis, idx, src)
def _segment_sum(src, seg, n):
    out = torch.zeros((n,) + src.shape[1:], dtype=src.dtype)
    return out.index_add_(0, seg, src)
def _pad(x, pw):
    flat = tuple(v for pair in reversed(pw) for v in pair)
    return torch.nn.functional.pad(x, flat)

kernel_name = 'interleave_layers__spectral_gfnet__glu_gated_reglu__prompt'

def setup_inputs():

    _w = (lambda a: (lambda t: t.to(torch.bfloat16) if t.is_floating_point() else t)(torch.as_tensor(a)))
    def _A_setup():
        B, S, D = 1, 2048, 512
        Df = D // 2 + 1
        return {
            "x": _w((lambda *s: torch.randn(*s, dtype=torch.bfloat16) * 0.05)(B, S, D)),
            "w_r": _w((lambda *s: torch.randn(*s, dtype=torch.bfloat16) * 0.4)(S, Df) * 0.02),
            "w_i": _w((lambda *s: torch.randn(*s, dtype=torch.bfloat16) * 0.4)(S, Df) * 0.02),
        }
    _A_in = _A_setup()

    def _B_setup():
        B, S, D, F = 1, 2048, 512, 1376
        return {
            "x": _w((lambda *s: torch.randn(*s, dtype=torch.bfloat16) * 0.05)(B, S, D)),
            "W_gate": _w((lambda *s: torch.randn(*s, dtype=torch.bfloat16) * 0.2)(D, F) * (2.0 / D) ** 0.5),
            "W_up": _w((lambda *s: torch.randn(*s, dtype=torch.bfloat16) * 0.2)(D, F) * (2.0 / D) ** 0.5),
            "W_down": _w((lambda *s: torch.randn(*s, dtype=torch.bfloat16) * 0.2)(F, D) * (1.0 / F) ** 0.5),
        }
    _B_in = _B_setup()

    return {
        "A_x": _A_in["x"],
        "A_w_r": _A_in["w_r"],
        "A_w_i": _A_in["w_i"],
        "B_x": _B_in["x"],
        "B_W_gate": _B_in["W_gate"],
        "B_W_up": _B_in["W_up"],
        "B_W_down": _B_in["W_down"],
    }

def reference(A_x, A_w_r, A_w_i, B_x, B_W_gate, B_W_up, B_W_down):
    def _A_ref(x, w_r, w_i):
        B, S, D = x.shape
        X = (lambda x, axes=(-2,-1): torch.fft.rfft2(x.float(), dim=axes))(x, axes=(-2, -1))
        W = w_r + 1j * w_i
        X = X * W
        y = (lambda x, s, axes=(-2,-1): torch.fft.irfft2(x, s=s, dim=axes).to(torch.bfloat16))(X, (S, D), axes=(-2, -1))
        return y

    def _B_ref(x, W_gate, W_up, W_down):
        gate = torch.einsum("bsd,df->bsf", x, W_gate)
        up = torch.einsum("bsd,df->bsf", x, W_up)
        gate = gate * (lambda x, dt: x.to(dt))(gate > 0, gate.dtype)
        h = gate * up
        return torch.einsum("bsf,fd->bsd", h, W_down)

    x = A_x
    x = x + _A_ref(_layernorm(x, axis=-1), A_w_r, A_w_i)
    x = x + _B_ref(_layernorm(x, axis=-1), B_W_gate, B_W_up, B_W_down)
    x = x + _A_ref(_layernorm(x, axis=-1), A_w_r, A_w_i)
    x = x + _B_ref(_layernorm(x, axis=-1), B_W_gate, B_W_up, B_W_down)
    return x
```

```asm
; @launch grid=(256,1,1) block=(256,1,1) lds=163840
.amdgcn_target "amdgcn-amd-amdhsa--gfx950"
.text
.p2align 12
.fill 832, 4, 0xbf810000
.globl interleave_layers__spectral_gfnet__glu_gated_reglu__prompt_kernel
.p2align 8
.type interleave_layers__spectral_gfnet__glu_gated_reglu__prompt_kernel,@function
interleave_layers__spectral_gfnet__glu_gated_reglu__prompt_kernel:
Lstart:
  s_load_dwordx16 s[32:47], s[0:1], 0
  s_load_dwordx4 s[48:51], s[0:1], 64
  s_cmp_lt_u32 s2, 256
  s_cbranch_scc1 Lgo
  s_endpgm
Lgo:
  v_lshrrev_b32 v1, 6, v0
  v_and_b32 v0, 63, v0
  s_getpc_b64 s[16:17]
  s_add_u32 s16, s16, Lstart@rel32@lo+4
  s_addc_u32 s17, s17, Lstart@rel32@hi+12
  s_mov_b32 s18, Lcode_end-Lstart
  s_mov_b32 s19, 0x20000
  v_readfirstlane_b32 s3, v1
  v_lshlrev_b32 v1, 4, v0
  s_lshr_b32 s5, s2, 3
  s_lshl_b32 s5, s5, 2
  s_add_u32 s5, s5, s3
  s_lshl_b32 s5, s5, 10
  buffer_load_dwordx4 v[172:175], v1, s[16:19], s5 offen
  s_getpc_b64 s[12:13]
  s_add_u32 s12, s12, tbl@rel32@lo+4
  s_addc_u32 s13, s13, tbl@rel32@hi+12
  s_mov_b32 s14, 565248
  s_mov_b32 s15, 0x20000
  s_movk_i32 s4, 4096
  buffer_load_dwordx4 v[112:115], v1, s[12:15], 0 offen offset:0
  buffer_load_dwordx4 v[116:119], v1, s[12:15], 0 offen offset:1024
  buffer_load_dwordx4 v[120:123], v1, s[12:15], 0 offen offset:2048
  buffer_load_dwordx4 v[124:127], v1, s[12:15], 0 offen offset:3072
  buffer_load_dwordx4 v[128:131], v1, s[12:15], s4 offen offset:0
  buffer_load_dwordx4 v[132:135], v1, s[12:15], s4 offen offset:1024
  buffer_load_dwordx4 v[136:139], v1, s[12:15], s4 offen offset:2048
  buffer_load_dwordx4 v[140:143], v1, s[12:15], s4 offen offset:3072
  s_lshl_b32 s28, s3, 13
  v_and_b32 v2, 15, v0
  v_lshrrev_b32 v3, 4, v0
  s_cmp_lt_u32 s2, 128
  s_cbranch_scc1 P1_X
  v_mov_b32 v7, 0
  v_mov_b32 v8, 0
  v_mov_b32 v15, 0
  s_mov_b32 s90, s28
  v_mov_b32 v4, v1
  s_lshl_b32 s1, s3, 8
  s_add_u32 s1, s1, s2
  s_sub_u32 s1, s1, 216
  s_cmp_ge_u32 s2, 216
  s_cbranch_scc1 P1_D
  s_sub_u32 s4, s2, 128
  s_and_b32 s5, s4, 7
  s_mul_i32 s5, s5, 11
  s_lshr_b32 s4, s4, 3
  s_add_u32 s4, s4, s5
  s_sub_u32 s31, s4, 46
  s_cmp_ge_u32 s4, 86
  s_cbranch_scc1 P1_D1
  s_cmp_ge_u32 s4, 43
  s_cselect_b32 s88, 1, 0
  s_cselect_b32 s5, 43, 0
  s_sub_u32 s4, s4, s5
  v_lshrrev_b32 v4, 2, v0
  v_mul_u32_u24 v4, 2752, v4
  v_and_b32 v8, 3, v0
  v_xor_b32 v8, v8, v3
  v_lshl_add_u32 v4, v8, 4, v4
  s_lshl_b32 s5, s4, 6
  s_mul_i32 s6, s3, 352256
  s_add_u32 s5, s5, s6
  s_mov_b32 s6, 44032
  s_lshl_b32 s89, s4, 2
  s_add_u32 s89, s89, s3
  s_mov_b32 s29, 2
  s_mov_b32 s18, 1409024
  s_bitcmp1_b32 s4, 0
  s_cselect_b32 s7, 176128, 0
  s_cselect_b32 s4, 4096, 0
  s_cselect_b32 s0, 4294659072, s6
  s_add_u32 s5, s5, s7
  s_add_u32 s90, s90, s4
  s_mov_b32 s7, s0
  s_lshl_b32 s30, s89, 1
  s_add_u32 s30, s30, s88
  s_cmp_eq_u32 s88, 1
  s_waitcnt lgkmcnt(0)
  s_cselect_b32 s16, s42, s40
  s_cselect_b32 s17, s43, s41
P1_LD:
  s_xor_b32 m0, s90, 0
  s_nop 0
  buffer_load_dwordx4 v4, s[16:19], s5 offen  lds
  s_xor_b32 m0, s90, 1024
  s_add_u32 s5, s5, s6
  buffer_load_dwordx4 v4, s[16:19], s5 offen  lds
  s_xor_b32 m0, s90, 2048
  s_add_u32 s5, s5, s6
  buffer_load_dwordx4 v4, s[16:19], s5 offen  lds
  s_xor_b32 m0, s90, 3072
  s_add_u32 s5, s5, s6
  buffer_load_dwordx4 v4, s[16:19], s5 offen  lds
  s_xor_b32 m0, s90, 4096
  s_add_u32 s5, s5, s7
  buffer_load_dwordx4 v4, s[16:19], s5 offen  lds
  s_xor_b32 m0, s90, 5120
  s_add_u32 s5, s5, s6
  buffer_load_dwordx4 v4, s[16:19], s5 offen  lds
  s_xor_b32 m0, s90, 6144
  s_add_u32 s5, s5, s6
  buffer_load_dwordx4 v4, s[16:19], s5 offen  lds
  s_xor_b32 m0, s90, 7168
  s_add_u32 s5, s5, s6
  buffer_load_dwordx4 v4, s[16:19], s5 offen  lds
  s_branch P1_GT
P1_D:
  s_sub_u32 s31, s2, 216
P1_D1:
  s_lshl_b32 s31, s31, 2
  s_add_u32 s31, s31, s3
  s_lshl_b32 s5, s31, 13
  s_movk_i32 s6, 1024
  s_mov_b32 s7, s6
  s_mov_b32 s29, 1
  s_mov_b32 s18, 1409024
  s_waitcnt lgkmcnt(0)
  s_mov_b64 s[16:17], s[44:45]
  s_mov_b32 s8, s50
  s_mov_b32 s9, s51
  s_mov_b32 s10, 46137344
  s_mov_b32 s11, 0x20000
  s_mov_b32 s24, s48
  s_mov_b32 s25, s49
  s_mov_b32 s26, 256
  s_mov_b32 s27, 0x20000
  s_cmp_ge_u32 s1, 9
  s_cbranch_scc1 P1_D2
  v_mul_u32_u24 v8, 4224, v0
  v_mov_b32 v5, 0
  v_mov_b32 v9, 1
  s_mul_i32 s4, s1, 270336
  s_add_u32 s4, s4, 36700160
  buffer_store_dword v5, v8, s[8:11], s4 offen sc1
  s_waitcnt vmcnt(0)
  s_mov_b64 exec, 1
  buffer_atomic_add v9, v5, s[24:27], 0 offen sc1
  s_mov_b64 exec, -1
P1_D2:
  s_cmp_lg_u32 s2, 255
  s_cbranch_scc1 P1_LD
  s_branch P1_DE
P1_X:
  s_lshr_b32 s5, s2, 6
  s_lshl_b32 s5, s5, 4
  s_bfe_u32 s6, s2, 0x40002
  s_lshl_b32 s6, s6, 7
  s_add_u32 s5, s5, s6
  s_and_b32 s6, s2, 3
  s_lshl_b32 s6, s6, 2
  s_add_u32 s5, s5, s6
  s_add_u32 s5, s5, s3
  s_lshl_b32 s5, s5, 10
  s_mov_b32 s18, 2097152
  s_mov_b32 m0, s28
  s_and_b32 s91, s2, 7
  s_bfe_u32 s92, s2, 0x10003
  s_lshr_b32 s93, s2, 4
  s_lshl_b32 s52, s91, 7
  s_lshl_b32 s6, s93, 2
  s_add_u32 s52, s52, s6
  s_add_u32 s52, s52, s3
  s_mul_i32 s52, s52, 1028
  s_lshl_b32 s6, s92, 8
  s_add_u32 s52, s52, s6
  v_lshlrev_b32 v5, 2, v0
  s_mov_b32 s22, 1052672
  s_mov_b32 s23, 0x20000
  s_mov_b32 s26, s22
  s_mov_b32 s27, 0x20000
  s_lshl_b32 s1, s3, 8
  s_add_u32 s1, s1, s2
  s_sub_u32 s1, s1, 256
  s_cmp_ge_u32 s1, 4
  s_waitcnt lgkmcnt(0)
  s_cbranch_scc0 P1_XE
P1_X2:
  s_mov_b64 s[16:17], s[32:33]
  buffer_load_dwordx4 v1, s[16:19], s5 offen  lds
  s_add_u32 m0, m0, 1024
  s_add_u32 s5, s5, 32768
  buffer_load_dwordx4 v1, s[16:19], s5 offen  lds
  s_add_u32 m0, m0, 1024
  s_add_u32 s5, s5, 32768
  buffer_load_dwordx4 v1, s[16:19], s5 offen  lds
  s_add_u32 m0, m0, 1024
  s_add_u32 s5, s5, 32768
  buffer_load_dwordx4 v1, s[16:19], s5 offen  lds
  s_mov_b64 s[20:21], s[34:35]
  s_mov_b64 s[24:25], s[36:37]
  buffer_load_dword v80, v5, s[20:23], s52 offen offset:2
  buffer_load_dword v88, v5, s[24:27], s52 offen offset:2
  buffer_load_dword v84, v5, s[20:23], s52 offen offset:516
  buffer_load_dword v92, v5, s[24:27], s52 offen offset:516
  s_add_u32 s52, s52, 32896
  buffer_load_dword v81, v5, s[20:23], s52 offen offset:2
  buffer_load_dword v89, v5, s[24:27], s52 offen offset:2
  buffer_load_dword v85, v5, s[20:23], s52 offen offset:516
  buffer_load_dword v93, v5, s[24:27], s52 offen offset:516
  s_add_u32 s52, s52, 32896
  buffer_load_dword v82, v5, s[20:23], s52 offen offset:2
  buffer_load_dword v90, v5, s[24:27], s52 offen offset:2
  buffer_load_dword v86, v5, s[20:23], s52 offen offset:516
  buffer_load_dword v94, v5, s[24:27], s52 offen offset:516
  s_add_u32 s52, s52, 32896
  buffer_load_dword v83, v5, s[20:23], s52 offen offset:2
  buffer_load_dword v91, v5, s[24:27], s52 offen offset:2
  buffer_load_dword v87, v5, s[20:23], s52 offen offset:516
  buffer_load_dword v95, v5, s[24:27], s52 offen offset:516
  s_mov_b32 s8, s50
  s_mov_b32 s9, s51
  s_mov_b32 s10, 46137344
  s_mov_b32 s11, 0x20000
  s_mov_b32 s24, s48
  s_mov_b32 s25, s49
  s_mov_b32 s26, 256
  s_mov_b32 s27, 0x20000
  s_mov_b32 s58, 0x05040100
  s_mov_b32 s59, 0x07060302
  s_mov_b32 s16, 0x3b000000
  s_mov_b32 s29, 0
  s_lshl_b32 s0, s92, 20
  s_lshl_b32 s5, s3, 18
  s_add_u32 s0, s0, s5
  s_lshr_b32 s5, s93, 1
  s_lshl_b32 s5, s5, 11
  s_add_u32 s0, s0, s5
  s_lshl_b32 s5, s91, 8
  s_add_u32 s0, s0, s5
  s_and_b32 s5, s93, 1
  s_lshl_b32 s5, s5, 7
  s_add_u32 s0, s0, s5
  s_add_u32 s0, s0, 31457280
  v_cmp_eq_u32 vcc, 0, v2
  s_nop 1
  v_cndmask_b32 v10, 0, -1, vcc
  v_lshlrev_b32 v11, 3, v0
  v_add_u32 v11, s28, v11
  v_mul_u32_u24 v13, 272, v0
  s_lshl_b32 s4, s3, 5
  s_add_u32 s4, s4, 73728
  v_add_u32 v4, s4, v13
  v_mul_u32_u24 v14, 272, v3
  v_lshl_add_u32 v14, v2, 4, v14
  s_mul_i32 s4, s3, 4352
  s_add_u32 s4, s4, 49152
  v_add_u32 v14, s4, v14
  v_lshrrev_b32 v8, 3, v0
  v_lshlrev_b32 v8, 13, v8
  v_and_b32 v9, 7, v0
  v_lshl_add_u32 v8, v9, 4, v8
  v_and_b32 v9, 1, v0
  v_lshlrev_b32 v9, 7, v9
  s_lshl_b32 s4, s3, 4
  s_add_u32 s4, s4, 49152
  v_add_u32 v13, s4, v13
  v_add_u32 v5, v13, v9
  v_sub_u32 v13, v13, v9
  v_lshlrev_b32 v15, 11, v3
  v_lshl_add_u32 v15, v2, 4, v15
  s_lshr_b32 s30, s2, 3
  s_lshl_b32 s30, s30, 17
  s_and_b32 s6, s2, 7
  s_lshl_b32 s6, s6, 8
  s_add_u32 s30, s30, s6
  s_lshl_b32 s6, s3, 15
  s_add_u32 s30, s30, s6
  v_cmp_ne_u32 vcc, 0, v0
  s_nop 1
  v_cndmask_b32 v12, 0, 1.0, vcc
  v_lshlrev_b32 v7, 2, v3
  s_lshl_b32 s49, s2, 6
  s_lshl_b32 s6, s3, 4
  s_add_u32 s49, s49, s6
  s_add_u32 s49, s49, 33554432
  s_add_u32 s50, s49, 8192
  s_waitcnt vmcnt(19)
  ds_read_b64_tr_b16 v[16:17], v11 offset:0
  ds_read_b64_tr_b16 v[18:19], v11 offset:512
  s_waitcnt vmcnt(18)
  ds_read_b64_tr_b16 v[20:21], v11 offset:1024
  ds_read_b64_tr_b16 v[22:23], v11 offset:1536
  s_waitcnt vmcnt(17)
  ds_read_b64_tr_b16 v[24:25], v11 offset:2048
  ds_read_b64_tr_b16 v[26:27], v11 offset:2560
  s_waitcnt vmcnt(16)
  ds_read_b64_tr_b16 v[28:29], v11 offset:3072
  ds_read_b64_tr_b16 v[30:31], v11 offset:3584
  s_waitcnt lgkmcnt(0)
  v_mfma_f32_16x16x32_bf16 v[48:51], v[16:19], v[112:115], 0
  v_mfma_f32_16x16x32_bf16 v[52:55], v[16:19], v[116:119], 0
  v_mfma_f32_16x16x32_bf16 v[56:59], v[20:23], v[112:115], 0
  v_mfma_f32_16x16x32_bf16 v[60:63], v[20:23], v[116:119], 0
  v_mfma_f32_16x16x32_bf16 v[64:67], v[24:27], v[112:115], 0
  s_nop 3
  v_mul_f32 v152, v48, v124
  v_mul_f32 v153, v49, v125
  v_mul_f32 v154, v50, v126
  v_mul_f32 v155, v51, v127
  v_mfma_f32_16x16x32_bf16 v[68:71], v[24:27], v[116:119], 0
  v_mul_f32 v48, v48, v120
  v_mul_f32 v49, v49, v121
  v_mul_f32 v50, v50, v122
  v_mul_f32 v51, v51, v123
  v_fma_f32 v48, -v52, v124, v48
  v_fma_f32 v49, -v53, v125, v49
  v_fma_f32 v50, -v54, v126, v50
  v_fma_f32 v51, -v55, v127, v51
  v_fma_f32 v52, v52, v120, v152
  v_fma_f32 v53, v53, v121, v153
  v_fma_f32 v54, v54, v122, v154
  v_fma_f32 v55, v55, v123, v155
  v_cvt_pk_bf16_f32 v16, v48, v49
  v_cvt_pk_bf16_f32 v17, v50, v51
  v_cvt_pk_bf16_f32 v18, v52, v53
  v_cvt_pk_bf16_f32 v19, v54, v55
  v_and_b32 v144, v16, v10
  v_and_b32 v145, v17, v10
  v_and_b32 v146, v18, v10
  v_and_b32 v147, v19, v10
  v_mul_f32 v152, v56, v124
  v_mfma_f32_16x16x32_bf16 v[48:51], v[128:131], v[16:19], 0
  v_mul_f32 v153, v57, v125
  v_mul_f32 v154, v58, v126
  v_mul_f32 v155, v59, v127
  v_mul_f32 v56, v56, v120
  v_mfma_f32_16x16x32_bf16 v[52:55], v[132:135], v[16:19], 0
  v_mul_f32 v57, v57, v121
  v_mul_f32 v58, v58, v122
  v_mul_f32 v59, v59, v123
  v_fma_f32 v56, -v60, v124, v56
  v_mfma_f32_16x16x32_bf16 v[48:51], v[136:139], v[144:147], v[48:51]
  v_fma_f32 v57, -v61, v125, v57
  v_fma_f32 v58, -v62, v126, v58
  v_fma_f32 v59, -v63, v127, v59
  v_fma_f32 v60, v60, v120, v152
  v_mfma_f32_16x16x32_bf16 v[52:55], v[140:143], v[144:147], v[52:55]
  v_fma_f32 v61, v61, v121, v153
  v_fma_f32 v62, v62, v122, v154
  v_fma_f32 v63, v63, v123, v155
  v_cvt_pk_bf16_f32 v20, v56, v57
  v_mfma_f32_16x16x32_bf16 v[72:75], v[28:31], v[112:115], 0
  v_cvt_pk_bf16_f32 v21, v58, v59
  v_cvt_pk_bf16_f32 v22, v60, v61
  v_cvt_pk_bf16_f32 v23, v62, v63
  v_and_b32 v148, v20, v10
  v_mfma_f32_16x16x32_bf16 v[76:79], v[28:31], v[116:119], 0
  v_and_b32 v149, v21, v10
  v_and_b32 v150, v22, v10
  v_and_b32 v151, v23, v10
  v_mul_f32 v152, v64, v124
  v_mfma_f32_16x16x32_bf16 v[56:59], v[128:131], v[20:23], 0
  v_mul_f32 v153, v65, v125
  v_mul_f32 v154, v66, v126
  v_mul_f32 v155, v67, v127
  v_mul_f32 v64, v64, v120
  v_mfma_f32_16x16x32_bf16 v[60:63], v[132:135], v[20:23], 0
  v_mul_f32 v65, v65, v121
  v_mul_f32 v66, v66, v122
  v_mul_f32 v67, v67, v123
  v_fma_f32 v64, -v68, v124, v64
  v_mfma_f32_16x16x32_bf16 v[56:59], v[136:139], v[148:151], v[56:59]
  v_fma_f32 v65, -v69, v125, v65
  v_fma_f32 v66, -v70, v126, v66
  v_fma_f32 v67, -v71, v127, v67
  v_fma_f32 v68, v68, v120, v152
  v_mfma_f32_16x16x32_bf16 v[60:63], v[140:143], v[148:151], v[60:63]
  v_fma_f32 v69, v69, v121, v153
  v_fma_f32 v70, v70, v122, v154
  v_fma_f32 v71, v71, v123, v155
  v_cvt_pk_bf16_f32 v24, v64, v65
  v_cvt_pk_bf16_f32 v25, v66, v67
  v_cvt_pk_bf16_f32 v26, v68, v69
  v_cvt_pk_bf16_f32 v27, v70, v71
  v_and_b32 v144, v24, v10
  v_and_b32 v145, v25, v10
  v_and_b32 v146, v26, v10
  v_and_b32 v147, v27, v10
  v_mul_f32 v152, v72, v124
  v_mfma_f32_16x16x32_bf16 v[64:67], v[128:131], v[24:27], 0
  v_mul_f32 v153, v73, v125
  v_mul_f32 v154, v74, v126
  v_mul_f32 v155, v75, v127
  v_mul_f32 v72, v72, v120
  v_mfma_f32_16x16x32_bf16 v[68:71], v[132:135], v[24:27], 0
  v_mul_f32 v73, v73, v121
  v_mul_f32 v74, v74, v122
  v_mul_f32 v75, v75, v123
  v_fma_f32 v72, -v76, v124, v72
  v_mfma_f32_16x16x32_bf16 v[64:67], v[136:139], v[144:147], v[64:67]
  v_fma_f32 v73, -v77, v125, v73
  v_fma_f32 v74, -v78, v126, v74
  v_fma_f32 v75, -v79, v127, v75
  v_fma_f32 v76, v76, v120, v152
  v_mfma_f32_16x16x32_bf16 v[68:71], v[140:143], v[144:147], v[68:71]
  v_fma_f32 v77, v77, v121, v153
  v_fma_f32 v78, v78, v122, v154
  v_fma_f32 v79, v79, v123, v155
  v_cvt_pk_bf16_f32 v28, v72, v73
  v_cvt_pk_bf16_f32 v29, v74, v75
  v_cvt_pk_bf16_f32 v30, v76, v77
  v_cvt_pk_bf16_f32 v31, v78, v79
  v_and_b32 v148, v28, v10
  v_and_b32 v149, v29, v10
  v_and_b32 v150, v30, v10
  v_and_b32 v151, v31, v10
  v_mfma_f32_16x16x32_bf16 v[72:75], v[128:131], v[28:31], 0
  v_mfma_f32_16x16x32_bf16 v[76:79], v[132:135], v[28:31], 0
  v_mfma_f32_16x16x32_bf16 v[72:75], v[136:139], v[148:151], v[72:75]
  v_mfma_f32_16x16x32_bf16 v[76:79], v[140:143], v[148:151], v[76:79]
  s_waitcnt vmcnt(0)
  v_perm_b32 v96, v88, v80, s58
  v_perm_b32 v97, v89, v81, s58
  v_perm_b32 v98, v90, v82, s58
  v_perm_b32 v99, v91, v83, s58
  ds_write_b128 v4, v[96:99] offset:0
  v_perm_b32 v100, v92, v84, s58
  v_perm_b32 v101, v93, v85, s58
  v_perm_b32 v102, v94, v86, s58
  v_perm_b32 v103, v95, v87, s58
  ds_write_b128 v4, v[100:103] offset:16
  v_perm_b32 v104, v88, v80, s59
  v_perm_b32 v105, v89, v81, s59
  v_perm_b32 v106, v90, v82, s59
  v_perm_b32 v107, v91, v83, s59
  ds_write_b128 v4, v[104:107] offset:128
  v_perm_b32 v108, v92, v84, s59
  v_perm_b32 v109, v93, v85, s59
  v_perm_b32 v110, v94, v86, s59
  v_perm_b32 v111, v95, v87, s59
  ds_write_b128 v4, v[108:111] offset:144
  v_cvt_pk_bf16_f32 v32, v48, v56
  v_cvt_pk_bf16_f32 v33, v64, v72
  v_cvt_pk_bf16_f32 v34, v52, v60
  v_cvt_pk_bf16_f32 v35, v68, v76
  ds_write_b128 v5, v[32:35] offset:0
  v_cvt_pk_bf16_f32 v36, v49, v57
  v_cvt_pk_bf16_f32 v37, v65, v73
  v_cvt_pk_bf16_f32 v38, v53, v61
  v_cvt_pk_bf16_f32 v39, v69, v77
  ds_write_b128 v5, v[36:39] offset:64
  v_cvt_pk_bf16_f32 v40, v50, v58
  v_cvt_pk_bf16_f32 v41, v66, v74
  v_cvt_pk_bf16_f32 v42, v54, v62
  v_cvt_pk_bf16_f32 v43, v70, v78
  ds_write_b128 v13, v[40:43] offset:128
  v_cvt_pk_bf16_f32 v44, v51, v59
  v_cvt_pk_bf16_f32 v45, v67, v75
  v_cvt_pk_bf16_f32 v46, v55, v63
  v_cvt_pk_bf16_f32 v47, v71, v79
  ds_write_b128 v13, v[44:47] offset:192
  v_mul_f32 v52, v52, v12
  v_mul_f32 v60, v60, v12
  v_mul_f32 v68, v68, v12
  v_mul_f32 v76, v76, v12
  v_pk_mul_f32 v[144:145], v[48:49], v[48:49]
  v_pk_mul_f32 v[146:147], v[56:57], v[56:57]
  v_pk_mul_f32 v[148:149], v[64:65], v[64:65]
  v_pk_mul_f32 v[150:151], v[72:73], v[72:73]
  v_pk_fma_f32 v[144:145], v[50:51], v[50:51], v[144:145]
  v_pk_fma_f32 v[146:147], v[58:59], v[58:59], v[146:147]
  v_pk_fma_f32 v[148:149], v[66:67], v[66:67], v[148:149]
  v_pk_fma_f32 v[150:151], v[74:75], v[74:75], v[150:151]
  v_pk_fma_f32 v[144:145], v[52:53], v[52:53], v[144:145]
  v_pk_fma_f32 v[146:147], v[60:61], v[60:61], v[146:147]
  v_pk_fma_f32 v[148:149], v[68:69], v[68:69], v[148:149]
  v_pk_fma_f32 v[150:151], v[76:77], v[76:77], v[150:151]
  v_pk_fma_f32 v[144:145], v[54:55], v[54:55], v[144:145]
  v_pk_fma_f32 v[146:147], v[62:63], v[62:63], v[146:147]
  v_pk_fma_f32 v[148:149], v[70:71], v[70:71], v[148:149]
  v_pk_fma_f32 v[150:151], v[78:79], v[78:79], v[150:151]
  s_waitcnt lgkmcnt(0)
  s_barrier
  ds_read_b128 v[16:19], v14 offset:0
  ds_read_b128 v[20:23], v14 offset:1088
  ds_read_b128 v[24:27], v14 offset:2176
  ds_read_b128 v[28:31], v14 offset:3264
  ds_read_b128 v[32:35], v14 offset:24576
  ds_read_b128 v[36:39], v14 offset:25664
  ds_read_b128 v[40:43], v14 offset:26752
  ds_read_b128 v[44:47], v14 offset:27840
  v_add_f32 v152, v144, v145
  v_add_f32 v153, v146, v147
  v_add_f32 v154, v148, v149
  v_add_f32 v155, v150, v151
  s_nop 0
  v_permlane32_swap_b32 v152, v154
  v_permlane32_swap_b32 v153, v155
  v_pk_add_f32 v[152:153], v[152:153], v[154:155]
  v_mov_b32 v9, 0x3727c5ac
  v_mov_b32 v5, 0
  v_permlane16_swap_b32 v152, v153
  v_add_f32 v11, v152, v153
  s_waitcnt lgkmcnt(7)
  buffer_store_dwordx4 v[16:19], v15, s[8:11], s30 offen sc1
  s_add_u32 s30, s30, 8192
  v_add_f32_dpp v11, v11, v11 row_ror:8 row_mask:0xf bank_mask:0xf
  s_waitcnt lgkmcnt(6)
  buffer_store_dwordx4 v[20:23], v15, s[8:11], s30 offen sc1
  s_add_u32 s30, s30, 8192
  v_add_f32_dpp v11, v11, v11 row_ror:4 row_mask:0xf bank_mask:0xf
  s_waitcnt lgkmcnt(5)
  buffer_store_dwordx4 v[24:27], v15, s[8:11], s30 offen sc1
  s_add_u32 s30, s30, 8192
  v_add_f32_dpp v11, v11, v11 quad_perm:[1,0,3,2] row_mask:0xf bank_mask:0xf
  s_waitcnt lgkmcnt(4)
  buffer_store_dwordx4 v[28:31], v15, s[8:11], s30 offen sc1
  s_add_u32 s30, s30, 8192
  v_add_f32_dpp v11, v11, v11 quad_perm:[2,3,0,1] row_mask:0xf bank_mask:0xf
  s_waitcnt lgkmcnt(3)
  buffer_store_dwordx4 v[32:35], v8, s[8:11], s0 offen sc1
  s_add_u32 s0, s0, 65536
  v_fmac_f32 v9, s16, v11
  s_waitcnt lgkmcnt(2)
  buffer_store_dwordx4 v[36:39], v8, s[8:11], s0 offen sc1
  s_add_u32 s0, s0, 65536
  v_rsq_f32 v11, v9
  s_waitcnt lgkmcnt(1)
  buffer_store_dwordx4 v[40:43], v8, s[8:11], s0 offen sc1
  s_add_u32 s0, s0, 65536
  s_waitcnt lgkmcnt(0)
  buffer_store_dwordx4 v[44:47], v8, s[8:11], s0 offen sc1
  s_add_u32 s0, s0, 65536
  s_mov_b32 exec_lo, 0x00010001
  s_mov_b32 exec_hi, 0x00010001
  buffer_store_dword v11, v7, s[8:11], s49 offen sc1
  buffer_store_dword v5, v7, s[8:11], s50 offen sc1
  s_mov_b64 exec, -1
  buffer_load_dword v172, v5, s[24:27], 0 offen sc1
  s_branch P1_COM
P1_DE:
  s_add_u32 s1, s3, 168
  s_lshl_b32 s4, s1, 13
  s_add_u32 m0, s28, 98304
  s_nop 0
  buffer_load_dwordx4 v1, s[16:19], s4 offen offset:0 lds
  buffer_load_dwordx4 v1, s[16:19], s4 offen offset:1024 lds
  buffer_load_dwordx4 v1, s[16:19], s4 offen offset:2048 lds
  buffer_load_dwordx4 v1, s[16:19], s4 offen offset:3072 lds
  s_add_u32 m0, m0, 4096
  s_add_u32 s4, s4, 4096
  buffer_load_dwordx4 v1, s[16:19], s4 offen offset:0 lds
  buffer_load_dwordx4 v1, s[16:19], s4 offen offset:1024 lds
  buffer_load_dwordx4 v1, s[16:19], s4 offen offset:2048 lds
  buffer_load_dwordx4 v1, s[16:19], s4 offen offset:3072 lds
  s_branch P1_LD
P1_XE:
  s_mov_b64 s[16:17], s[44:45]
  s_mov_b32 s18, 1409024
  s_lshl_b32 s6, s2, 13
  s_add_u32 s6, s6, 1376256
  s_add_u32 m0, s28, 98304
  s_nop 0
  buffer_load_dwordx4 v1, s[16:19], s6 offen offset:0 lds
  buffer_load_dwordx4 v1, s[16:19], s6 offen offset:1024 lds
  buffer_load_dwordx4 v1, s[16:19], s6 offen offset:2048 lds
  buffer_load_dwordx4 v1, s[16:19], s6 offen offset:3072 lds
  s_add_u32 m0, m0, 4096
  s_add_u32 s6, s6, 4096
  buffer_load_dwordx4 v1, s[16:19], s6 offen offset:0 lds
  buffer_load_dwordx4 v1, s[16:19], s6 offen offset:1024 lds
  buffer_load_dwordx4 v1, s[16:19], s6 offen offset:2048 lds
  buffer_load_dwordx4 v1, s[16:19], s6 offen offset:3072 lds
  s_mov_b32 s18, 2097152
  s_mov_b32 m0, s28
  s_branch P1_X2
P1_GT:
  s_mov_b32 s8, s50
  s_mov_b32 s9, s51
  s_mov_b32 s10, 46137344
  s_mov_b32 s11, 0x20000
  s_mov_b32 s24, s48
  s_mov_b32 s25, s49
  s_mov_b32 s26, 256
  s_mov_b32 s27, 0x20000
  s_mov_b32 s58, 0x05040100
  s_mov_b32 s59, 0x07060302
  v_cmp_eq_u32 vcc, 0, v2
  s_nop 1
  v_cndmask_b32 v10, 0, -1, vcc
P1_COM:
  s_mov_b32 s20, s46
  s_mov_b32 s21, s47
  s_mov_b32 s22, 2097152
  s_mov_b32 s23, 0x20000
  s_and_b32 s4, s2, 7
  s_lshr_b32 s5, s2, 3
  s_lshl_b32 s52, s4, 5
  s_add_u32 s52, s52, s5
  s_lshr_b32 s53, s4, 1
  s_lshl_b32 s53, s53, 2
  s_and_b32 s6, s5, 3
  s_add_u32 s53, s53, s6
  s_and_b32 s54, s4, 1
  s_lshl_b32 s54, s54, 3
  s_lshr_b32 s6, s5, 2
  s_add_u32 s54, s54, s6
  s_lshr_b32 s6, s54, 3
  s_lshl_b32 s55, s53, 1
  s_add_u32 s55, s55, s6
  s_and_b32 s56, s54, 7
  s_lshr_b32 s6, s54, 3
  s_sub_u32 s7, s54, s6
  s_add_u32 s6, s6, 14
  s_cmp_eq_u32 s56, 7
  s_cselect_b32 s54, s6, s7
  s_mul_i32 s57, s54, 12
  s_mul_i32 s6, s3, 3
  s_add_u32 s57, s57, s6
  v_lshlrev_b32 v6, 10, v3
  v_lshl_add_u32 v6, v2, 4, v6
  s_lshl_b32 s5, s57, 14
  s_add_u32 s5, s5, 23068672
  s_min_u32 s4, s57, 170
  s_lshl_b32 s4, s4, 10
  s_mul_i32 s6, s53, 352256
  s_add_u32 s6, s6, s4
  s_cmp_lt_u32 s57, 174
  s_cselect_b32 s88, s5, 46137344
  s_cselect_b32 s40, s6, 46137344
  s_add_u32 s89, s88, 16384
  s_add_u32 s41, s40, 176128
  s_add_u32 s5, s5, 32768
  s_add_u32 s6, s6, 2048
  s_cmp_lt_u32 s57, 168
  s_cselect_b32 s90, s5, 46137344
  s_cselect_b32 s42, s6, 46137344
  s_mul_i32 s4, s3, 45056
  s_mul_i32 s32, s56, 176128
  s_add_u32 s32, s32, s4
  s_mul_i32 s34, s55, 176128
  s_add_u32 s34, s34, s4
  s_and_b32 s57, s3, 1
  s_lshl_b32 s57, s57, 10
  s_cmp_eq_u32 s3, 3
  s_cselect_b32 s33, 46137344, s32
  s_lshl_b32 s36, s56, 16
  s_lshl_b32 s4, s3, 12
  s_add_u32 s36, s36, s4
  s_add_u32 s36, s36, 25952256
  s_lshl_b32 s37, s53, 17
  s_lshl_b32 s38, s3, 11
  s_add_u32 s37, s37, s38
  s_lshr_b32 s35, s3, 1
  s_lshl_b32 s35, s35, 8
  s_xor_b32 s4, s35, 256
  s_add_u32 s92, s34, s4
  s_add_u32 s93, s34, s35
  s_bfe_u32 s4, s52, 0x40002
  s_lshr_b32 s5, s52, 6
  s_lshl_b32 s5, s5, 2
  s_and_b32 s6, s52, 3
  s_add_u32 s5, s5, s6
  s_lshl_b32 s6, s5, 5
  s_add_u32 s6, s6, s4
  s_sub_u32 s7, 512, s6
  s_sub_u32 s39, s6, 240
  s_cmp_eq_u32 s4, 0
  s_cselect_b32 s7, s39, s7
  s_cmp_lt_u32 s5, 8
  s_cselect_b32 s6, s6, s7
  s_cmp_eq_u32 s52, 0
  s_cselect_b32 s6, 256, s6
  s_cselect_b32 s51, 0, -1
  s_sub_u32 s6, s6, 1
  s_lshl_b32 s6, s6, 13
  s_add_u32 s39, s6, s38
  s_add_u32 s39, s39, 31457280
  s_lshr_b32 s5, s52, 2
  s_and_b32 s6, s52, 3
  s_bfe_u32 s7, s52, 0x10002
  s_lshl_b32 s7, s7, 1
  s_xor_b32 s6, s6, s7
  s_lshl_b32 s5, s5, 11
  s_lshl_b32 s6, s6, 6
  s_add_u32 s5, s5, s6
  s_lshl_b32 s6, s3, 18
  s_add_u32 s43, s5, s6
Lstub0:
  s_lshr_b32 s44, s3, 1
  s_lshl_b32 s44, s44, 11
  s_and_b32 s7, s3, 1
  s_lshl_b32 s7, s7, 9
  s_add_u32 s44, s44, s7
  s_add_u32 s44, s44, 32768
  s_mov_b32 s16, 0x3b000000
  s_mov_b32 s17, s16
  s_mov_b32 s18, 0x80008000
  s_mov_b32 s19, 0xffff0000
  s_mul_i32 s4, s3, 9216
  s_add_u32 s4, s4, 49152
  v_mul_u32_u24 v13, 144, v0
  v_add_u32 v13, s4, v13
  v_lshrrev_b32 v7, 3, v0
  v_mul_u32_u24 v14, 144, v7
  v_and_b32 v8, 7, v0
  v_lshl_add_u32 v14, v8, 4, v14
  v_add_u32 v14, s4, v14
  v_mov_b32 v15, v1
  s_mov_b32 s47, 92274688
  s_mov_b32 s48, 0
  s_mov_b32 s45, s29
  s_mov_b32 s49, s47
  s_cmp_lg_u32 s29, 0
  s_cbranch_scc1 P1_E2
  v_mov_b32 v4, 1
  v_mul_u32_u24 v5, 4224, v0
  s_and_b32 s4, s2, 7
  s_mul_i32 s4, s4, 4224
  s_add_u32 s4, s4, 36700160
  s_cmp_lg_u32 s3, 0
  s_waitcnt vmcnt(0) lgkmcnt(0)
  s_barrier
  s_cbranch_scc1 Larr_1
  v_readfirstlane_b32 s5, v172
  s_nop 0
  s_cmp_ge_u32 s5, 9
  s_cbranch_scc1 Lok_2
  v_mov_b32 v8, 0
  s_mov_b32 s7, 0x100000
Lpoll_3:
  buffer_load_dword v4, v8, s[24:27], 0 offen sc1
  s_sub_u32 s7, s7, 1
  s_cbranch_scc1 Ldone_4
  s_waitcnt vmcnt(0)
  v_cmp_gt_u32 vcc, 9, v4
  s_cbranch_vccnz Lpoll_3
Ldone_4:
  s_waitcnt vmcnt(0)
  v_mov_b32 v4, 1
Lok_2:
  s_mov_b64 exec, 1
  buffer_atomic_add v4, v5, s[8:11], s4 offen sc0 sc1
  s_mov_b32 s4, 36835328
  s_waitcnt vmcnt(0)
  v_readfirstlane_b32 s5, v4
  s_mov_b64 exec, -1
  s_cmp_lg_u32 s5, 15
  s_cbranch_scc1 Larr_1
  v_mov_b32 v4, 1
  s_mov_b64 exec, 0xff
  buffer_atomic_add v4, v5, s[8:11], s4 offen sc1
  s_mov_b64 exec, -1
Larr_1:
  s_add_u32 s31, s2, 168
  s_cmp_lt_u32 s1, 4
  s_cselect_b32 s29, 1, 0
  s_cbranch_scc1 P1_E3
  s_add_u32 s5, s28, 8192
  s_add_u32 m0, s28, 131072
  s_nop 0
  buffer_load_dwordx4 v1, s[12:15], s5 offen offset:0 lds
  buffer_load_dwordx4 v1, s[12:15], s5 offen offset:1024 lds
  buffer_load_dwordx4 v1, s[12:15], s5 offen offset:2048 lds
  buffer_load_dwordx4 v1, s[12:15], s5 offen offset:3072 lds
  s_add_u32 m0, m0, 4096
  s_add_u32 s5, s5, 4096
  buffer_load_dwordx4 v1, s[12:15], s5 offen offset:0 lds
  buffer_load_dwordx4 v1, s[12:15], s5 offen offset:1024 lds
  buffer_load_dwordx4 v1, s[12:15], s5 offen offset:2048 lds
  buffer_load_dwordx4 v1, s[12:15], s5 offen offset:3072 lds
  s_waitcnt vmcnt(0)
P1_E3:
  s_add_u32 s28, s28, 98304
P1_E2:
  s_cmp_eq_u32 s29, 0
  s_cbranch_scc1 P1_END
  s_cmp_lg_u32 s3, 2
  s_cbranch_scc1 Lnt1_782
  s_mov_b64 exec, 0
  s_branch Lstub1
Lret1_782:
  s_mov_b64 exec, -1
Lnt1_782:
  s_cmp_eq_u32 s29, 2
  s_cbranch_scc1 P1_AG
  v_lshlrev_b32 v11, 3, v0
  v_add_u32 v11, s28, v11
  s_lshl_b32 s46, s31, 10
  s_add_u32 s47, s46, 29360128
  s_mov_b32 s48, 176128
  s_waitcnt vmcnt(0)
  s_cmp_lg_u32 s54, 15
  s_cbranch_scc1 P1_NQ
  s_lshl_b32 s5, s53, 15
  s_add_u32 s5, s5, s28
  s_add_u32 s4, s5, 40960
  s_add_u32 s5, s4, 4096
  buffer_load_dwordx4 a[160:163], v1, s[12:15], s4 offen offset:0
  buffer_load_dwordx4 a[164:167], v1, s[12:15], s4 offen offset:1024
  buffer_load_dwordx4 a[168:171], v1, s[12:15], s4 offen offset:2048
  buffer_load_dwordx4 a[172:175], v1, s[12:15], s4 offen offset:3072
  buffer_load_dwordx4 a[176:179], v1, s[12:15], s5 offen offset:0
  buffer_load_dwordx4 a[180:183], v1, s[12:15], s5 offen offset:1024
  buffer_load_dwordx4 a[184:187], v1, s[12:15], s5 offen offset:2048
  buffer_load_dwordx4 a[188:191], v1, s[12:15], s5 offen offset:3072
  s_lshl_b32 s4, s53, 9
  s_lshl_b32 s5, s3, 7
  s_add_u32 s4, s4, s5
  s_add_u32 s4, s4, 33570816
  s_add_u32 s5, s4, 8192
  s_mov_b64 exec, 0xff
  buffer_store_dwordx4 v[0:3], v1, s[8:11], s4 offen sc1
  buffer_store_dwordx4 v[0:3], v1, s[8:11], s5 offen sc1
  s_mov_b64 exec, -1
P1_NQ:
  ds_read_b64_tr_b16 v[16:17], v11 offset:0
  ds_read_b64_tr_b16 v[18:19], v11 offset:512
  ds_read_b64_tr_b16 v[20:21], v11 offset:1024
  ds_read_b64_tr_b16 v[22:23], v11 offset:1536
  ds_read_b64_tr_b16 v[24:25], v11 offset:2048
  ds_read_b64_tr_b16 v[26:27], v11 offset:2560
  ds_read_b64_tr_b16 v[28:29], v11 offset:3072
  ds_read_b64_tr_b16 v[30:31], v11 offset:3584
  ds_read_b64_tr_b16 v[32:33], v11 offset:4096
  ds_read_b64_tr_b16 v[34:35], v11 offset:4608
  ds_read_b64_tr_b16 v[36:37], v11 offset:5120
  ds_read_b64_tr_b16 v[38:39], v11 offset:5632
  s_waitcnt lgkmcnt(8)
  ds_read_b64_tr_b16 v[40:41], v11 offset:6144
  ds_read_b64_tr_b16 v[42:43], v11 offset:6656
  ds_read_b64_tr_b16 v[44:45], v11 offset:7168
  ds_read_b64_tr_b16 v[46:47], v11 offset:7680
  s_branch P1_CORE
P1_AG:
  s_lshr_b32 s4, s30, 1
  s_and_b32 s0, s30, 1
  s_mul_i32 s5, s4, 171
  s_lshr_b32 s5, s5, 9
  s_mul_i32 s5, s5, 3
  s_sub_u32 s6, s4, s5
  s_cmp_ge_u32 s4, 170
  s_cselect_b32 s5, 171, s5
  s_and_b32 s7, s4, 1
  s_cmp_ge_u32 s4, 170
  s_cselect_b32 s6, s7, s6
  s_lshl_b32 s47, s5, 14
  s_add_u32 s47, s47, 23068672
  s_lshl_b32 s5, s0, 14
  s_lshl_b32 s7, s6, 7
  s_add_u32 s5, s5, s7
  s_lshl_b32 s7, s0, 6
  s_add_u32 s7, s7, 32768
  s_cmp_eq_u32 s6, 2
  s_cselect_b32 s5, s7, s5
  s_cselect_b32 s7, 64, 0
  s_add_u32 s47, s47, s5
  s_movk_i32 s48, 2048
  v_lshrrev_b32 v15, 3, v0
  v_lshlrev_b32 v15, 8, v15
  v_and_b32 v9, 7, v0
  v_lshl_add_u32 v15, v9, 4, v15
  v_bfe_u32 v9, v0, 2, 1
  v_mad_u32_u24 v15, v9, s7, v15
  s_lshr_b32 s4, s4, 2
  s_mul_i32 s4, s4, 43
  s_lshr_b32 s4, s4, 7
  s_mul_i32 s4, s4, 4224
  s_add_u32 s4, s4, 38592512
  s_cmp_eq_u32 s3, 0
  s_cselect_b32 s49, s4, s49
  v_lshrrev_b32 v11, 2, v2
  v_xor_b32 v11, s3, v11
  v_lshlrev_b32 v11, 4, v11
  v_lshl_add_u32 v11, v2, 6, v11
  v_lshl_add_u32 v11, v3, 12, v11
  v_mov_b32 v12, -1
  v_mov_b32 v9, 0xffff
  v_cmp_eq_u32 vcc, 0, v0
  s_nop 1
  v_cndmask_b32 v12, v12, v9, vcc
  s_waitcnt vmcnt(0)
  s_barrier
  ds_read_b128 v[48:51], v11 offset:0
  ds_read_b128 v[52:55], v11 offset:1024
  ds_read_b128 v[56:59], v11 offset:2048
  ds_read_b128 v[60:63], v11 offset:3072
  ds_read_b128 v[64:67], v11 offset:16384
  ds_read_b128 v[68:71], v11 offset:17408
  ds_read_b128 v[72:75], v11 offset:18432
  ds_read_b128 v[76:79], v11 offset:19456
  s_waitcnt lgkmcnt(6)
  v_perm_b32 v16, v52, v48, s58
  v_perm_b32 v20, v52, v48, s59
  v_perm_b32 v24, v53, v49, s58
  v_perm_b32 v28, v53, v49, s59
  v_perm_b32 v32, v54, v50, s58
  v_perm_b32 v36, v54, v50, s59
  v_perm_b32 v40, v55, v51, s58
  v_perm_b32 v44, v55, v51, s59
  s_waitcnt lgkmcnt(4)
  v_perm_b32 v17, v60, v56, s58
  v_perm_b32 v21, v60, v56, s59
  v_perm_b32 v25, v61, v57, s58
  v_perm_b32 v29, v61, v57, s59
  v_perm_b32 v33, v62, v58, s58
  v_perm_b32 v37, v62, v58, s59
  v_perm_b32 v41, v63, v59, s58
  v_perm_b32 v45, v63, v59, s59
  s_waitcnt lgkmcnt(2)
  v_perm_b32 v18, v68, v64, s58
  v_perm_b32 v22, v68, v64, s59
  v_perm_b32 v26, v69, v65, s58
  v_perm_b32 v30, v69, v65, s59
  v_perm_b32 v34, v70, v66, s58
  v_perm_b32 v38, v70, v66, s59
  v_perm_b32 v42, v71, v67, s58
  v_perm_b32 v46, v71, v67, s59
  s_waitcnt lgkmcnt(0)
  v_perm_b32 v19, v76, v72, s58
  v_perm_b32 v23, v76, v72, s59
  v_perm_b32 v27, v77, v73, s58
  v_perm_b32 v31, v77, v73, s59
  v_perm_b32 v35, v78, v74, s58
  v_perm_b32 v39, v78, v74, s59
  v_perm_b32 v43, v79, v75, s58
  v_perm_b32 v47, v79, v75, s59
P1_CORE:
  s_mov_b32 s0, s28
  s_lshl_b32 s28, s3, 13
  s_add_u32 s5, s28, 8192
  s_add_u32 m0, s28, 131072
  s_nop 0
  buffer_load_dwordx4 v1, s[12:15], s5 offen offset:0 lds
  buffer_load_dwordx4 v1, s[12:15], s5 offen offset:1024 lds
  buffer_load_dwordx4 v1, s[12:15], s5 offen offset:2048 lds
  buffer_load_dwordx4 v1, s[12:15], s5 offen offset:3072 lds
  s_add_u32 m0, m0, 4096
  s_add_u32 s5, s5, 4096
  buffer_load_dwordx4 v1, s[12:15], s5 offen offset:0 lds
  buffer_load_dwordx4 v1, s[12:15], s5 offen offset:1024 lds
  buffer_load_dwordx4 v1, s[12:15], s5 offen offset:2048 lds
  buffer_load_dwordx4 v1, s[12:15], s5 offen offset:3072 lds
  s_mov_b32 s28, s0
  v_mov_b32 v5, 0
  buffer_load_dword v4, v5, s[24:27], 0 offen sc1
  s_waitcnt lgkmcnt(0)
  v_mfma_f32_16x16x32_bf16 v[48:51], v[16:19], v[112:115], 0
  v_mfma_f32_16x16x32_bf16 v[52:55], v[16:19], v[116:119], 0
  v_mfma_f32_16x16x32_bf16 v[56:59], v[20:23], v[112:115], 0
  v_mfma_f32_16x16x32_bf16 v[60:63], v[20:23], v[116:119], 0
  v_mfma_f32_16x16x32_bf16 v[64:67], v[24:27], v[112:115], 0
  s_nop 3
  v_mul_f32 v152, v48, v124
  v_mul_f32 v153, v49, v125
  v_mul_f32 v154, v50, v126
  v_mul_f32 v155, v51, v127
  v_mfma_f32_16x16x32_bf16 v[68:71], v[24:27], v[116:119], 0
  v_mul_f32 v48, v48, v120
  v_mul_f32 v49, v49, v121
  v_mul_f32 v50, v50, v122
  v_mul_f32 v51, v51, v123
  v_fma_f32 v48, -v52, v124, v48
  v_fma_f32 v49, -v53, v125, v49
  v_fma_f32 v50, -v54, v126, v50
  v_fma_f32 v51, -v55, v127, v51
  v_fma_f32 v52, v52, v120, v152
  v_fma_f32 v53, v53, v121, v153
  v_fma_f32 v54, v54, v122, v154
  v_fma_f32 v55, v55, v123, v155
  v_cvt_pk_bf16_f32 v16, v48, v49
  v_cvt_pk_bf16_f32 v17, v50, v51
  v_cvt_pk_bf16_f32 v18, v52, v53
  v_cvt_pk_bf16_f32 v19, v54, v55
  v_and_b32 v144, v16, v10
  v_and_b32 v145, v17, v10
  v_and_b32 v146, v18, v10
  v_and_b32 v147, v19, v10
  v_mul_f32 v152, v56, v124
  v_mfma_f32_16x16x32_bf16 v[48:51], v[128:131], v[16:19], 0
  v_mul_f32 v153, v57, v125
  v_mul_f32 v154, v58, v126
  v_mul_f32 v155, v59, v127
  v_mul_f32 v56, v56, v120
  v_mfma_f32_16x16x32_bf16 v[52:55], v[132:135], v[16:19], 0
  v_mul_f32 v57, v57, v121
  v_mul_f32 v58, v58, v122
  v_mul_f32 v59, v59, v123
  v_fma_f32 v56, -v60, v124, v56
  v_mfma_f32_16x16x32_bf16 v[48:51], v[136:139], v[144:147], v[48:51]
  v_fma_f32 v57, -v61, v125, v57
  v_fma_f32 v58, -v62, v126, v58
  v_fma_f32 v59, -v63, v127, v59
  v_fma_f32 v60, v60, v120, v152
  v_mfma_f32_16x16x32_bf16 v[52:55], v[140:143], v[144:147], v[52:55]
  v_fma_f32 v61, v61, v121, v153
  v_fma_f32 v62, v62, v122, v154
  v_fma_f32 v63, v63, v123, v155
  v_cvt_pk_bf16_f32 v20, v56, v57
  v_mfma_f32_16x16x32_bf16 v[72:75], v[28:31], v[112:115], 0
  v_cvt_pk_bf16_f32 v21, v58, v59
  v_cvt_pk_bf16_f32 v22, v60, v61
  v_cvt_pk_bf16_f32 v23, v62, v63
  v_and_b32 v148, v20, v10
  v_mfma_f32_16x16x32_bf16 v[76:79], v[28:31], v[116:119], 0
  v_and_b32 v149, v21, v10
  v_and_b32 v150, v22, v10
  v_and_b32 v151, v23, v10
  v_mul_f32 v152, v64, v124
  v_mfma_f32_16x16x32_bf16 v[56:59], v[128:131], v[20:23], 0
  v_mul_f32 v153, v65, v125
  v_mul_f32 v154, v66, v126
  v_mul_f32 v155, v67, v127
  v_mul_f32 v64, v64, v120
  v_mfma_f32_16x16x32_bf16 v[60:63], v[132:135], v[20:23], 0
  v_mul_f32 v65, v65, v121
  v_mul_f32 v66, v66, v122
  v_mul_f32 v67, v67, v123
  v_fma_f32 v64, -v68, v124, v64
  v_mfma_f32_16x16x32_bf16 v[56:59], v[136:139], v[148:151], v[56:59]
  v_fma_f32 v65, -v69, v125, v65
  v_fma_f32 v66, -v70, v126, v66
  v_fma_f32 v67, -v71, v127, v67
  v_fma_f32 v68, v68, v120, v152
  v_mfma_f32_16x16x32_bf16 v[60:63], v[140:143], v[148:151], v[60:63]
  v_fma_f32 v69, v69, v121, v153
  v_fma_f32 v70, v70, v122, v154
  v_fma_f32 v71, v71, v123, v155
  v_cvt_pk_bf16_f32 v24, v64, v65
  v_mfma_f32_16x16x32_bf16 v[80:83], v[32:35], v[112:115], 0
  v_cvt_pk_bf16_f32 v25, v66, v67
  v_cvt_pk_bf16_f32 v26, v68, v69
  v_cvt_pk_bf16_f32 v27, v70, v71
  v_and_b32 v144, v24, v10
  v_mfma_f32_16x16x32_bf16 v[84:87], v[32:35], v[116:119], 0
  v_and_b32 v145, v25, v10
  v_and_b32 v146, v26, v10
  v_and_b32 v147, v27, v10
  v_mul_f32 v152, v72, v124
  v_mfma_f32_16x16x32_bf16 v[64:67], v[128:131], v[24:27], 0
  v_mul_f32 v153, v73, v125
  v_mul_f32 v154, v74, v126
  v_mul_f32 v155, v75, v127
  v_mul_f32 v72, v72, v120
  v_mfma_f32_16x16x32_bf16 v[68:71], v[132:135], v[24:27], 0
  v_mul_f32 v73, v73, v121
  v_mul_f32 v74, v74, v122
  v_mul_f32 v75, v75, v123
  v_fma_f32 v72, -v76, v124, v72
  v_mfma_f32_16x16x32_bf16 v[64:67], v[136:139], v[144:147], v[64:67]
  v_fma_f32 v73, -v77, v125, v73
  v_fma_f32 v74, -v78, v126, v74
  v_fma_f32 v75, -v79, v127, v75
  v_fma_f32 v76, v76, v120, v152
  v_mfma_f32_16x16x32_bf16 v[68:71], v[140:143], v[144:147], v[68:71]
  v_fma_f32 v77, v77, v121, v153
  v_fma_f32 v78, v78, v122, v154
  v_fma_f32 v79, v79, v123, v155
  v_cvt_pk_bf16_f32 v28, v72, v73
  v_mfma_f32_16x16x32_bf16 v[88:91], v[36:39], v[112:115], 0
  v_cvt_pk_bf16_f32 v29, v74, v75
  v_cvt_pk_bf16_f32 v30, v76, v77
  v_cvt_pk_bf16_f32 v31, v78, v79
  v_and_b32 v148, v28, v10
  v_mfma_f32_16x16x32_bf16 v[92:95], v[36:39], v[116:119], 0
  v_and_b32 v149, v29, v10
  v_and_b32 v150, v30, v10
  v_and_b32 v151, v31, v10
  v_mul_f32 v152, v80, v124
  v_mfma_f32_16x16x32_bf16 v[72:75], v[128:131], v[28:31], 0
  v_mul_f32 v153, v81, v125
  v_mul_f32 v154, v82, v126
  v_mul_f32 v155, v83, v127
  v_mul_f32 v80, v80, v120
  v_mfma_f32_16x16x32_bf16 v[76:79], v[132:135], v[28:31], 0
  v_mul_f32 v81, v81, v121
  v_mul_f32 v82, v82, v122
  v_mul_f32 v83, v83, v123
  v_fma_f32 v80, -v84, v124, v80
  v_mfma_f32_16x16x32_bf16 v[72:75], v[136:139], v[148:151], v[72:75]
  v_fma_f32 v81, -v85, v125, v81
  v_fma_f32 v82, -v86, v126, v82
  v_fma_f32 v83, -v87, v127, v83
  v_fma_f32 v84, v84, v120, v152
  v_mfma_f32_16x16x32_bf16 v[76:79], v[140:143], v[148:151], v[76:79]
  v_fma_f32 v85, v85, v121, v153
  v_fma_f32 v86, v86, v122, v154
  v_fma_f32 v87, v87, v123, v155
  v_cvt_pk_bf16_f32 v32, v80, v81
  v_mfma_f32_16x16x32_bf16 v[96:99], v[40:43], v[112:115], 0
  v_cvt_pk_bf16_f32 v33, v82, v83
  v_cvt_pk_bf16_f32 v34, v84, v85
  v_cvt_pk_bf16_f32 v35, v86, v87
  v_and_b32 v144, v32, v10
  v_mfma_f32_16x16x32_bf16 v[100:103], v[40:43], v[116:119], 0
  v_and_b32 v145, v33, v10
  v_and_b32 v146, v34, v10
  v_and_b32 v147, v35, v10
  v_mul_f32 v152, v88, v124
  v_mfma_f32_16x16x32_bf16 v[80:83], v[128:131], v[32:35], 0
  v_mul_f32 v153, v89, v125
  v_mul_f32 v154, v90, v126
  v_mul_f32 v155, v91, v127
  v_mul_f32 v88, v88, v120
  v_mfma_f32_16x16x32_bf16 v[84:87], v[132:135], v[32:35], 0
  v_mul_f32 v89, v89, v121
  v_mul_f32 v90, v90, v122
  v_mul_f32 v91, v91, v123
  v_fma_f32 v88, -v92, v124, v88
  v_mfma_f32_16x16x32_bf16 v[80:83], v[136:139], v[144:147], v[80:83]
  v_fma_f32 v89, -v93, v125, v89
  v_fma_f32 v90, -v94, v126, v90
  v_fma_f32 v91, -v95, v127, v91
  v_fma_f32 v92, v92, v120, v152
  v_mfma_f32_16x16x32_bf16 v[84:87], v[140:143], v[144:147], v[84:87]
  v_fma_f32 v93, v93, v121, v153
  v_fma_f32 v94, v94, v122, v154
  v_fma_f32 v95, v95, v123, v155
  v_cvt_pk_bf16_f32 v36, v88, v89
  v_mfma_f32_16x16x32_bf16 v[104:107], v[44:47], v[112:115], 0
  v_cvt_pk_bf16_f32 v37, v90, v91
  v_cvt_pk_bf16_f32 v38, v92, v93
  v_cvt_pk_bf16_f32 v39, v94, v95
  v_and_b32 v148, v36, v10
  v_mfma_f32_16x16x32_bf16 v[108:111], v[44:47], v[116:119], 0
  v_and_b32 v149, v37, v10
  v_and_b32 v150, v38, v10
  v_and_b32 v151, v39, v10
  v_mul_f32 v152, v96, v124
  v_mfma_f32_16x16x32_bf16 v[88:91], v[128:131], v[36:39], 0
  v_mul_f32 v153, v97, v125
  v_mul_f32 v154, v98, v126
  v_mul_f32 v155, v99, v127
  v_mul_f32 v96, v96, v120
  v_mfma_f32_16x16x32_bf16 v[92:95], v[132:135], v[36:39], 0
  v_mul_f32 v97, v97, v121
  v_mul_f32 v98, v98, v122
  v_mul_f32 v99, v99, v123
  v_fma_f32 v96, -v100, v124, v96
  v_mfma_f32_16x16x32_bf16 v[88:91], v[136:139], v[148:151], v[88:91]
  v_fma_f32 v97, -v101, v125, v97
  v_fma_f32 v98, -v102, v126, v98
  v_fma_f32 v99, -v103, v127, v99
  v_fma_f32 v100, v100, v120, v152
  v_mfma_f32_16x16x32_bf16 v[92:95], v[140:143], v[148:151], v[92:95]
  v_fma_f32 v101, v101, v121, v153
  v_fma_f32 v102, v102, v122, v154
  v_fma_f32 v103, v103, v123, v155
  v_cvt_pk_bf16_f32 v40, v96, v97
  v_cvt_pk_bf16_f32 v41, v98, v99
  v_cvt_pk_bf16_f32 v42, v100, v101
  v_cvt_pk_bf16_f32 v43, v102, v103
  v_and_b32 v144, v40, v10
  v_and_b32 v145, v41, v10
  v_and_b32 v146, v42, v10
  v_and_b32 v147, v43, v10
  v_mul_f32 v152, v104, v124
  v_mfma_f32_16x16x32_bf16 v[96:99], v[128:131], v[40:43], 0
  v_mul_f32 v153, v105, v125
  v_mul_f32 v154, v106, v126
  v_mul_f32 v155, v107, v127
  v_mul_f32 v104, v104, v120
  v_mfma_f32_16x16x32_bf16 v[100:103], v[132:135], v[40:43], 0
  v_mul_f32 v105, v105, v121
  v_mul_f32 v106, v106, v122
  v_mul_f32 v107, v107, v123
  v_fma_f32 v104, -v108, v124, v104
  v_mfma_f32_16x16x32_bf16 v[96:99], v[136:139], v[144:147], v[96:99]
  v_fma_f32 v105, -v109, v125, v105
  v_fma_f32 v106, -v110, v126, v106
  v_fma_f32 v107, -v111, v127, v107
  v_fma_f32 v108, v108, v120, v152
  v_mfma_f32_16x16x32_bf16 v[100:103], v[140:143], v[144:147], v[100:103]
  v_fma_f32 v109, v109, v121, v153
  v_fma_f32 v110, v110, v122, v154
  v_fma_f32 v111, v111, v123, v155
  v_cvt_pk_bf16_f32 v44, v104, v105
  v_cvt_pk_bf16_f32 v45, v106, v107
  v_cvt_pk_bf16_f32 v46, v108, v109
  v_cvt_pk_bf16_f32 v47, v110, v111
  v_and_b32 v148, v44, v10
  v_and_b32 v149, v45, v10
  v_and_b32 v150, v46, v10
  v_and_b32 v151, v47, v10
  v_mfma_f32_16x16x32_bf16 v[104:107], v[128:131], v[44:47], 0
  v_mfma_f32_16x16x32_bf16 v[108:111], v[132:135], v[44:47], 0
  v_mfma_f32_16x16x32_bf16 v[104:107], v[136:139], v[148:151], v[104:107]
  v_mfma_f32_16x16x32_bf16 v[108:111], v[140:143], v[148:151], v[108:111]
  s_cmp_eq_u32 s29, 2
  s_cbranch_scc1 P1_OUTG
  v_cvt_pk_bf16_f32 v16, v48, v56
  v_cvt_pk_bf16_f32 v20, v52, v60
  v_cvt_pk_bf16_f32 v24, v49, v57
  v_cvt_pk_bf16_f32 v28, v53, v61
  v_cvt_pk_bf16_f32 v32, v50, v58
  v_cvt_pk_bf16_f32 v36, v54, v62
  v_cvt_pk_bf16_f32 v40, v51, v59
  v_cvt_pk_bf16_f32 v44, v55, v63
  v_cvt_pk_bf16_f32 v17, v64, v72
  v_cvt_pk_bf16_f32 v21, v68, v76
  v_cvt_pk_bf16_f32 v25, v65, v73
  v_cvt_pk_bf16_f32 v29, v69, v77
  v_cvt_pk_bf16_f32 v33, v66, v74
  v_cvt_pk_bf16_f32 v37, v70, v78
  v_cvt_pk_bf16_f32 v41, v67, v75
  v_cvt_pk_bf16_f32 v45, v71, v79
  v_cvt_pk_bf16_f32 v18, v80, v88
  v_cvt_pk_bf16_f32 v22, v84, v92
  v_cvt_pk_bf16_f32 v26, v81, v89
  v_cvt_pk_bf16_f32 v30, v85, v93
  v_cvt_pk_bf16_f32 v34, v82, v90
  v_cvt_pk_bf16_f32 v38, v86, v94
  v_cvt_pk_bf16_f32 v42, v83, v91
  v_cvt_pk_bf16_f32 v46, v87, v95
  v_cvt_pk_bf16_f32 v19, v96, v104
  ds_write_b128 v13, v[16:19] offset:0
  v_cvt_pk_bf16_f32 v23, v100, v108
  ds_write_b128 v13, v[20:23] offset:16
  v_cvt_pk_bf16_f32 v27, v97, v105
  ds_write_b128 v13, v[24:27] offset:32
  v_cvt_pk_bf16_f32 v31, v101, v109
  ds_write_b128 v13, v[28:31] offset:48
  v_cvt_pk_bf16_f32 v35, v98, v106
  ds_write_b128 v13, v[32:35] offset:64
  v_cvt_pk_bf16_f32 v39, v102, v110
  ds_write_b128 v13, v[36:39] offset:80
  v_cvt_pk_bf16_f32 v43, v99, v107
  ds_write_b128 v13, v[40:43] offset:96
  v_cvt_pk_bf16_f32 v47, v103, v111
  ds_write_b128 v13, v[44:47] offset:112
  s_waitcnt vmcnt(0) lgkmcnt(0)
  v_readfirstlane_b32 s0, v4
  s_cmp_eq_u32 s2, 255
  s_cselect_b32 s45, 3, s45
  s_cmp_eq_u32 s54, 15
  s_cbranch_scc1 P1_FL
  s_bitcmp1_b32 s45, 0
  s_cbranch_scc0 G1_NODa
  v_lshrrev_b32 v8, 2, v2
  v_lshlrev_b32 v8, 10, v8
  v_and_b32 v9, 3, v2
  v_lshl_add_u32 v8, v9, 4, v8
  v_lshrrev_b32 v9, 1, v3
  v_lshl_add_u32 v8, v9, 6, v8
  v_and_b32 v9, 1, v3
  v_lshl_add_u32 v8, v9, 3, v8
  s_lshl_b32 s4, s3, 13
  v_add_u32 v8, s4, v8
  s_add_u32 s5, s46, 26476544
G1_DTa:
  ds_read_b64_tr_b16 v[16:17], v8 offset:0
  ds_read_b64_tr_b16 v[18:19], v8 offset:4096
  ds_read_b64_tr_b16 v[20:21], v8 offset:128
  ds_read_b64_tr_b16 v[22:23], v8 offset:4224
  ds_read_b64_tr_b16 v[24:25], v8 offset:256
  ds_read_b64_tr_b16 v[26:27], v8 offset:4352
  ds_read_b64_tr_b16 v[28:29], v8 offset:384
  ds_read_b64_tr_b16 v[30:31], v8 offset:4480
  ds_read_b64_tr_b16 v[32:33], v8 offset:512
  ds_read_b64_tr_b16 v[34:35], v8 offset:4608
  ds_read_b64_tr_b16 v[36:37], v8 offset:640
  ds_read_b64_tr_b16 v[38:39], v8 offset:4736
  s_waitcnt lgkmcnt(8)
  ds_read_b64_tr_b16 v[40:41], v8 offset:768
  ds_read_b64_tr_b16 v[42:43], v8 offset:4864
  ds_read_b64_tr_b16 v[44:45], v8 offset:896
  ds_read_b64_tr_b16 v[46:47], v8 offset:4992
  s_waitcnt lgkmcnt(0)
  buffer_store_dwordx4 v[16:19], v1, s[8:11], s5 offen sc1
  s_add_u32 s5, s5, 176128
  buffer_store_dwordx4 v[20:23], v1, s[8:11], s5 offen sc1
  s_add_u32 s5, s5, 176128
  buffer_store_dwordx4 v[24:27], v1, s[8:11], s5 offen sc1
  s_add_u32 s5, s5, 176128
  buffer_store_dwordx4 v[28:31], v1, s[8:11], s5 offen sc1
  s_add_u32 s5, s5, 176128
  buffer_store_dwordx4 v[32:35], v1, s[8:11], s5 offen sc1
  s_add_u32 s5, s5, 176128
  buffer_store_dwordx4 v[36:39], v1, s[8:11], s5 offen sc1
  s_add_u32 s5, s5, 176128
  buffer_store_dwordx4 v[40:43], v1, s[8:11], s5 offen sc1
  s_add_u32 s5, s5, 176128
  buffer_store_dwordx4 v[44:47], v1, s[8:11], s5 offen sc1
  s_cmp_eq_u32 s45, 3
  s_mov_b32 s45, 1
  s_cbranch_scc0 G1_NODa
  v_add_u32 v8, 98304, v8
  s_lshl_b32 s5, s1, 10
  s_add_u32 s5, s5, 26476544
  s_branch G1_DTa
G1_NODa:
  s_mov_b32 s45, 0
  s_branch P1_FL
P1_OUTG:
  v_cvt_pk_bf16_f32 v16, v48, v52
  v_cvt_pk_bf16_f32 v17, v49, v53
  v_cvt_pk_bf16_f32 v18, v50, v54
  v_cvt_pk_bf16_f32 v19, v51, v55
  v_and_b32 v16, v16, v12
  ds_write_b128 v13, v[16:19] offset:0
  v_cvt_pk_bf16_f32 v20, v56, v60
  v_cvt_pk_bf16_f32 v21, v57, v61
  v_cvt_pk_bf16_f32 v22, v58, v62
  v_cvt_pk_bf16_f32 v23, v59, v63
  v_and_b32 v20, v20, v12
  ds_write_b128 v13, v[20:23] offset:16
  v_cvt_pk_bf16_f32 v24, v64, v68
  v_cvt_pk_bf16_f32 v25, v65, v69
  v_cvt_pk_bf16_f32 v26, v66, v70
  v_cvt_pk_bf16_f32 v27, v67, v71
  v_and_b32 v24, v24, v12
  ds_write_b128 v13, v[24:27] offset:32
  v_cvt_pk_bf16_f32 v28, v72, v76
  v_cvt_pk_bf16_f32 v29, v73, v77
  v_cvt_pk_bf16_f32 v30, v74, v78
  v_cvt_pk_bf16_f32 v31, v75, v79
  v_and_b32 v28, v28, v12
  ds_write_b128 v13, v[28:31] offset:48
  v_cvt_pk_bf16_f32 v32, v80, v84
  v_cvt_pk_bf16_f32 v33, v81, v85
  v_cvt_pk_bf16_f32 v34, v82, v86
  v_cvt_pk_bf16_f32 v35, v83, v87
  v_and_b32 v32, v32, v12
  ds_write_b128 v13, v[32:35] offset:64
  v_cvt_pk_bf16_f32 v36, v88, v92
  v_cvt_pk_bf16_f32 v37, v89, v93
  v_cvt_pk_bf16_f32 v38, v90, v94
  v_cvt_pk_bf16_f32 v39, v91, v95
  v_and_b32 v36, v36, v12
  ds_write_b128 v13, v[36:39] offset:80
  v_cvt_pk_bf16_f32 v40, v96, v100
  v_cvt_pk_bf16_f32 v41, v97, v101
  v_cvt_pk_bf16_f32 v42, v98, v102
  v_cvt_pk_bf16_f32 v43, v99, v103
  v_and_b32 v40, v40, v12
  ds_write_b128 v13, v[40:43] offset:96
  v_cvt_pk_bf16_f32 v44, v104, v108
Lstub1:
  s_cbranch_execz Lret1_782
  v_cvt_pk_bf16_f32 v45, v105, v109
  v_cvt_pk_bf16_f32 v46, v106, v110
  v_cvt_pk_bf16_f32 v47, v107, v111
  v_and_b32 v44, v44, v12
  ds_write_b128 v13, v[44:47] offset:112
  s_waitcnt vmcnt(0)
  v_readfirstlane_b32 s0, v4
  ds_read_b128 v[16:19], v14 offset:0
  ds_read_b128 v[20:23], v14 offset:1152
  ds_read_b128 v[24:27], v14 offset:2304
  ds_read_b128 v[28:31], v14 offset:3456
  ds_read_b128 v[32:35], v14 offset:4608
  ds_read_b128 v[36:39], v14 offset:5760
  ds_read_b128 v[40:43], v14 offset:6912
  ds_read_b128 v[44:47], v14 offset:8064
  s_waitcnt lgkmcnt(7)
  buffer_store_dwordx4 v[16:19], v15, s[8:11], s47 offen sc1
  s_add_u32 s47, s47, s48
  s_waitcnt lgkmcnt(6)
  buffer_store_dwordx4 v[20:23], v15, s[8:11], s47 offen sc1
  s_add_u32 s47, s47, s48
  s_waitcnt lgkmcnt(5)
  buffer_store_dwordx4 v[24:27], v15, s[8:11], s47 offen sc1
  s_add_u32 s47, s47, s48
  s_waitcnt lgkmcnt(4)
  buffer_store_dwordx4 v[28:31], v15, s[8:11], s47 offen sc1
  s_add_u32 s47, s47, s48
  s_waitcnt lgkmcnt(3)
  buffer_store_dwordx4 v[32:35], v15, s[8:11], s47 offen sc1
  s_add_u32 s47, s47, s48
  s_waitcnt lgkmcnt(2)
  buffer_store_dwordx4 v[36:39], v15, s[8:11], s47 offen sc1
  s_add_u32 s47, s47, s48
  s_waitcnt lgkmcnt(1)
  buffer_store_dwordx4 v[40:43], v15, s[8:11], s47 offen sc1
  s_add_u32 s47, s47, s48
  s_waitcnt lgkmcnt(0)
  buffer_store_dwordx4 v[44:47], v15, s[8:11], s47 offen sc1
  s_mov_b32 s47, 92274688
  s_mov_b32 s48, 0
P1_FL:
  s_cmp_ge_u32 s0, 9
  s_cbranch_scc1 P1_END
  s_mov_b32 s7, 0x100000
Lpoll_5:
  buffer_load_dword v4, v5, s[24:27], 0 offen sc1
  s_sub_u32 s7, s7, 1
  s_cbranch_scc1 Ldone_6
  s_waitcnt vmcnt(0)
  v_cmp_gt_u32 vcc, 9, v4
  s_cbranch_vccnz Lpoll_5
Ldone_6:
P1_END:
  s_lshl_b32 s4, s3, 13
  s_add_u32 s4, s4, 131072
  v_add_u32 v4, s4, v1
  ds_read_b128 v[176:179], v4 offset:0
  ds_read_b128 v[184:187], v4 offset:1024
  ds_read_b128 v[224:227], v4 offset:2048
  ds_read_b128 v[232:235], v4 offset:3072
  ds_read_b128 v[156:159], v4 offset:4096
  ds_read_b128 v[160:163], v4 offset:5120
  ds_read_b128 v[164:167], v4 offset:6144
  ds_read_b128 v[168:171], v4 offset:7168
  v_and_b32 v5, 1, v0
  v_mul_lo_u32 v5, v5, s18
  s_brev_b32 s4, 1
  s_waitcnt lgkmcnt(4)
  v_xor_b32 v180, v5, v176
  v_xor_b32 v188, v5, v184
  v_xor_b32 v181, v5, v177
  v_xor_b32 v189, v5, v185
  v_xor_b32 v182, v5, v178
  v_xor_b32 v190, v5, v186
  v_xor_b32 v183, v5, v179
  v_xor_b32 v191, v5, v187
  v_xor_b32 v228, s4, v224
  v_xor_b32 v236, s4, v232
  v_xor_b32 v229, s4, v225
  v_xor_b32 v237, s4, v233
  v_xor_b32 v230, s4, v226
  v_xor_b32 v238, s4, v234
  v_xor_b32 v231, s4, v227
  v_xor_b32 v239, s4, v235
  v_xor_b32 v240, s18, v184
  v_xor_b32 v241, s18, v185
  v_xor_b32 v242, s18, v186
  v_xor_b32 v243, s18, v187
  v_xor_b32 v244, s18, v188
  v_xor_b32 v245, s18, v189
  v_xor_b32 v246, s18, v190
  v_xor_b32 v247, s18, v191
  v_xor_b32 v248, s18, v232
  v_xor_b32 v249, s18, v233
  v_xor_b32 v250, s18, v234
  v_xor_b32 v251, s18, v235
  v_xor_b32 v252, s18, v236
  v_xor_b32 v253, s18, v237
  v_xor_b32 v254, s18, v238
  v_xor_b32 v255, s18, v239
  s_waitcnt lgkmcnt(0)
  v_cvt_f32_f16 v192, v156
  v_cvt_f32_f16_sdwa v196, v156 dst_sel:DWORD dst_unused:UNUSED_PAD src0_sel:WORD_1
  v_cvt_f32_f16 v193, v157
  v_cvt_f32_f16_sdwa v197, v157 dst_sel:DWORD dst_unused:UNUSED_PAD src0_sel:WORD_1
  v_cvt_f32_f16 v194, v158
  v_cvt_f32_f16_sdwa v198, v158 dst_sel:DWORD dst_unused:UNUSED_PAD src0_sel:WORD_1
  v_cvt_f32_f16 v195, v159
  v_cvt_f32_f16_sdwa v199, v159 dst_sel:DWORD dst_unused:UNUSED_PAD src0_sel:WORD_1
  v_cvt_f32_f16 v200, v160
  v_cvt_f32_f16_sdwa v204, v160 dst_sel:DWORD dst_unused:UNUSED_PAD src0_sel:WORD_1
  v_cvt_f32_f16 v201, v161
  v_cvt_f32_f16_sdwa v205, v161 dst_sel:DWORD dst_unused:UNUSED_PAD src0_sel:WORD_1
  v_cvt_f32_f16 v202, v162
  v_cvt_f32_f16_sdwa v206, v162 dst_sel:DWORD dst_unused:UNUSED_PAD src0_sel:WORD_1
  v_cvt_f32_f16 v203, v163
  v_cvt_f32_f16_sdwa v207, v163 dst_sel:DWORD dst_unused:UNUSED_PAD src0_sel:WORD_1
  v_cvt_f32_f16 v208, v164
  v_cvt_f32_f16_sdwa v212, v164 dst_sel:DWORD dst_unused:UNUSED_PAD src0_sel:WORD_1
  v_cvt_f32_f16 v209, v165
  v_cvt_f32_f16_sdwa v213, v165 dst_sel:DWORD dst_unused:UNUSED_PAD src0_sel:WORD_1
  v_cvt_f32_f16 v210, v166
  v_cvt_f32_f16_sdwa v214, v166 dst_sel:DWORD dst_unused:UNUSED_PAD src0_sel:WORD_1
  v_cvt_f32_f16 v211, v167
  v_cvt_f32_f16_sdwa v215, v167 dst_sel:DWORD dst_unused:UNUSED_PAD src0_sel:WORD_1
  v_cvt_f32_f16 v216, v168
  v_cvt_f32_f16_sdwa v220, v168 dst_sel:DWORD dst_unused:UNUSED_PAD src0_sel:WORD_1
  v_cvt_f32_f16 v217, v169
  v_cvt_f32_f16_sdwa v221, v169 dst_sel:DWORD dst_unused:UNUSED_PAD src0_sel:WORD_1
  v_cvt_f32_f16 v218, v170
  v_cvt_f32_f16_sdwa v222, v170 dst_sel:DWORD dst_unused:UNUSED_PAD src0_sel:WORD_1
  v_cvt_f32_f16 v219, v171
  v_cvt_f32_f16_sdwa v223, v171 dst_sel:DWORD dst_unused:UNUSED_PAD src0_sel:WORD_1
P1_END2:
  v_and_b32 v12, 0x39, v0
  v_bfe_u32 v8, v0, 1, 1
  v_lshl_add_u32 v12, v8, 2, v12
  v_bfe_u32 v8, v0, 2, 1
  v_lshl_add_u32 v12, v8, 1, v12
  v_lshlrev_b32 v12, 4, v12
  v_lshrrev_b32 v8, 1, v3
  v_lshlrev_b32 v9, 17, v8
  v_and_b32 v10, 1, v3
  v_lshl_add_u32 v9, v10, 10, v9
  v_lshrrev_b32 v11, 2, v2
  v_lshl_add_u32 v9, v11, 8, v9
  v_and_b32 v11, 3, v2
  v_lshl_add_u32 v9, v11, 4, v9
  v_lshlrev_b32 v10, 3, v10
  v_lshl_add_u32 v10, v8, 8, v10
  v_lshl_add_u32 v10, v2, 4, v10
  v_add_u32 v10, s44, v10
  s_cmp_lg_u32 s29, 2
  s_cbranch_scc1 P1_E4
  v_mov_b32 v4, 1
  v_mov_b32 v5, 0
  s_waitcnt vmcnt(0)
  s_barrier
  s_mov_b64 exec, 1
  buffer_atomic_add v4, v5, s[8:11], s49 offen sc1
  s_mov_b64 exec, -1
P1_E4:
  s_add_u32 s24, s43, 0
  s_add_u32 s25, s43, 1048576
  s_add_u32 s26, s43, 2097152
  s_add_u32 s27, s43, 3145728
  s_lshl_b32 s6, s3, 10
  s_add_u32 s28, s6, 33554432
  s_add_u32 s29, s28, 4096
  v_mov_b32 v7, 1
  v_mov_b32 v13, 0
  s_mul_i32 s31, s54, 4224
  s_add_u32 s31, s31, 38592512
  s_cmp_eq_u32 s54, 14
  s_cselect_b32 s30, 2, 6
  s_cmp_eq_u32 s54, 15
  s_cselect_b32 s30, 0, s30
  s_cmp_lg_u32 s3, 0
  s_cbranch_scc1 Lwait_7
  v_mul_u32_u24 v5, 4224, v0
  s_mov_b64 exec, 1
  s_and_b32 s4, s2, 7
  s_mul_i32 s4, s4, 4224
  s_add_u32 s4, s4, 36835328
  s_mov_b32 s7, 0x100000
Lpoll_8:
  buffer_load_dword v4, v5, s[8:11], s4 offen sc1
  s_sub_u32 s7, s7, 1
  s_cbranch_scc1 Ldone_9
  s_waitcnt vmcnt(0)
  v_cmp_gt_u32 vcc, 8, v4
  s_cbranch_vccz Ldone_9
  s_sleep 1
  s_branch Lpoll_8
Ldone_9:
  s_mov_b64 exec, -1
Lwait_7:
  s_barrier
  buffer_load_dwordx4 v[56:59], v1, s[8:11], s28 offen sc1
  buffer_load_dwordx4 v[60:63], v1, s[8:11], s29 offen sc1
  buffer_load_dwordx4 v[48:51], v9, s[8:11], s24 offen sc1
  buffer_load_dwordx4 v[52:55], v9, s[8:11], s25 offen sc1
  buffer_load_dword v4, v13, s[8:11], s31 offen sc1
  buffer_load_dwordx4 v[112:115], v1, s[8:11], s39 offen offset:0 sc1
  buffer_load_dwordx4 v[116:119], v1, s[8:11], s39 offen offset:1024 sc1
  ds_read_b128 v[120:123], v14 offset:0
  ds_read_b128 v[124:127], v14 offset:1152
  ds_read_b128 v[128:131], v14 offset:2304
  ds_read_b128 v[132:135], v14 offset:3456
  ds_read_b128 v[136:139], v14 offset:4608
  ds_read_b128 v[140:143], v14 offset:5760
  ds_read_b128 v[144:147], v14 offset:6912
  ds_read_b128 v[148:151], v14 offset:8064
  s_waitcnt lgkmcnt(7)
  buffer_store_dwordx4 v[120:123], v15, s[8:11], s47 offen sc1
  s_add_u32 s47, s47, s48
  s_waitcnt lgkmcnt(6)
  buffer_store_dwordx4 v[124:127], v15, s[8:11], s47 offen sc1
  s_add_u32 s47, s47, s48
  s_waitcnt lgkmcnt(5)
  buffer_store_dwordx4 v[128:131], v15, s[8:11], s47 offen sc1
  s_add_u32 s47, s47, s48
  s_waitcnt lgkmcnt(4)
  buffer_store_dwordx4 v[132:135], v15, s[8:11], s47 offen sc1
  s_add_u32 s47, s47, s48
  s_waitcnt lgkmcnt(3)
  buffer_store_dwordx4 v[136:139], v15, s[8:11], s47 offen sc1
  s_add_u32 s47, s47, s48
  s_waitcnt lgkmcnt(2)
  buffer_store_dwordx4 v[140:143], v15, s[8:11], s47 offen sc1
  s_add_u32 s47, s47, s48
  s_waitcnt lgkmcnt(1)
  buffer_store_dwordx4 v[144:147], v15, s[8:11], s47 offen sc1
  s_add_u32 s47, s47, s48
  s_waitcnt lgkmcnt(0)
  buffer_store_dwordx4 v[148:151], v15, s[8:11], s47 offen sc1
  s_waitcnt vmcnt(12)
  v_lshlrev_b32 v32, 16, v48
  v_and_b32 v33, s19, v48
  v_lshlrev_b32 v34, 16, v49
  v_and_b32 v35, s19, v49
  v_lshlrev_b32 v36, 16, v50
  v_and_b32 v37, s19, v50
  v_lshlrev_b32 v38, 16, v51
  v_and_b32 v39, s19, v51
  v_pk_mul_f32 v[80:81], v[32:33], v[56:57]
  v_pk_mul_f32 v[82:83], v[34:35], v[58:59]
  v_pk_mul_f32 v[84:85], v[36:37], v[56:57]
  v_pk_mul_f32 v[86:87], v[38:39], v[58:59]
  v_cvt_pk_bf16_f32 v96, v80, v81
  v_cvt_pk_bf16_f32 v97, v82, v83
  ds_write_b64 v10, v[96:97] offset:0
  v_cvt_pk_bf16_f32 v98, v84, v85
  v_cvt_pk_bf16_f32 v99, v86, v87
  v_and_b32 v98, s51, v98
  v_and_b32 v99, s51, v99
  ds_write_b64 v10, v[98:99] offset:1024
  s_waitcnt vmcnt(11)
  v_lshlrev_b32 v40, 16, v52
  v_and_b32 v41, s19, v52
  v_lshlrev_b32 v42, 16, v53
  v_and_b32 v43, s19, v53
  v_lshlrev_b32 v44, 16, v54
  v_and_b32 v45, s19, v54
  v_lshlrev_b32 v46, 16, v55
  v_and_b32 v47, s19, v55
  v_pk_mul_f32 v[88:89], v[40:41], v[60:61]
  v_pk_mul_f32 v[90:91], v[42:43], v[62:63]
  v_pk_mul_f32 v[92:93], v[44:45], v[60:61]
  v_pk_mul_f32 v[94:95], v[46:47], v[62:63]
  v_cvt_pk_bf16_f32 v100, v88, v89
  v_cvt_pk_bf16_f32 v101, v90, v91
  ds_write_b64 v10, v[100:101] offset:4096
  v_cvt_pk_bf16_f32 v102, v92, v93
  v_cvt_pk_bf16_f32 v103, v94, v95
  v_and_b32 v102, s51, v102
  v_and_b32 v103, s51, v103
  ds_write_b64 v10, v[102:103] offset:5120
  s_waitcnt lgkmcnt(0)
  s_barrier
  ds_read_b128 v[48:51], v1 offset:32768
  ds_read_b128 v[52:55], v1 offset:33792
  ds_read_b128 v[56:59], v1 offset:34816
  ds_read_b128 v[60:63], v1 offset:35840
  ds_read_b128 v[64:67], v1 offset:36864
  ds_read_b128 v[68:71], v1 offset:37888
  ds_read_b128 v[72:75], v1 offset:38912
  ds_read_b128 v[76:79], v1 offset:39936
  s_waitcnt vmcnt(8)
  v_cmp_gt_u32 vcc, s30, v4
  s_cbranch_vccnz C0_SP
C0_BK:
  buffer_load_dwordx4 a[0:3], v1, s[8:11], s88 offen offset:0 sc1
  buffer_load_dwordx4 a[4:7], v1, s[8:11], s89 offen offset:0 sc1
  buffer_load_dwordx4 a[8:11], v12, s[8:11], s90 offen offset:0 sc1
  buffer_load_dwordx4 a[12:15], v1, s[8:11], s88 offen offset:1024 sc1
  buffer_load_dwordx4 a[16:19], v1, s[8:11], s89 offen offset:1024 sc1
  buffer_load_dwordx4 a[20:23], v12, s[8:11], s90 offen offset:1024 sc1
  s_waitcnt lgkmcnt(6)
  v_lshlrev_b32 v16, 16, v112
  v_and_b32 v20, s19, v112
  v_mfma_f32_16x16x32_bf16 v[80:83], v[48:51], v[176:179], 0
  v_lshlrev_b32 v17, 16, v113
  v_and_b32 v21, s19, v113
  v_mfma_f32_16x16x32_bf16 v[84:87], v[48:51], v[184:187], 0
  v_lshlrev_b32 v18, 16, v114
  v_and_b32 v22, s19, v114
  v_mfma_f32_16x16x32_bf16 v[80:83], v[52:55], v[240:243], v[80:83]
  v_lshlrev_b32 v19, 16, v115
  v_and_b32 v23, s19, v115
  v_mfma_f32_16x16x32_bf16 v[84:87], v[52:55], v[176:179], v[84:87]
  v_lshlrev_b32 v24, 16, v116
  v_and_b32 v28, s19, v116
  s_waitcnt lgkmcnt(4)
  v_lshlrev_b32 v25, 16, v117
  v_and_b32 v29, s19, v117
  v_mfma_f32_16x16x32_bf16 v[80:83], v[56:59], v[180:183], v[80:83]
  v_lshlrev_b32 v26, 16, v118
  v_and_b32 v30, s19, v118
  v_mfma_f32_16x16x32_bf16 v[84:87], v[56:59], v[188:191], v[84:87]
  v_lshlrev_b32 v27, 16, v119
  v_and_b32 v31, s19, v119
  v_mfma_f32_16x16x32_bf16 v[80:83], v[60:63], v[244:247], v[80:83]
  v_mfma_f32_16x16x32_bf16 v[84:87], v[60:63], v[180:183], v[84:87]
  s_waitcnt lgkmcnt(2)
  v_mfma_f32_16x16x32_bf16 v[88:91], v[64:67], v[176:179], 0
  v_mfma_f32_16x16x32_bf16 v[92:95], v[64:67], v[184:187], 0
  v_mfma_f32_16x16x32_bf16 v[88:91], v[68:71], v[240:243], v[88:91]
  s_nop 2
  v_mul_f32 v104, v80, v196
  v_mul_f32 v105, v81, v197
  v_mfma_f32_16x16x32_bf16 v[92:95], v[68:71], v[176:179], v[92:95]
  v_mul_f32 v106, v82, v198
  v_mul_f32 v107, v83, v199
  s_waitcnt lgkmcnt(0)
  v_mul_f32 v80, v80, v192
  v_mul_f32 v81, v81, v193
  v_mfma_f32_16x16x32_bf16 v[88:91], v[72:75], v[180:183], v[88:91]
  v_mul_f32 v82, v82, v194
  v_mul_f32 v83, v83, v195
  v_mfma_f32_16x16x32_bf16 v[92:95], v[72:75], v[188:191], v[92:95]
  v_fma_f32 v80, -v84, v196, v80
  v_fma_f32 v81, -v85, v197, v81
  v_mfma_f32_16x16x32_bf16 v[88:91], v[76:79], v[244:247], v[88:91]
  v_fma_f32 v82, -v86, v198, v82
  v_fma_f32 v83, -v87, v199, v83
  v_mfma_f32_16x16x32_bf16 v[92:95], v[76:79], v[180:183], v[92:95]
  v_fma_f32 v84, v84, v192, v104
  v_fma_f32 v85, v85, v193, v105
  v_fma_f32 v86, v86, v194, v106
  v_fma_f32 v87, v87, v195, v107
  v_cvt_pk_bf16_f32 v96, v80, v81
  v_cvt_pk_bf16_f32 v97, v82, v83
  v_cvt_pk_bf16_f32 v100, v84, v85
  v_cvt_pk_bf16_f32 v101, v86, v87
  v_pk_mul_f32 v[108:109], v[88:89], v[204:205]
  v_pk_mul_f32 v[110:111], v[90:91], v[206:207]
  v_pk_mul_f32 v[88:89], v[88:89], v[200:201]
  v_pk_mul_f32 v[90:91], v[90:91], v[202:203]
  v_pk_fma_f32 v[88:89], v[92:93], v[204:205], v[88:89] neg_lo:[1,0,0] neg_hi:[1,0,0]
  v_pk_fma_f32 v[90:91], v[94:95], v[206:207], v[90:91] neg_lo:[1,0,0] neg_hi:[1,0,0]
  v_pk_fma_f32 v[92:93], v[92:93], v[200:201], v[108:109]
  v_pk_fma_f32 v[94:95], v[94:95], v[202:203], v[110:111]
  v_cvt_pk_bf16_f32 v98, v88, v89
  v_cvt_pk_bf16_f32 v99, v90, v91
  v_cvt_pk_bf16_f32 v102, v92, v93
  v_cvt_pk_bf16_f32 v103, v94, v95
  v_mfma_f32_16x16x32_bf16 v[80:83], v[224:227], v[96:99], 0
  buffer_load_dwordx4 a[24:27], v1, s[8:11], s88 offen offset:2048 sc1
  v_mfma_f32_16x16x32_bf16 v[84:87], v[232:235], v[96:99], 0
  buffer_load_dwordx4 a[28:31], v1, s[8:11], s89 offen offset:2048 sc1
  v_mfma_f32_16x16x32_bf16 v[80:83], v[248:251], v[100:103], v[80:83]
  buffer_load_dwordx4 a[32:35], v12, s[8:11], s90 offen offset:2048 sc1
  v_mfma_f32_16x16x32_bf16 v[84:87], v[224:227], v[100:103], v[84:87]
  buffer_load_dwordx4 a[36:39], v1, s[8:11], s88 offen offset:3072 sc1
  v_mfma_f32_16x16x32_bf16 v[88:91], v[228:231], v[96:99], 0
  v_mfma_f32_16x16x32_bf16 v[92:95], v[236:239], v[96:99], 0
  v_mfma_f32_16x16x32_bf16 v[88:91], v[252:255], v[100:103], v[88:91]
  v_mfma_f32_16x16x32_bf16 v[92:95], v[228:231], v[100:103], v[92:95]
  s_nop 0
  v_pk_mul_f32 v[104:105], v[80:81], v[20:21]
  v_pk_mul_f32 v[106:107], v[82:83], v[22:23]
  v_pk_mul_f32 v[80:81], v[80:81], v[16:17]
  v_pk_mul_f32 v[82:83], v[82:83], v[18:19]
  v_pk_fma_f32 v[80:81], v[84:85], v[20:21], v[80:81] neg_lo:[1,0,0] neg_hi:[1,0,0]
  v_pk_fma_f32 v[82:83], v[86:87], v[22:23], v[82:83] neg_lo:[1,0,0] neg_hi:[1,0,0]
  v_pk_fma_f32 v[84:85], v[84:85], v[16:17], v[104:105]
  v_pk_fma_f32 v[86:87], v[86:87], v[18:19], v[106:107]
  v_cvt_pk_bf16_f32 v96, v80, v81
  v_cvt_pk_bf16_f32 v97, v82, v83
  v_cvt_pk_bf16_f32 v100, v84, v85
  v_cvt_pk_bf16_f32 v101, v86, v87
  v_pk_mul_f32 v[108:109], v[88:89], v[28:29]
  v_pk_mul_f32 v[110:111], v[90:91], v[30:31]
  v_pk_mul_f32 v[88:89], v[88:89], v[24:25]
  v_pk_mul_f32 v[90:91], v[90:91], v[26:27]
  v_pk_fma_f32 v[88:89], v[92:93], v[28:29], v[88:89] neg_lo:[1,0,0] neg_hi:[1,0,0]
  v_pk_fma_f32 v[90:91], v[94:95], v[30:31], v[90:91] neg_lo:[1,0,0] neg_hi:[1,0,0]
  v_pk_fma_f32 v[92:93], v[92:93], v[24:25], v[108:109]
  v_pk_fma_f32 v[94:95], v[94:95], v[26:27], v[110:111]
  v_cvt_pk_bf16_f32 v98, v88, v89
  v_cvt_pk_bf16_f32 v99, v90, v91
  v_cvt_pk_bf16_f32 v102, v92, v93
  v_cvt_pk_bf16_f32 v103, v94, v95
  v_mfma_f32_16x16x32_bf16 v[80:83], v[96:99], v[224:227], 0
  s_add_u32 s88, s88, 4096
  buffer_load_dwordx4 a[40:43], v1, s[8:11], s89 offen offset:3072 sc1
  v_mfma_f32_16x16x32_bf16 v[84:87], v[96:99], v[248:251], 0
  s_add_u32 s89, s89, 4096
  buffer_load_dwordx4 a[44:47], v12, s[8:11], s90 offen offset:3072 sc1
  v_mfma_f32_16x16x32_bf16 v[80:83], v[100:103], v[232:235], v[80:83]
  s_add_u32 s90, s90, 4096
  buffer_load_dwordx4 a[48:51], v1, s[8:11], s88 offen offset:0 sc1
  v_mfma_f32_16x16x32_bf16 v[84:87], v[100:103], v[224:227], v[84:87]
  buffer_load_dwordx4 a[52:55], v1, s[8:11], s89 offen offset:0 sc1
  v_mfma_f32_16x16x32_bf16 v[88:91], v[96:99], v[228:231], 0
  v_mfma_f32_16x16x32_bf16 v[92:95], v[96:99], v[252:255], 0
  v_mfma_f32_16x16x32_bf16 v[88:91], v[100:103], v[236:239], v[88:91]
  v_mfma_f32_16x16x32_bf16 v[92:95], v[100:103], v[228:231], v[92:95]
  v_pk_mul_f32 v[104:105], v[80:81], v[212:213]
  v_pk_mul_f32 v[106:107], v[82:83], v[214:215]
  v_pk_mul_f32 v[80:81], v[80:81], v[208:209]
  v_pk_mul_f32 v[82:83], v[82:83], v[210:211]
  v_pk_fma_f32 v[80:81], v[84:85], v[212:213], v[80:81] neg_lo:[1,0,0] neg_hi:[1,0,0]
  v_pk_fma_f32 v[82:83], v[86:87], v[214:215], v[82:83] neg_lo:[1,0,0] neg_hi:[1,0,0]
  v_pk_fma_f32 v[84:85], v[84:85], v[208:209], v[104:105]
  v_pk_fma_f32 v[86:87], v[86:87], v[210:211], v[106:107]
  v_cvt_pk_bf16_f32 v96, v80, v81
  v_cvt_pk_bf16_f32 v97, v82, v83
  ds_write_b64 v10, v[96:97] offset:8192
  v_cvt_pk_bf16_f32 v98, v84, v85
  v_cvt_pk_bf16_f32 v99, v86, v87
  ds_write_b64 v10, v[98:99] offset:9216
  v_pk_mul_f32 v[108:109], v[88:89], v[220:221]
  v_pk_mul_f32 v[110:111], v[90:91], v[222:223]
  v_pk_mul_f32 v[88:89], v[88:89], v[216:217]
  v_pk_mul_f32 v[90:91], v[90:91], v[218:219]
  v_pk_fma_f32 v[88:89], v[92:93], v[220:221], v[88:89] neg_lo:[1,0,0] neg_hi:[1,0,0]
  v_pk_fma_f32 v[90:91], v[94:95], v[222:223], v[90:91] neg_lo:[1,0,0] neg_hi:[1,0,0]
  v_pk_fma_f32 v[92:93], v[92:93], v[216:217], v[108:109]
  v_pk_fma_f32 v[94:95], v[94:95], v[218:219], v[110:111]
  v_cvt_pk_bf16_f32 v100, v88, v89
  v_cvt_pk_bf16_f32 v101, v90, v91
  ds_write_b64 v10, v[100:101] offset:12288
  v_cvt_pk_bf16_f32 v102, v92, v93
  v_cvt_pk_bf16_f32 v103, v94, v95
  ds_write_b64 v10, v[102:103] offset:13312
  s_waitcnt lgkmcnt(0)
  s_barrier
  ds_read_b128 v[48:51], v1 offset:40960
  ds_read_b128 v[52:55], v1 offset:41984
  ds_read_b128 v[56:59], v1 offset:43008
  ds_read_b128 v[60:63], v1 offset:44032
  ds_read_b128 v[64:67], v1 offset:45056
  ds_read_b128 v[68:71], v1 offset:46080
  ds_read_b128 v[72:75], v1 offset:47104
  ds_read_b128 v[76:79], v1 offset:48128
  buffer_load_dwordx4 a[56:59], v12, s[8:11], s90 offen offset:0 sc1
  buffer_load_dwordx4 a[60:63], v1, s[8:11], s88 offen offset:1024 sc1
  buffer_load_dwordx4 a[64:67], v1, s[8:11], s89 offen offset:1024 sc1
  buffer_load_dwordx4 a[68:71], v12, s[8:11], s90 offen offset:1024 sc1
  buffer_load_dwordx4 a[72:75], v1, s[8:11], s88 offen offset:2048 sc1
  buffer_load_dwordx4 a[76:79], v1, s[8:11], s89 offen offset:2048 sc1
  s_waitcnt lgkmcnt(6)
  v_cvt_pk_bf16_f32 v104, v36, v37
  v_mfma_f32_16x16x32_bf16 v[80:83], v[176:179], v[48:51], v[32:35]
  v_cvt_pk_bf16_f32 v105, v38, v39
  v_mfma_f32_16x16x32_bf16 v[84:87], v[240:243], v[48:51], v[36:39]
  v_cvt_pk_bf16_f32 v106, v44, v45
  v_mfma_f32_16x16x32_bf16 v[80:83], v[184:187], v[52:55], v[80:83]
  v_cvt_pk_bf16_f32 v107, v46, v47
  v_mfma_f32_16x16x32_bf16 v[84:87], v[176:179], v[52:55], v[84:87]
  s_waitcnt lgkmcnt(4)
  v_mfma_f32_16x16x32_bf16 v[80:83], v[180:183], v[56:59], v[80:83]
  v_mfma_f32_16x16x32_bf16 v[84:87], v[244:247], v[56:59], v[84:87]
  v_mfma_f32_16x16x32_bf16 v[80:83], v[188:191], v[60:63], v[80:83]
  v_mfma_f32_16x16x32_bf16 v[84:87], v[180:183], v[60:63], v[84:87]
  s_waitcnt lgkmcnt(2)
  v_mfma_f32_16x16x32_bf16 v[88:91], v[176:179], v[64:67], v[40:43]
  v_mfma_f32_16x16x32_bf16 v[92:95], v[240:243], v[64:67], v[44:47]
  v_mfma_f32_16x16x32_bf16 v[88:91], v[184:187], v[68:71], v[88:91]
  v_mfma_f32_16x16x32_bf16 v[92:95], v[176:179], v[68:71], v[92:95]
  s_nop 1
  v_cvt_pk_bf16_f32 v96, v80, v81
  v_cvt_pk_bf16_f32 v97, v82, v83
  s_waitcnt lgkmcnt(0)
  v_cvt_pk_bf16_f32 v98, v84, v85
  v_cvt_pk_bf16_f32 v99, v86, v87
  v_mfma_f32_16x16x32_bf16 v[88:91], v[180:183], v[72:75], v[88:91]
  v_bfi_b32 v98, s51, v98, v104
  v_bfi_b32 v99, s51, v99, v105
  v_mfma_f32_16x16x32_bf16 v[92:95], v[244:247], v[72:75], v[92:95]
  buffer_store_dwordx4 v[96:99], v9, s[8:11], s26 offen sc1
  v_mfma_f32_16x16x32_bf16 v[88:91], v[188:191], v[76:79], v[88:91]
  v_mfma_f32_16x16x32_bf16 v[92:95], v[180:183], v[76:79], v[92:95]
  s_nop 6
  v_cvt_pk_bf16_f32 v100, v88, v89
  v_cvt_pk_bf16_f32 v101, v90, v91
  v_cvt_pk_bf16_f32 v102, v92, v93
  v_cvt_pk_bf16_f32 v103, v94, v95
  v_bfi_b32 v102, s51, v102, v106
  v_bfi_b32 v103, s51, v103, v107
  buffer_store_dwordx4 v[100:103], v9, s[8:11], s27 offen sc1
  v_mov_b32 v4, 1
  v_mul_u32_u24 v5, 67584, v0
  s_and_b32 s4, s2, 15
  s_mul_i32 s4, s4, 4224
  s_add_u32 s4, s4, 36970496
  s_cmp_lg_u32 s3, 0
  s_waitcnt vmcnt(0) lgkmcnt(0)
  s_barrier
  s_cbranch_scc1 Larr_12
  s_mov_b64 exec, 0xff
  buffer_atomic_add v4, v5, s[8:11], s4 offen sc1
  s_mov_b64 exec, -1
Larr_12:
  buffer_load_dwordx4 a[80:83], v12, s[8:11], s90 offen offset:2048 sc1
  buffer_load_dwordx4 a[84:87], v1, s[8:11], s88 offen offset:3072 sc1
  s_add_u32 s88, s88, 4096
  buffer_load_dwordx4 a[88:91], v1, s[8:11], s89 offen offset:3072 sc1
  s_add_u32 s89, s89, 4096
  buffer_load_dwordx4 a[92:95], v12, s[8:11], s90 offen offset:3072 sc1
  s_add_u32 s90, s90, 4096
  buffer_load_dwordx4 a[96:99], v1, s[8:11], s88 offen offset:0 sc1
  buffer_load_dwordx4 a[100:103], v1, s[8:11], s89 offen offset:0 sc1
  buffer_load_dwordx4 a[104:107], v12, s[8:11], s90 offen offset:0 sc1
  buffer_load_dwordx4 a[108:111], v1, s[8:11], s88 offen offset:1024 sc1
  buffer_load_dwordx4 a[112:115], v1, s[8:11], s89 offen offset:1024 sc1
  buffer_load_dwordx4 a[116:119], v12, s[8:11], s90 offen offset:1024 sc1
  buffer_load_dwordx4 a[120:123], v1, s[8:11], s88 offen offset:2048 sc1
  s_bitcmp1_b32 s45, 0
  s_cbranch_scc1 G1_DTB
G1_DTR:
  s_add_u32 s28, s37, 2097152
  s_mov_b32 m0, s38
  v_lshlrev_b32 v8, 11, v3
  v_and_b32 v9, 1, v3
  v_lshl_add_u32 v8, v9, 7, v8
  v_lshrrev_b32 v9, 3, v2
  v_lshl_add_u32 v8, v9, 6, v8
  v_and_b32 v9, 3, v2
  v_lshl_add_u32 v8, v9, 4, v8
  v_bfe_u32 v9, v2, 2, 1
  v_lshl_add_u32 v8, v9, 3, v8
  v_xor_b32 v9, 128, v8
  v_add_u32 v10, 0x10000, v8
  v_add_u32 v11, 0x10000, v9
  v_lshrrev_b32 v13, 5, v0
  v_mul_u32_u24 v13, 175616, v13
  v_add_u32 v13, v13, v1
  v_add_u32 v13, 10485760, v13
  s_cmp_eq_u32 s3, 3
  s_cselect_b32 s4, 2146435072, 0
  v_add_u32 v14, s4, v6
  v_mov_b32 v7, 1
  v_mov_b32 v15, 0
  s_mul_i32 s24, s53, 4224
  s_add_u32 s24, s24, 38660096
  s_add_u32 s26, s24, 67584
  s_cmp_eq_u32 s3, 0
  s_cselect_b32 s25, s24, 46137344
  s_cselect_b32 s27, s26, 46137344
  s_lshl_b32 s30, s55, 8
  s_lshr_b32 s4, s35, 2
  s_add_u32 s31, s30, s4
  s_xor_b32 s4, s4, 64
  s_add_u32 s30, s30, s4
  s_cmp_eq_u32 s54, 15
  s_cselect_b32 s29, 1, 0
  s_cmp_lg_u32 s3, 1
  s_cbranch_scc1 Lnt2_1906
  s_mov_b64 exec, 0
  s_branch Lstub2
Lret2_1906:
  s_mov_b64 exec, -1
Lnt2_1906:
  s_cmp_lg_u32 s3, 2
  s_cbranch_scc1 Lnt3_1906
  s_mov_b64 exec, 0
  s_branch Lstub3
Lret3_1906:
  s_mov_b64 exec, -1
Lnt3_1906:
  s_cmp_lg_u32 s3, 0
  s_cbranch_scc1 Lwait_13
  v_mul_u32_u24 v5, 4224, v0
  s_sleep 8
  s_mov_b64 exec, 0xffff
  s_and_b32 s4, s2, 7
  s_mul_i32 s4, s4, 67584
  s_add_u32 s4, s4, 36970496
  s_mov_b32 s7, 0x100000
Lpoll_14:
  buffer_load_dword v4, v5, s[8:11], s4 offen sc1
  s_sub_u32 s7, s7, 1
  s_cbranch_scc1 Ldone_15
  s_waitcnt vmcnt(0)
  v_cmp_gt_u32 vcc, 16, v4
  s_cbranch_vccz Ldone_15
  s_mov_b64 exec, vcc
  s_branch Lpoll_14
Ldone_15:
  s_mov_b64 exec, -1
Lwait_13:
  s_barrier
  buffer_load_dwordx4 v1, s[8:11], s28 offen sc1 lds
  buffer_load_dwordx4 v1, s[8:11], s28 offen offset:1024 sc1 lds
  s_add_u32 m0, m0, 8192
  s_add_u32 s28, s28, 8192
  buffer_load_dwordx4 v1, s[8:11], s28 offen sc1 lds
  buffer_load_dwordx4 v1, s[8:11], s28 offen offset:1024 sc1 lds
  s_add_u32 m0, m0, 8192
  s_add_u32 s28, s28, 8192
  buffer_load_dwordx4 v1, s[8:11], s28 offen sc1 lds
  buffer_load_dwordx4 v1, s[8:11], s28 offen offset:1024 sc1 lds
  s_add_u32 m0, m0, 8192
  s_add_u32 s28, s28, 8192
  buffer_load_dwordx4 v1, s[8:11], s28 offen sc1 lds
  buffer_load_dwordx4 v1, s[8:11], s28 offen offset:1024 sc1 lds
  s_add_u32 m0, m0, 8192
  s_add_u32 s28, s28, 8192
  buffer_load_dwordx4 v1, s[8:11], s28 offen sc1 lds
  buffer_load_dwordx4 v1, s[8:11], s28 offen offset:1024 sc1 lds
  s_add_u32 m0, m0, 8192
  s_add_u32 s28, s28, 8192
  v_lshrrev_b32 v5, 5, v0
  v_lshl_add_u32 v5, v5, 9, v1
  v_add_u32 v5, 10485760, v5
  s_cmp_eq_u32 s29, 1
  s_cbranch_scc1 G1_STATS0
  s_waitcnt vmcnt(8)
  s_barrier
  ds_read_b64_tr_b16 v[112:113], v8 offset:0
  ds_read_b64_tr_b16 v[114:115], v9 offset:0
  ds_read_b64_tr_b16 v[116:117], v8 offset:256
  ds_read_b64_tr_b16 v[118:119], v9 offset:256
  ds_read_b64_tr_b16 v[120:121], v8 offset:1024
  ds_read_b64_tr_b16 v[122:123], v9 offset:1024
  ds_read_b64_tr_b16 v[124:125], v8 offset:1280
  ds_read_b64_tr_b16 v[126:127], v9 offset:1280
  ds_read_b64_tr_b16 v[128:129], v8 offset:512
  ds_read_b64_tr_b16 v[130:131], v9 offset:512
  ds_read_b64_tr_b16 v[132:133], v8 offset:768
  ds_read_b64_tr_b16 v[134:135], v9 offset:768
  ds_read_b64_tr_b16 v[136:137], v8 offset:1536
  ds_read_b64_tr_b16 v[138:139], v9 offset:1536
  ds_read_b64_tr_b16 v[140:141], v8 offset:1792
  ds_read_b64_tr_b16 v[142:143], v9 offset:1792
  s_waitcnt lgkmcnt(12)
  v_mfma_f32_16x16x32_bf16 v[16:19], a[0:3], v[112:115], 0
  buffer_load_dwordx4 v1, s[8:11], s28 offen sc1 lds
  v_mfma_f32_16x16x32_bf16 v[32:35], a[4:7], v[112:115], 0
  v_mfma_f32_16x16x32_bf16 v[48:51], a[8:11], v[112:115], 0
  s_waitcnt vmcnt(7)
  s_barrier
  v_mfma_f32_16x16x32_bf16 v[52:55], a[8:11], v[116:119], 0
  ds_read_b64_tr_b16 v[112:113], v8 offset:8192
  v_mfma_f32_16x16x32_bf16 v[36:39], a[4:7], v[116:119], 0
  ds_read_b64_tr_b16 v[114:115], v9 offset:8192
Lstub2:
  s_cbranch_execz Lret2_1906
  v_mfma_f32_16x16x32_bf16 v[20:23], a[0:3], v[116:119], 0
  s_waitcnt lgkmcnt(10)
  v_mfma_f32_16x16x32_bf16 v[24:27], a[0:3], v[120:123], 0
  ds_read_b64_tr_b16 v[116:117], v8 offset:8448
  v_mfma_f32_16x16x32_bf16 v[40:43], a[4:7], v[120:123], 0
  ds_read_b64_tr_b16 v[118:119], v9 offset:8448
  v_mfma_f32_16x16x32_bf16 v[56:59], a[8:11], v[120:123], 0
  buffer_load_dwordx4 v1, s[8:11], s28 offen offset:1024 sc1 lds
  v_mfma_f32_16x16x32_bf16 v[60:63], a[8:11], v[124:127], 0
  ds_read_b64_tr_b16 v[120:121], v8 offset:9216
  s_add_u32 m0, m0, 8192
  v_mfma_f32_16x16x32_bf16 v[44:47], a[4:7], v[124:127], 0
  ds_read_b64_tr_b16 v[122:123], v9 offset:9216
  s_add_u32 s28, s28, 8192
  v_mfma_f32_16x16x32_bf16 v[28:31], a[0:3], v[124:127], 0
  s_waitcnt lgkmcnt(10)
  v_mfma_f32_16x16x32_bf16 v[64:67], a[0:3], v[128:131], 0
  ds_read_b64_tr_b16 v[124:125], v8 offset:9472
  v_mfma_f32_16x16x32_bf16 v[80:83], a[4:7], v[128:131], 0
  ds_read_b64_tr_b16 v[126:127], v9 offset:9472
  v_mfma_f32_16x16x32_bf16 v[96:99], a[8:11], v[128:131], 0
  buffer_load_dwordx4 a[124:127], v1, s[8:11], s89 offen offset:2048 sc1
  v_mfma_f32_16x16x32_bf16 v[100:103], a[8:11], v[132:135], 0
  ds_read_b64_tr_b16 v[128:129], v8 offset:8704
  v_mfma_f32_16x16x32_bf16 v[84:87], a[4:7], v[132:135], 0
  ds_read_b64_tr_b16 v[130:131], v9 offset:8704
  v_mfma_f32_16x16x32_bf16 v[68:71], a[0:3], v[132:135], 0
  buffer_load_dwordx4 a[128:131], v12, s[8:11], s90 offen offset:2048 sc1
  s_waitcnt lgkmcnt(10)
  v_mfma_f32_16x16x32_bf16 v[72:75], a[0:3], v[136:139], 0
  ds_read_b64_tr_b16 v[132:133], v8 offset:8960
  v_mfma_f32_16x16x32_bf16 v[88:91], a[4:7], v[136:139], 0
  ds_read_b64_tr_b16 v[134:135], v9 offset:8960
  v_mfma_f32_16x16x32_bf16 v[104:107], a[8:11], v[136:139], 0
  v_mfma_f32_16x16x32_bf16 v[108:111], a[8:11], v[140:143], 0
  ds_read_b64_tr_b16 v[136:137], v8 offset:9728
  v_mfma_f32_16x16x32_bf16 v[92:95], a[4:7], v[140:143], 0
  ds_read_b64_tr_b16 v[138:139], v9 offset:9728
  v_mfma_f32_16x16x32_bf16 v[76:79], a[0:3], v[140:143], 0
  buffer_load_dwordx4 v1, s[8:11], s28 offen sc1 lds
  s_waitcnt lgkmcnt(10)
  v_mfma_f32_16x16x32_bf16 v[16:19], a[12:15], v[112:115], v[16:19]
  ds_read_b64_tr_b16 v[140:141], v8 offset:9984
  v_mfma_f32_16x16x32_bf16 v[32:35], a[16:19], v[112:115], v[32:35]
  ds_read_b64_tr_b16 v[142:143], v9 offset:9984
  v_mfma_f32_16x16x32_bf16 v[48:51], a[20:23], v[112:115], v[48:51]
  buffer_load_dwordx4 v1, s[8:11], s28 offen offset:1024 sc1 lds
  s_waitcnt vmcnt(10)
  s_barrier
  v_mfma_f32_16x16x32_bf16 v[52:55], a[20:23], v[116:119], v[52:55]
  ds_read_b64_tr_b16 v[112:113], v8 offset:16384
  s_add_u32 m0, m0, 8192
  v_mfma_f32_16x16x32_bf16 v[36:39], a[16:19], v[116:119], v[36:39]
  ds_read_b64_tr_b16 v[114:115], v9 offset:16384
  s_add_u32 s28, s28, 8192
  v_mfma_f32_16x16x32_bf16 v[20:23], a[12:15], v[116:119], v[20:23]
  s_waitcnt lgkmcnt(10)
  v_mfma_f32_16x16x32_bf16 v[24:27], a[12:15], v[120:123], v[24:27]
  ds_read_b64_tr_b16 v[116:117], v8 offset:16640
  v_mfma_f32_16x16x32_bf16 v[40:43], a[16:19], v[120:123], v[40:43]
  ds_read_b64_tr_b16 v[118:119], v9 offset:16640
  v_mfma_f32_16x16x32_bf16 v[56:59], a[20:23], v[120:123], v[56:59]
  buffer_load_dwordx4 a[132:135], v1, s[8:11], s88 offen offset:3072 sc1
  v_mfma_f32_16x16x32_bf16 v[60:63], a[20:23], v[124:127], v[60:63]
  ds_read_b64_tr_b16 v[120:121], v8 offset:17408
  s_add_u32 s88, s88, 4096
  v_mfma_f32_16x16x32_bf16 v[44:47], a[16:19], v[124:127], v[44:47]
  ds_read_b64_tr_b16 v[122:123], v9 offset:17408
  v_mfma_f32_16x16x32_bf16 v[28:31], a[12:15], v[124:127], v[28:31]
  buffer_load_dwordx4 a[136:139], v1, s[8:11], s89 offen offset:3072 sc1
  s_waitcnt lgkmcnt(10)
  v_mfma_f32_16x16x32_bf16 v[64:67], a[12:15], v[128:131], v[64:67]
  ds_read_b64_tr_b16 v[124:125], v8 offset:17664
  v_mfma_f32_16x16x32_bf16 v[80:83], a[16:19], v[128:131], v[80:83]
  ds_read_b64_tr_b16 v[126:127], v9 offset:17664
  v_mfma_f32_16x16x32_bf16 v[96:99], a[20:23], v[128:131], v[96:99]
  v_mfma_f32_16x16x32_bf16 v[100:103], a[20:23], v[132:135], v[100:103]
  ds_read_b64_tr_b16 v[128:129], v8 offset:16896
  v_mfma_f32_16x16x32_bf16 v[84:87], a[16:19], v[132:135], v[84:87]
  ds_read_b64_tr_b16 v[130:131], v9 offset:16896
  v_mfma_f32_16x16x32_bf16 v[68:71], a[12:15], v[132:135], v[68:71]
  buffer_load_dwordx4 v1, s[8:11], s28 offen sc1 lds
  s_waitcnt lgkmcnt(10)
  v_mfma_f32_16x16x32_bf16 v[72:75], a[12:15], v[136:139], v[72:75]
  ds_read_b64_tr_b16 v[132:133], v8 offset:17152
  v_mfma_f32_16x16x32_bf16 v[88:91], a[16:19], v[136:139], v[88:91]
  ds_read_b64_tr_b16 v[134:135], v9 offset:17152
  v_mfma_f32_16x16x32_bf16 v[104:107], a[20:23], v[136:139], v[104:107]
  buffer_load_dwordx4 v1, s[8:11], s28 offen offset:1024 sc1 lds
  v_mfma_f32_16x16x32_bf16 v[108:111], a[20:23], v[140:143], v[108:111]
  ds_read_b64_tr_b16 v[136:137], v8 offset:17920
  s_add_u32 m0, m0, 8192
  v_mfma_f32_16x16x32_bf16 v[92:95], a[16:19], v[140:143], v[92:95]
  ds_read_b64_tr_b16 v[138:139], v9 offset:17920
  s_add_u32 s28, s28, 8192
  v_mfma_f32_16x16x32_bf16 v[76:79], a[12:15], v[140:143], v[76:79]
  s_add_u32 s89, s89, 4096
  s_waitcnt lgkmcnt(10)
  v_mfma_f32_16x16x32_bf16 v[16:19], a[24:27], v[112:115], v[16:19]
  ds_read_b64_tr_b16 v[140:141], v8 offset:18176
  v_mfma_f32_16x16x32_bf16 v[32:35], a[28:31], v[112:115], v[32:35]
  ds_read_b64_tr_b16 v[142:143], v9 offset:18176
  v_mfma_f32_16x16x32_bf16 v[48:51], a[32:35], v[112:115], v[48:51]
  buffer_load_dwordx4 a[140:143], v12, s[8:11], s90 offen offset:3072 sc1
  s_waitcnt vmcnt(11)
  s_barrier
  v_mfma_f32_16x16x32_bf16 v[52:55], a[32:35], v[116:119], v[52:55]
  ds_read_b64_tr_b16 v[112:113], v8 offset:24576
  s_add_u32 s90, s90, 4096
  v_mfma_f32_16x16x32_bf16 v[36:39], a[28:31], v[116:119], v[36:39]
  ds_read_b64_tr_b16 v[114:115], v9 offset:24576
  v_mfma_f32_16x16x32_bf16 v[20:23], a[24:27], v[116:119], v[20:23]
  buffer_load_dwordx4 a[144:147], v1, s[8:11], s88 offen offset:0 sc1
  s_waitcnt lgkmcnt(10)
  v_mfma_f32_16x16x32_bf16 v[24:27], a[24:27], v[120:123], v[24:27]
  ds_read_b64_tr_b16 v[116:117], v8 offset:24832
  v_mfma_f32_16x16x32_bf16 v[40:43], a[28:31], v[120:123], v[40:43]
  ds_read_b64_tr_b16 v[118:119], v9 offset:24832
  v_mfma_f32_16x16x32_bf16 v[56:59], a[32:35], v[120:123], v[56:59]
  v_mfma_f32_16x16x32_bf16 v[60:63], a[32:35], v[124:127], v[60:63]
  ds_read_b64_tr_b16 v[120:121], v8 offset:25600
  v_mfma_f32_16x16x32_bf16 v[44:47], a[28:31], v[124:127], v[44:47]
  ds_read_b64_tr_b16 v[122:123], v9 offset:25600
  v_mfma_f32_16x16x32_bf16 v[28:31], a[24:27], v[124:127], v[28:31]
  buffer_load_dwordx4 v1, s[8:11], s28 offen sc1 lds
  s_waitcnt lgkmcnt(10)
  v_mfma_f32_16x16x32_bf16 v[64:67], a[24:27], v[128:131], v[64:67]
  ds_read_b64_tr_b16 v[124:125], v8 offset:25856
  v_mfma_f32_16x16x32_bf16 v[80:83], a[28:31], v[128:131], v[80:83]
  ds_read_b64_tr_b16 v[126:127], v9 offset:25856
  v_mfma_f32_16x16x32_bf16 v[96:99], a[32:35], v[128:131], v[96:99]
  buffer_load_dwordx4 v1, s[8:11], s28 offen offset:1024 sc1 lds
  v_mfma_f32_16x16x32_bf16 v[100:103], a[32:35], v[132:135], v[100:103]
  ds_read_b64_tr_b16 v[128:129], v8 offset:25088
  s_add_u32 m0, m0, 8192
  v_mfma_f32_16x16x32_bf16 v[84:87], a[28:31], v[132:135], v[84:87]
  ds_read_b64_tr_b16 v[130:131], v9 offset:25088
  s_add_u32 s28, s28, 8192
  v_mfma_f32_16x16x32_bf16 v[68:71], a[24:27], v[132:135], v[68:71]
  s_waitcnt lgkmcnt(10)
  v_mfma_f32_16x16x32_bf16 v[72:75], a[24:27], v[136:139], v[72:75]
  ds_read_b64_tr_b16 v[132:133], v8 offset:25344
  v_mfma_f32_16x16x32_bf16 v[88:91], a[28:31], v[136:139], v[88:91]
  ds_read_b64_tr_b16 v[134:135], v9 offset:25344
  v_mfma_f32_16x16x32_bf16 v[104:107], a[32:35], v[136:139], v[104:107]
  buffer_load_dwordx4 a[148:151], v1, s[8:11], s89 offen offset:0 sc1
  v_mfma_f32_16x16x32_bf16 v[108:111], a[32:35], v[140:143], v[108:111]
  ds_read_b64_tr_b16 v[136:137], v8 offset:26112
  v_mfma_f32_16x16x32_bf16 v[92:95], a[28:31], v[140:143], v[92:95]
  ds_read_b64_tr_b16 v[138:139], v9 offset:26112
  v_mfma_f32_16x16x32_bf16 v[76:79], a[24:27], v[140:143], v[76:79]
  buffer_load_dwordx4 a[152:155], v12, s[8:11], s90 offen offset:0 sc1
  s_waitcnt lgkmcnt(10)
  v_mfma_f32_16x16x32_bf16 v[16:19], a[36:39], v[112:115], v[16:19]
  ds_read_b64_tr_b16 v[140:141], v8 offset:26368
  v_mfma_f32_16x16x32_bf16 v[32:35], a[40:43], v[112:115], v[32:35]
  ds_read_b64_tr_b16 v[142:143], v9 offset:26368
  v_mfma_f32_16x16x32_bf16 v[48:51], a[44:47], v[112:115], v[48:51]
  v_mfma_f32_16x16x32_bf16 v[52:55], a[44:47], v[116:119], v[52:55]
  ds_read_b64_tr_b16 v[112:113], v8 offset:32768
  v_mfma_f32_16x16x32_bf16 v[36:39], a[40:43], v[116:119], v[36:39]
  ds_read_b64_tr_b16 v[114:115], v9 offset:32768
  v_mfma_f32_16x16x32_bf16 v[20:23], a[36:39], v[116:119], v[20:23]
  buffer_load_dwordx4 v1, s[8:11], s28 offen sc1 lds
  s_waitcnt lgkmcnt(10)
  v_mfma_f32_16x16x32_bf16 v[24:27], a[36:39], v[120:123], v[24:27]
  ds_read_b64_tr_b16 v[116:117], v8 offset:33024
  v_mfma_f32_16x16x32_bf16 v[40:43], a[40:43], v[120:123], v[40:43]
  ds_read_b64_tr_b16 v[118:119], v9 offset:33024
  v_mfma_f32_16x16x32_bf16 v[56:59], a[44:47], v[120:123], v[56:59]
  buffer_load_dwordx4 v1, s[8:11], s28 offen offset:1024 sc1 lds
  v_mfma_f32_16x16x32_bf16 v[60:63], a[44:47], v[124:127], v[60:63]
  ds_read_b64_tr_b16 v[120:121], v8 offset:33792
  s_add_u32 m0, m0, 8192
  v_mfma_f32_16x16x32_bf16 v[44:47], a[40:43], v[124:127], v[44:47]
  ds_read_b64_tr_b16 v[122:123], v9 offset:33792
  s_add_u32 s28, s28, 8192
  v_mfma_f32_16x16x32_bf16 v[28:31], a[36:39], v[124:127], v[28:31]
  s_waitcnt lgkmcnt(10)
  v_mfma_f32_16x16x32_bf16 v[64:67], a[36:39], v[128:131], v[64:67]
  ds_read_b64_tr_b16 v[124:125], v8 offset:34048
  v_mfma_f32_16x16x32_bf16 v[80:83], a[40:43], v[128:131], v[80:83]
  ds_read_b64_tr_b16 v[126:127], v9 offset:34048
  v_mfma_f32_16x16x32_bf16 v[96:99], a[44:47], v[128:131], v[96:99]
  buffer_load_dwordx4 a[156:159], v1, s[8:11], s88 offen offset:1024 sc1
  v_mfma_f32_16x16x32_bf16 v[100:103], a[44:47], v[132:135], v[100:103]
  ds_read_b64_tr_b16 v[128:129], v8 offset:33280
  v_mfma_f32_16x16x32_bf16 v[84:87], a[40:43], v[132:135], v[84:87]
  ds_read_b64_tr_b16 v[130:131], v9 offset:33280
  v_mfma_f32_16x16x32_bf16 v[68:71], a[36:39], v[132:135], v[68:71]
  buffer_load_dwordx4 a[160:163], v1, s[8:11], s89 offen offset:1024 sc1
  s_waitcnt lgkmcnt(10)
  v_mfma_f32_16x16x32_bf16 v[72:75], a[36:39], v[136:139], v[72:75]
  ds_read_b64_tr_b16 v[132:133], v8 offset:33536
  v_mfma_f32_16x16x32_bf16 v[88:91], a[40:43], v[136:139], v[88:91]
  ds_read_b64_tr_b16 v[134:135], v9 offset:33536
  v_mfma_f32_16x16x32_bf16 v[104:107], a[44:47], v[136:139], v[104:107]
  v_mfma_f32_16x16x32_bf16 v[108:111], a[44:47], v[140:143], v[108:111]
  ds_read_b64_tr_b16 v[136:137], v8 offset:34304
  v_mfma_f32_16x16x32_bf16 v[92:95], a[40:43], v[140:143], v[92:95]
  ds_read_b64_tr_b16 v[138:139], v9 offset:34304
  v_mfma_f32_16x16x32_bf16 v[76:79], a[36:39], v[140:143], v[76:79]
  buffer_load_dwordx4 v1, s[8:11], s28 offen sc1 lds
  s_waitcnt lgkmcnt(10)
  v_mfma_f32_16x16x32_bf16 v[16:19], a[48:51], v[112:115], v[16:19]
  ds_read_b64_tr_b16 v[140:141], v8 offset:34560
  v_mfma_f32_16x16x32_bf16 v[32:35], a[52:55], v[112:115], v[32:35]
  ds_read_b64_tr_b16 v[142:143], v9 offset:34560
  v_mfma_f32_16x16x32_bf16 v[48:51], a[56:59], v[112:115], v[48:51]
  buffer_load_dwordx4 v1, s[8:11], s28 offen offset:1024 sc1 lds
  s_waitcnt vmcnt(12)
  s_barrier
  v_mfma_f32_16x16x32_bf16 v[52:55], a[56:59], v[116:119], v[52:55]
  ds_read_b64_tr_b16 v[112:113], v8 offset:40960
  s_add_u32 m0, m0, 8192
  v_mfma_f32_16x16x32_bf16 v[36:39], a[52:55], v[116:119], v[36:39]
  ds_read_b64_tr_b16 v[114:115], v9 offset:40960
  s_add_u32 s28, s28, 8192
  v_mfma_f32_16x16x32_bf16 v[20:23], a[48:51], v[116:119], v[20:23]
  s_waitcnt lgkmcnt(10)
  v_mfma_f32_16x16x32_bf16 v[24:27], a[48:51], v[120:123], v[24:27]
  ds_read_b64_tr_b16 v[116:117], v8 offset:41216
  v_mfma_f32_16x16x32_bf16 v[40:43], a[52:55], v[120:123], v[40:43]
  ds_read_b64_tr_b16 v[118:119], v9 offset:41216
  v_mfma_f32_16x16x32_bf16 v[56:59], a[56:59], v[120:123], v[56:59]
  buffer_load_dwordx4 a[164:167], v12, s[8:11], s90 offen offset:1024 sc1
  v_mfma_f32_16x16x32_bf16 v[60:63], a[56:59], v[124:127], v[60:63]
  ds_read_b64_tr_b16 v[120:121], v8 offset:41984
  v_mfma_f32_16x16x32_bf16 v[44:47], a[52:55], v[124:127], v[44:47]
  ds_read_b64_tr_b16 v[122:123], v9 offset:41984
  v_mfma_f32_16x16x32_bf16 v[28:31], a[48:51], v[124:127], v[28:31]
  buffer_load_dwordx4 a[168:171], v1, s[8:11], s88 offen offset:2048 sc1
  s_waitcnt lgkmcnt(10)
  v_mfma_f32_16x16x32_bf16 v[64:67], a[48:51], v[128:131], v[64:67]
  ds_read_b64_tr_b16 v[124:125], v8 offset:42240
  v_mfma_f32_16x16x32_bf16 v[80:83], a[52:55], v[128:131], v[80:83]
  ds_read_b64_tr_b16 v[126:127], v9 offset:42240
  v_mfma_f32_16x16x32_bf16 v[96:99], a[56:59], v[128:131], v[96:99]
  v_mfma_f32_16x16x32_bf16 v[100:103], a[56:59], v[132:135], v[100:103]
  ds_read_b64_tr_b16 v[128:129], v8 offset:41472
  v_mfma_f32_16x16x32_bf16 v[84:87], a[52:55], v[132:135], v[84:87]
  ds_read_b64_tr_b16 v[130:131], v9 offset:41472
  v_mfma_f32_16x16x32_bf16 v[68:71], a[48:51], v[132:135], v[68:71]
  buffer_load_dwordx4 v1, s[8:11], s28 offen sc1 lds
  s_waitcnt lgkmcnt(10)
  v_mfma_f32_16x16x32_bf16 v[72:75], a[48:51], v[136:139], v[72:75]
  ds_read_b64_tr_b16 v[132:133], v8 offset:41728
  v_mfma_f32_16x16x32_bf16 v[88:91], a[52:55], v[136:139], v[88:91]
  ds_read_b64_tr_b16 v[134:135], v9 offset:41728
  v_mfma_f32_16x16x32_bf16 v[104:107], a[56:59], v[136:139], v[104:107]
  buffer_load_dwordx4 v1, s[8:11], s28 offen offset:1024 sc1 lds
  v_mfma_f32_16x16x32_bf16 v[108:111], a[56:59], v[140:143], v[108:111]
  ds_read_b64_tr_b16 v[136:137], v8 offset:42496
  s_add_u32 m0, m0, 8192
  v_mfma_f32_16x16x32_bf16 v[92:95], a[52:55], v[140:143], v[92:95]
  ds_read_b64_tr_b16 v[138:139], v9 offset:42496
  s_add_u32 s28, s28, 8192
  v_mfma_f32_16x16x32_bf16 v[76:79], a[48:51], v[140:143], v[76:79]
  s_waitcnt lgkmcnt(10)
  v_mfma_f32_16x16x32_bf16 v[16:19], a[60:63], v[112:115], v[16:19]
  ds_read_b64_tr_b16 v[140:141], v8 offset:42752
  v_mfma_f32_16x16x32_bf16 v[32:35], a[64:67], v[112:115], v[32:35]
  ds_read_b64_tr_b16 v[142:143], v9 offset:42752
  v_mfma_f32_16x16x32_bf16 v[48:51], a[68:71], v[112:115], v[48:51]
  buffer_load_dwordx4 a[172:175], v1, s[8:11], s89 offen offset:2048 sc1
  v_mfma_f32_16x16x32_bf16 v[52:55], a[68:71], v[116:119], v[52:55]
  ds_read_b64_tr_b16 v[112:113], v8 offset:49152
  v_mfma_f32_16x16x32_bf16 v[36:39], a[64:67], v[116:119], v[36:39]
  ds_read_b64_tr_b16 v[114:115], v9 offset:49152
  v_mfma_f32_16x16x32_bf16 v[20:23], a[60:63], v[116:119], v[20:23]
  s_waitcnt lgkmcnt(10)
  v_mfma_f32_16x16x32_bf16 v[24:27], a[60:63], v[120:123], v[24:27]
  ds_read_b64_tr_b16 v[116:117], v8 offset:49408
  v_mfma_f32_16x16x32_bf16 v[40:43], a[64:67], v[120:123], v[40:43]
  ds_read_b64_tr_b16 v[118:119], v9 offset:49408
  v_mfma_f32_16x16x32_bf16 v[56:59], a[68:71], v[120:123], v[56:59]
  buffer_load_dwordx4 a[176:179], v12, s[8:11], s90 offen offset:2048 sc1
  v_mfma_f32_16x16x32_bf16 v[60:63], a[68:71], v[124:127], v[60:63]
  ds_read_b64_tr_b16 v[120:121], v8 offset:50176
  v_mfma_f32_16x16x32_bf16 v[44:47], a[64:67], v[124:127], v[44:47]
  ds_read_b64_tr_b16 v[122:123], v9 offset:50176
  v_mfma_f32_16x16x32_bf16 v[28:31], a[60:63], v[124:127], v[28:31]
  buffer_load_dwordx4 v1, s[8:11], s28 offen sc1 lds
  s_waitcnt lgkmcnt(10)
  v_mfma_f32_16x16x32_bf16 v[64:67], a[60:63], v[128:131], v[64:67]
  ds_read_b64_tr_b16 v[124:125], v8 offset:50432
  v_mfma_f32_16x16x32_bf16 v[80:83], a[64:67], v[128:131], v[80:83]
  ds_read_b64_tr_b16 v[126:127], v9 offset:50432
  v_mfma_f32_16x16x32_bf16 v[96:99], a[68:71], v[128:131], v[96:99]
  v_mfma_f32_16x16x32_bf16 v[100:103], a[68:71], v[132:135], v[100:103]
  ds_read_b64_tr_b16 v[128:129], v8 offset:49664
  v_mfma_f32_16x16x32_bf16 v[84:87], a[64:67], v[132:135], v[84:87]
  ds_read_b64_tr_b16 v[130:131], v9 offset:49664
  v_mfma_f32_16x16x32_bf16 v[68:71], a[60:63], v[132:135], v[68:71]
  buffer_load_dwordx4 v1, s[8:11], s28 offen offset:1024 sc1 lds
  s_waitcnt lgkmcnt(10)
  v_mfma_f32_16x16x32_bf16 v[72:75], a[60:63], v[136:139], v[72:75]
  ds_read_b64_tr_b16 v[132:133], v8 offset:49920
  s_add_u32 m0, m0, 8192
  v_mfma_f32_16x16x32_bf16 v[88:91], a[64:67], v[136:139], v[88:91]
  ds_read_b64_tr_b16 v[134:135], v9 offset:49920
  s_add_u32 s28, s28, 8192
  v_mfma_f32_16x16x32_bf16 v[104:107], a[68:71], v[136:139], v[104:107]
  buffer_load_dwordx4 a[180:183], v1, s[8:11], s88 offen offset:3072 sc1
  v_mfma_f32_16x16x32_bf16 v[108:111], a[68:71], v[140:143], v[108:111]
  ds_read_b64_tr_b16 v[136:137], v8 offset:50688
  v_mfma_f32_16x16x32_bf16 v[92:95], a[64:67], v[140:143], v[92:95]
  ds_read_b64_tr_b16 v[138:139], v9 offset:50688
  v_mfma_f32_16x16x32_bf16 v[76:79], a[60:63], v[140:143], v[76:79]
  s_waitcnt lgkmcnt(10)
  v_mfma_f32_16x16x32_bf16 v[16:19], a[72:75], v[112:115], v[16:19]
  ds_read_b64_tr_b16 v[140:141], v8 offset:50944
  v_mfma_f32_16x16x32_bf16 v[32:35], a[76:79], v[112:115], v[32:35]
  ds_read_b64_tr_b16 v[142:143], v9 offset:50944
  v_mfma_f32_16x16x32_bf16 v[48:51], a[80:83], v[112:115], v[48:51]
  buffer_load_dwordx4 a[184:187], v1, s[8:11], s89 offen offset:3072 sc1
  v_mfma_f32_16x16x32_bf16 v[52:55], a[80:83], v[116:119], v[52:55]
  ds_read_b64_tr_b16 v[112:113], v8 offset:57344
  v_mfma_f32_16x16x32_bf16 v[36:39], a[76:79], v[116:119], v[36:39]
  ds_read_b64_tr_b16 v[114:115], v9 offset:57344
  v_mfma_f32_16x16x32_bf16 v[20:23], a[72:75], v[116:119], v[20:23]
  buffer_load_dwordx4 v1, s[8:11], s28 offen sc1 lds
  s_waitcnt lgkmcnt(10)
  v_mfma_f32_16x16x32_bf16 v[24:27], a[72:75], v[120:123], v[24:27]
  ds_read_b64_tr_b16 v[116:117], v8 offset:57600
  v_mfma_f32_16x16x32_bf16 v[40:43], a[76:79], v[120:123], v[40:43]
  ds_read_b64_tr_b16 v[118:119], v9 offset:57600
  v_mfma_f32_16x16x32_bf16 v[56:59], a[80:83], v[120:123], v[56:59]
  v_mfma_f32_16x16x32_bf16 v[60:63], a[80:83], v[124:127], v[60:63]
  ds_read_b64_tr_b16 v[120:121], v8 offset:58368
  v_mfma_f32_16x16x32_bf16 v[44:47], a[76:79], v[124:127], v[44:47]
  ds_read_b64_tr_b16 v[122:123], v9 offset:58368
  v_mfma_f32_16x16x32_bf16 v[28:31], a[72:75], v[124:127], v[28:31]
  buffer_load_dwordx4 v1, s[8:11], s28 offen offset:1024 sc1 lds
  s_waitcnt lgkmcnt(10)
  v_mfma_f32_16x16x32_bf16 v[64:67], a[72:75], v[128:131], v[64:67]
  ds_read_b64_tr_b16 v[124:125], v8 offset:58624
  s_add_u32 m0, m0, 8192
  v_mfma_f32_16x16x32_bf16 v[80:83], a[76:79], v[128:131], v[80:83]
  ds_read_b64_tr_b16 v[126:127], v9 offset:58624
  s_add_u32 s28, s28, 8192
  v_mfma_f32_16x16x32_bf16 v[96:99], a[80:83], v[128:131], v[96:99]
  buffer_load_dwordx4 a[188:191], v12, s[8:11], s90 offen offset:3072 sc1
  v_mfma_f32_16x16x32_bf16 v[100:103], a[80:83], v[132:135], v[100:103]
  ds_read_b64_tr_b16 v[128:129], v8 offset:57856
  s_add_u32 s91, s32, 29360128
  v_mfma_f32_16x16x32_bf16 v[84:87], a[76:79], v[132:135], v[84:87]
  ds_read_b64_tr_b16 v[130:131], v9 offset:57856
  v_mfma_f32_16x16x32_bf16 v[68:71], a[72:75], v[132:135], v[68:71]
  s_waitcnt lgkmcnt(10)
  v_mfma_f32_16x16x32_bf16 v[72:75], a[72:75], v[136:139], v[72:75]
  ds_read_b64_tr_b16 v[132:133], v8 offset:58112
  v_mfma_f32_16x16x32_bf16 v[88:91], a[76:79], v[136:139], v[88:91]
  ds_read_b64_tr_b16 v[134:135], v9 offset:58112
  v_mfma_f32_16x16x32_bf16 v[104:107], a[80:83], v[136:139], v[104:107]
  buffer_load_dwordx4 v[144:147], v6, s[8:11], s91 offen offset:0 sc1
  v_mfma_f32_16x16x32_bf16 v[108:111], a[80:83], v[140:143], v[108:111]
  ds_read_b64_tr_b16 v[136:137], v8 offset:58880
  v_mfma_f32_16x16x32_bf16 v[92:95], a[76:79], v[140:143], v[92:95]
  ds_read_b64_tr_b16 v[138:139], v9 offset:58880
  v_mfma_f32_16x16x32_bf16 v[76:79], a[72:75], v[140:143], v[76:79]
  buffer_load_dwordx4 v1, s[8:11], s28 offen sc1 lds
  s_waitcnt lgkmcnt(10)
  v_mfma_f32_16x16x32_bf16 v[16:19], a[84:87], v[112:115], v[16:19]
  ds_read_b64_tr_b16 v[140:141], v8 offset:59136
  v_mfma_f32_16x16x32_bf16 v[32:35], a[88:91], v[112:115], v[32:35]
  ds_read_b64_tr_b16 v[142:143], v9 offset:59136
  v_mfma_f32_16x16x32_bf16 v[48:51], a[92:95], v[112:115], v[48:51]
  s_waitcnt vmcnt(11)
  s_barrier
  v_mfma_f32_16x16x32_bf16 v[52:55], a[92:95], v[116:119], v[52:55]
  ds_read_b64_tr_b16 v[112:113], v10 offset:0
  v_mfma_f32_16x16x32_bf16 v[36:39], a[88:91], v[116:119], v[36:39]
  ds_read_b64_tr_b16 v[114:115], v11 offset:0
  v_mfma_f32_16x16x32_bf16 v[20:23], a[84:87], v[116:119], v[20:23]
  buffer_load_dwordx4 v1, s[8:11], s28 offen offset:1024 sc1 lds
  s_waitcnt lgkmcnt(10)
  v_mfma_f32_16x16x32_bf16 v[24:27], a[84:87], v[120:123], v[24:27]
  ds_read_b64_tr_b16 v[116:117], v10 offset:256
  s_add_u32 m0, m0, 8192
  v_mfma_f32_16x16x32_bf16 v[40:43], a[88:91], v[120:123], v[40:43]
  ds_read_b64_tr_b16 v[118:119], v11 offset:256
  s_add_u32 s28, s28, 8192
  v_mfma_f32_16x16x32_bf16 v[56:59], a[92:95], v[120:123], v[56:59]
  buffer_load_dwordx4 v[148:151], v6, s[8:11], s91 offen offset:256 sc1
  v_mfma_f32_16x16x32_bf16 v[60:63], a[92:95], v[124:127], v[60:63]
  ds_read_b64_tr_b16 v[120:121], v10 offset:1024
  v_mfma_f32_16x16x32_bf16 v[44:47], a[88:91], v[124:127], v[44:47]
  ds_read_b64_tr_b16 v[122:123], v11 offset:1024
  v_mfma_f32_16x16x32_bf16 v[28:31], a[84:87], v[124:127], v[28:31]
  s_waitcnt lgkmcnt(10)
  v_mfma_f32_16x16x32_bf16 v[64:67], a[84:87], v[128:131], v[64:67]
  ds_read_b64_tr_b16 v[124:125], v10 offset:1280
  v_mfma_f32_16x16x32_bf16 v[80:83], a[88:91], v[128:131], v[80:83]
  ds_read_b64_tr_b16 v[126:127], v11 offset:1280
  v_mfma_f32_16x16x32_bf16 v[96:99], a[92:95], v[128:131], v[96:99]
  buffer_load_dwordx4 v[152:155], v6, s[8:11], s91 offen offset:512 sc1
  v_mfma_f32_16x16x32_bf16 v[100:103], a[92:95], v[132:135], v[100:103]
  ds_read_b64_tr_b16 v[128:129], v10 offset:8192
  v_mfma_f32_16x16x32_bf16 v[84:87], a[88:91], v[132:135], v[84:87]
  ds_read_b64_tr_b16 v[130:131], v11 offset:8192
  v_mfma_f32_16x16x32_bf16 v[68:71], a[84:87], v[132:135], v[68:71]
  buffer_load_dwordx4 v1, s[8:11], s28 offen sc1 lds
  s_waitcnt lgkmcnt(10)
  v_mfma_f32_16x16x32_bf16 v[72:75], a[84:87], v[136:139], v[72:75]
  ds_read_b64_tr_b16 v[132:133], v10 offset:8448
  v_mfma_f32_16x16x32_bf16 v[88:91], a[88:91], v[136:139], v[88:91]
  ds_read_b64_tr_b16 v[134:135], v11 offset:8448
  v_mfma_f32_16x16x32_bf16 v[104:107], a[92:95], v[136:139], v[104:107]
  v_mfma_f32_16x16x32_bf16 v[108:111], a[92:95], v[140:143], v[108:111]
  ds_read_b64_tr_b16 v[136:137], v10 offset:9216
  v_mfma_f32_16x16x32_bf16 v[92:95], a[88:91], v[140:143], v[92:95]
  ds_read_b64_tr_b16 v[138:139], v11 offset:9216
  v_mfma_f32_16x16x32_bf16 v[76:79], a[84:87], v[140:143], v[76:79]
  buffer_load_dwordx4 v1, s[8:11], s28 offen offset:1024 sc1 lds
  s_waitcnt lgkmcnt(10)
  v_mfma_f32_16x16x32_bf16 v[16:19], a[96:99], v[112:115], v[16:19]
  ds_read_b64_tr_b16 v[140:141], v10 offset:9472
  s_add_u32 m0, m0, 8192
  v_mfma_f32_16x16x32_bf16 v[32:35], a[100:103], v[112:115], v[32:35]
  ds_read_b64_tr_b16 v[142:143], v11 offset:9472
  s_add_u32 s28, s28, 8192
  v_mfma_f32_16x16x32_bf16 v[48:51], a[104:107], v[112:115], v[48:51]
  buffer_load_dwordx4 v[156:159], v6, s[8:11], s91 offen offset:768 sc1
  v_mfma_f32_16x16x32_bf16 v[52:55], a[104:107], v[116:119], v[52:55]
  ds_read_b64_tr_b16 v[112:113], v10 offset:16384
  s_add_u32 s91, s32, 29364224
  v_mfma_f32_16x16x32_bf16 v[36:39], a[100:103], v[116:119], v[36:39]
  ds_read_b64_tr_b16 v[114:115], v11 offset:16384
  v_mfma_f32_16x16x32_bf16 v[20:23], a[96:99], v[116:119], v[20:23]
  s_waitcnt lgkmcnt(10)
  v_mfma_f32_16x16x32_bf16 v[24:27], a[96:99], v[120:123], v[24:27]
  ds_read_b64_tr_b16 v[116:117], v10 offset:16640
  v_mfma_f32_16x16x32_bf16 v[40:43], a[100:103], v[120:123], v[40:43]
  ds_read_b64_tr_b16 v[118:119], v11 offset:16640
  v_mfma_f32_16x16x32_bf16 v[56:59], a[104:107], v[120:123], v[56:59]
  buffer_load_dwordx4 v[160:163], v6, s[8:11], s91 offen offset:0 sc1
  v_mfma_f32_16x16x32_bf16 v[60:63], a[104:107], v[124:127], v[60:63]
  ds_read_b64_tr_b16 v[120:121], v10 offset:17408
  v_mfma_f32_16x16x32_bf16 v[44:47], a[100:103], v[124:127], v[44:47]
  ds_read_b64_tr_b16 v[122:123], v11 offset:17408
  v_mfma_f32_16x16x32_bf16 v[28:31], a[96:99], v[124:127], v[28:31]
  buffer_load_dwordx4 v[164:167], v6, s[8:11], s91 offen offset:256 sc1
  s_waitcnt lgkmcnt(10)
  v_mfma_f32_16x16x32_bf16 v[16:19], a[108:111], v[128:131], v[16:19]
  ds_read_b64_tr_b16 v[124:125], v10 offset:17664
  v_mfma_f32_16x16x32_bf16 v[32:35], a[112:115], v[128:131], v[32:35]
  ds_read_b64_tr_b16 v[126:127], v11 offset:17664
  v_mfma_f32_16x16x32_bf16 v[48:51], a[116:119], v[128:131], v[48:51]
  v_mfma_f32_16x16x32_bf16 v[52:55], a[116:119], v[132:135], v[52:55]
  ds_read_b64_tr_b16 v[128:129], v10 offset:24576
  v_mfma_f32_16x16x32_bf16 v[36:39], a[112:115], v[132:135], v[36:39]
  ds_read_b64_tr_b16 v[130:131], v11 offset:24576
  v_mfma_f32_16x16x32_bf16 v[20:23], a[108:111], v[132:135], v[20:23]
  buffer_load_dwordx4 v[168:171], v6, s[8:11], s91 offen offset:512 sc1
  s_waitcnt lgkmcnt(10)
  v_mfma_f32_16x16x32_bf16 v[24:27], a[108:111], v[136:139], v[24:27]
  ds_read_b64_tr_b16 v[132:133], v10 offset:24832
  v_mfma_f32_16x16x32_bf16 v[40:43], a[112:115], v[136:139], v[40:43]
  ds_read_b64_tr_b16 v[134:135], v11 offset:24832
  v_mfma_f32_16x16x32_bf16 v[56:59], a[116:119], v[136:139], v[56:59]
  buffer_load_dwordx4 v[172:175], v6, s[8:11], s91 offen offset:768 sc1
  v_mfma_f32_16x16x32_bf16 v[60:63], a[116:119], v[140:143], v[60:63]
  ds_read_b64_tr_b16 v[136:137], v10 offset:25600
  s_add_u32 s91, s32, 29368320
  v_mfma_f32_16x16x32_bf16 v[44:47], a[112:115], v[140:143], v[44:47]
  ds_read_b64_tr_b16 v[138:139], v11 offset:25600
  v_mfma_f32_16x16x32_bf16 v[28:31], a[108:111], v[140:143], v[28:31]
  s_waitcnt lgkmcnt(10)
  v_mfma_f32_16x16x32_bf16 v[16:19], a[120:123], v[112:115], v[16:19]
  ds_read_b64_tr_b16 v[140:141], v10 offset:25856
  v_mfma_f32_16x16x32_bf16 v[32:35], a[124:127], v[112:115], v[32:35]
  ds_read_b64_tr_b16 v[142:143], v11 offset:25856
  v_mfma_f32_16x16x32_bf16 v[48:51], a[128:131], v[112:115], v[48:51]
  buffer_load_dwordx4 v[176:179], v6, s[8:11], s91 offen offset:0 sc1
  s_waitcnt vmcnt(14)
  s_barrier
  v_mfma_f32_16x16x32_bf16 v[52:55], a[128:131], v[116:119], v[52:55]
  ds_read_b64_tr_b16 v[112:113], v10 offset:32768
  v_mfma_f32_16x16x32_bf16 v[36:39], a[124:127], v[116:119], v[36:39]
  ds_read_b64_tr_b16 v[114:115], v11 offset:32768
  v_mfma_f32_16x16x32_bf16 v[20:23], a[120:123], v[116:119], v[20:23]
  buffer_load_dwordx4 v[180:183], v6, s[8:11], s91 offen offset:256 sc1
  s_waitcnt lgkmcnt(10)
  v_mfma_f32_16x16x32_bf16 v[24:27], a[120:123], v[120:123], v[24:27]
  ds_read_b64_tr_b16 v[116:117], v10 offset:33024
  v_mfma_f32_16x16x32_bf16 v[40:43], a[124:127], v[120:123], v[40:43]
  ds_read_b64_tr_b16 v[118:119], v11 offset:33024
  v_mfma_f32_16x16x32_bf16 v[56:59], a[128:131], v[120:123], v[56:59]
  v_mfma_f32_16x16x32_bf16 v[60:63], a[128:131], v[124:127], v[60:63]
  ds_read_b64_tr_b16 v[120:121], v10 offset:33792
  v_mfma_f32_16x16x32_bf16 v[44:47], a[124:127], v[124:127], v[44:47]
  ds_read_b64_tr_b16 v[122:123], v11 offset:33792
  v_mfma_f32_16x16x32_bf16 v[28:31], a[120:123], v[124:127], v[28:31]
  buffer_load_dwordx4 v[184:187], v6, s[8:11], s91 offen offset:512 sc1
  s_waitcnt lgkmcnt(10)
  v_mfma_f32_16x16x32_bf16 v[16:19], a[132:135], v[128:131], v[16:19]
  ds_read_b64_tr_b16 v[124:125], v10 offset:34048
  v_mfma_f32_16x16x32_bf16 v[32:35], a[136:139], v[128:131], v[32:35]
  ds_read_b64_tr_b16 v[126:127], v11 offset:34048
  v_mfma_f32_16x16x32_bf16 v[48:51], a[140:143], v[128:131], v[48:51]
  buffer_load_dwordx4 v[188:191], v6, s[8:11], s91 offen offset:768 sc1
  v_mfma_f32_16x16x32_bf16 v[52:55], a[140:143], v[132:135], v[52:55]
  ds_read_b64_tr_b16 v[128:129], v10 offset:40960
  s_add_u32 s91, s32, 29372416
  v_mfma_f32_16x16x32_bf16 v[36:39], a[136:139], v[132:135], v[36:39]
  ds_read_b64_tr_b16 v[130:131], v11 offset:40960
  v_mfma_f32_16x16x32_bf16 v[20:23], a[132:135], v[132:135], v[20:23]
  s_waitcnt lgkmcnt(10)
  v_mfma_f32_16x16x32_bf16 v[24:27], a[132:135], v[136:139], v[24:27]
  ds_read_b64_tr_b16 v[132:133], v10 offset:41216
  v_mfma_f32_16x16x32_bf16 v[40:43], a[136:139], v[136:139], v[40:43]
  ds_read_b64_tr_b16 v[134:135], v11 offset:41216
  v_mfma_f32_16x16x32_bf16 v[56:59], a[140:143], v[136:139], v[56:59]
  buffer_load_dwordx4 v[192:195], v6, s[8:11], s91 offen offset:0 sc1
  v_mfma_f32_16x16x32_bf16 v[60:63], a[140:143], v[140:143], v[60:63]
  ds_read_b64_tr_b16 v[136:137], v10 offset:41984
  v_mfma_f32_16x16x32_bf16 v[44:47], a[136:139], v[140:143], v[44:47]
  ds_read_b64_tr_b16 v[138:139], v11 offset:41984
  v_mfma_f32_16x16x32_bf16 v[28:31], a[132:135], v[140:143], v[28:31]
  s_waitcnt lgkmcnt(10)
  v_mfma_f32_16x16x32_bf16 v[16:19], a[144:147], v[112:115], v[16:19]
  ds_read_b64_tr_b16 v[140:141], v10 offset:42240
  v_mfma_f32_16x16x32_bf16 v[32:35], a[148:151], v[112:115], v[32:35]
  ds_read_b64_tr_b16 v[142:143], v11 offset:42240
  v_mfma_f32_16x16x32_bf16 v[48:51], a[152:155], v[112:115], v[48:51]
  buffer_load_dwordx4 v[196:199], v6, s[8:11], s91 offen offset:256 sc1
  s_waitcnt vmcnt(15)
  s_barrier
  v_mfma_f32_16x16x32_bf16 v[52:55], a[152:155], v[116:119], v[52:55]
  ds_read_b64_tr_b16 v[112:113], v10 offset:49152
  v_mfma_f32_16x16x32_bf16 v[36:39], a[148:151], v[116:119], v[36:39]
  ds_read_b64_tr_b16 v[114:115], v11 offset:49152
  v_mfma_f32_16x16x32_bf16 v[20:23], a[144:147], v[116:119], v[20:23]
  buffer_load_dwordx4 v[200:203], v6, s[8:11], s91 offen offset:512 sc1
  s_waitcnt lgkmcnt(10)
  v_mfma_f32_16x16x32_bf16 v[24:27], a[144:147], v[120:123], v[24:27]
  ds_read_b64_tr_b16 v[116:117], v10 offset:49408
Lstub3:
  s_cbranch_execz Lret3_1906
  v_mfma_f32_16x16x32_bf16 v[40:43], a[148:151], v[120:123], v[40:43]
  ds_read_b64_tr_b16 v[118:119], v11 offset:49408
  v_mfma_f32_16x16x32_bf16 v[56:59], a[152:155], v[120:123], v[56:59]
  v_mfma_f32_16x16x32_bf16 v[60:63], a[152:155], v[124:127], v[60:63]
  ds_read_b64_tr_b16 v[120:121], v10 offset:50176
  v_mfma_f32_16x16x32_bf16 v[44:47], a[148:151], v[124:127], v[44:47]
  ds_read_b64_tr_b16 v[122:123], v11 offset:50176
  v_mfma_f32_16x16x32_bf16 v[28:31], a[144:147], v[124:127], v[28:31]
  buffer_load_dwordx4 v[204:207], v6, s[8:11], s91 offen offset:768 sc1
  s_waitcnt lgkmcnt(10)
  v_mfma_f32_16x16x32_bf16 v[16:19], a[156:159], v[128:131], v[16:19]
  ds_read_b64_tr_b16 v[124:125], v10 offset:50432
  s_add_u32 s91, s32, 29376512
  v_mfma_f32_16x16x32_bf16 v[32:35], a[160:163], v[128:131], v[32:35]
  ds_read_b64_tr_b16 v[126:127], v11 offset:50432
  v_mfma_f32_16x16x32_bf16 v[48:51], a[164:167], v[128:131], v[48:51]
  buffer_load_dwordx4 v[208:211], v6, s[8:11], s91 offen offset:0 sc1
  s_waitcnt vmcnt(14)
  s_barrier
  v_mfma_f32_16x16x32_bf16 v[52:55], a[164:167], v[132:135], v[52:55]
  ds_read_b64_tr_b16 v[128:129], v10 offset:57344
  v_mfma_f32_16x16x32_bf16 v[36:39], a[160:163], v[132:135], v[36:39]
  ds_read_b64_tr_b16 v[130:131], v11 offset:57344
  v_mfma_f32_16x16x32_bf16 v[20:23], a[156:159], v[132:135], v[20:23]
  s_waitcnt lgkmcnt(10)
  v_mfma_f32_16x16x32_bf16 v[24:27], a[156:159], v[136:139], v[24:27]
  ds_read_b64_tr_b16 v[132:133], v10 offset:57600
  v_mfma_f32_16x16x32_bf16 v[40:43], a[160:163], v[136:139], v[40:43]
  ds_read_b64_tr_b16 v[134:135], v11 offset:57600
  v_mfma_f32_16x16x32_bf16 v[56:59], a[164:167], v[136:139], v[56:59]
  buffer_load_dwordx4 v[212:215], v6, s[8:11], s91 offen offset:256 sc1
  v_mfma_f32_16x16x32_bf16 v[60:63], a[164:167], v[140:143], v[60:63]
  ds_read_b64_tr_b16 v[136:137], v10 offset:58368
  v_mfma_f32_16x16x32_bf16 v[44:47], a[160:163], v[140:143], v[44:47]
  ds_read_b64_tr_b16 v[138:139], v11 offset:58368
  v_mfma_f32_16x16x32_bf16 v[28:31], a[156:159], v[140:143], v[28:31]
  buffer_load_dwordx4 v[216:219], v6, s[8:11], s91 offen offset:512 sc1
  s_waitcnt lgkmcnt(10)
  v_mfma_f32_16x16x32_bf16 v[16:19], a[168:171], v[112:115], v[16:19]
  ds_read_b64_tr_b16 v[140:141], v10 offset:58624
  v_mfma_f32_16x16x32_bf16 v[32:35], a[172:175], v[112:115], v[32:35]
  ds_read_b64_tr_b16 v[142:143], v11 offset:58624
  v_mfma_f32_16x16x32_bf16 v[48:51], a[176:179], v[112:115], v[48:51]
  v_mfma_f32_16x16x32_bf16 v[52:55], a[176:179], v[116:119], v[52:55]
  ds_read_b64_tr_b16 v[112:113], v10 offset:512
  v_mfma_f32_16x16x32_bf16 v[36:39], a[172:175], v[116:119], v[36:39]
  ds_read_b64_tr_b16 v[114:115], v11 offset:512
  v_mfma_f32_16x16x32_bf16 v[20:23], a[168:171], v[116:119], v[20:23]
  buffer_load_dwordx4 v[220:223], v6, s[8:11], s91 offen offset:768 sc1
  s_waitcnt lgkmcnt(10)
  v_mfma_f32_16x16x32_bf16 v[24:27], a[168:171], v[120:123], v[24:27]
  ds_read_b64_tr_b16 v[116:117], v10 offset:768
  s_add_u32 s91, s32, 29380608
  v_mfma_f32_16x16x32_bf16 v[40:43], a[172:175], v[120:123], v[40:43]
  ds_read_b64_tr_b16 v[118:119], v11 offset:768
  v_mfma_f32_16x16x32_bf16 v[56:59], a[176:179], v[120:123], v[56:59]
  buffer_load_dwordx4 v[224:227], v6, s[8:11], s91 offen offset:0 sc1
  v_mfma_f32_16x16x32_bf16 v[60:63], a[176:179], v[124:127], v[60:63]
  ds_read_b64_tr_b16 v[120:121], v10 offset:1536
  v_mfma_f32_16x16x32_bf16 v[44:47], a[172:175], v[124:127], v[44:47]
  ds_read_b64_tr_b16 v[122:123], v11 offset:1536
  v_mfma_f32_16x16x32_bf16 v[28:31], a[168:171], v[124:127], v[28:31]
  s_waitcnt lgkmcnt(10)
  v_mfma_f32_16x16x32_bf16 v[16:19], a[180:183], v[128:131], v[16:19]
  ds_read_b64_tr_b16 v[124:125], v10 offset:1792
  v_mfma_f32_16x16x32_bf16 v[32:35], a[184:187], v[128:131], v[32:35]
  ds_read_b64_tr_b16 v[126:127], v11 offset:1792
  v_mfma_f32_16x16x32_bf16 v[48:51], a[188:191], v[128:131], v[48:51]
  buffer_load_dwordx4 v[228:231], v6, s[8:11], s91 offen offset:256 sc1
  v_mfma_f32_16x16x32_bf16 v[52:55], a[188:191], v[132:135], v[52:55]
  ds_read_b64_tr_b16 v[128:129], v10 offset:8704
  v_mfma_f32_16x16x32_bf16 v[36:39], a[184:187], v[132:135], v[36:39]
  ds_read_b64_tr_b16 v[130:131], v11 offset:8704
  v_mfma_f32_16x16x32_bf16 v[20:23], a[180:183], v[132:135], v[20:23]
  buffer_load_dwordx4 v[232:235], v6, s[8:11], s91 offen offset:512 sc1
  s_waitcnt lgkmcnt(10)
  v_mfma_f32_16x16x32_bf16 v[24:27], a[180:183], v[136:139], v[24:27]
  ds_read_b64_tr_b16 v[132:133], v10 offset:8960
  v_mfma_f32_16x16x32_bf16 v[40:43], a[184:187], v[136:139], v[40:43]
  ds_read_b64_tr_b16 v[134:135], v11 offset:8960
  v_mfma_f32_16x16x32_bf16 v[56:59], a[188:191], v[136:139], v[56:59]
  v_mfma_f32_16x16x32_bf16 v[60:63], a[188:191], v[140:143], v[60:63]
  ds_read_b64_tr_b16 v[136:137], v10 offset:9728
  v_mfma_f32_16x16x32_bf16 v[44:47], a[184:187], v[140:143], v[44:47]
  ds_read_b64_tr_b16 v[138:139], v11 offset:9728
  v_mfma_f32_16x16x32_bf16 v[28:31], a[180:183], v[140:143], v[28:31]
  buffer_load_dwordx4 v[236:239], v6, s[8:11], s91 offen offset:768 sc1
  s_waitcnt lgkmcnt(10)
  v_mfma_f32_16x16x32_bf16 v[64:67], a[96:99], v[112:115], v[64:67]
  ds_read_b64_tr_b16 v[140:141], v10 offset:9984
  s_add_u32 s91, s32, 29384704
  v_mfma_f32_16x16x32_bf16 v[80:83], a[100:103], v[112:115], v[80:83]
  ds_read_b64_tr_b16 v[142:143], v11 offset:9984
  v_mfma_f32_16x16x32_bf16 v[96:99], a[104:107], v[112:115], v[96:99]
  buffer_load_dwordx4 v[240:243], v6, s[8:11], s91 offen offset:0 sc1
  v_mfma_f32_16x16x32_bf16 v[100:103], a[104:107], v[116:119], v[100:103]
  ds_read_b64_tr_b16 v[112:113], v10 offset:16896
  v_mfma_f32_16x16x32_bf16 v[84:87], a[100:103], v[116:119], v[84:87]
  ds_read_b64_tr_b16 v[114:115], v11 offset:16896
  v_mfma_f32_16x16x32_bf16 v[68:71], a[96:99], v[116:119], v[68:71]
  s_waitcnt lgkmcnt(10)
  v_mfma_f32_16x16x32_bf16 v[72:75], a[96:99], v[120:123], v[72:75]
  ds_read_b64_tr_b16 v[116:117], v10 offset:17152
  v_max_f32 v48, 0, v48
  v_mfma_f32_16x16x32_bf16 v[88:91], a[100:103], v[120:123], v[88:91]
  ds_read_b64_tr_b16 v[118:119], v11 offset:17152
  v_max_f32 v49, 0, v49
  v_mfma_f32_16x16x32_bf16 v[104:107], a[104:107], v[120:123], v[104:107]
  buffer_load_dwordx4 v[244:247], v6, s[8:11], s91 offen offset:256 sc1
  v_mul_f32 v48, v48, v50
  v_mfma_f32_16x16x32_bf16 v[108:111], a[104:107], v[124:127], v[108:111]
  ds_read_b64_tr_b16 v[120:121], v10 offset:17920
  v_mul_f32 v49, v49, v51
  v_mfma_f32_16x16x32_bf16 v[92:95], a[100:103], v[124:127], v[92:95]
  ds_read_b64_tr_b16 v[122:123], v11 offset:17920
  v_cvt_pk_bf16_f32 v48, v48, v49
  v_mfma_f32_16x16x32_bf16 v[76:79], a[96:99], v[124:127], v[76:79]
  buffer_load_dwordx4 v[248:251], v6, s[8:11], s91 offen offset:512 sc1
  v_max_f32 v52, 0, v52
  s_waitcnt lgkmcnt(10)
  v_mfma_f32_16x16x32_bf16 v[64:67], a[108:111], v[128:131], v[64:67]
  ds_read_b64_tr_b16 v[124:125], v10 offset:18176
  v_max_f32 v53, 0, v53
  v_mfma_f32_16x16x32_bf16 v[80:83], a[112:115], v[128:131], v[80:83]
  ds_read_b64_tr_b16 v[126:127], v11 offset:18176
  v_mul_f32 v52, v52, v54
  v_mfma_f32_16x16x32_bf16 v[96:99], a[116:119], v[128:131], v[96:99]
  v_mul_f32 v53, v53, v55
  v_cvt_pk_bf16_f32 v49, v52, v53
  v_mfma_f32_16x16x32_bf16 v[100:103], a[116:119], v[132:135], v[100:103]
  ds_read_b64_tr_b16 v[128:129], v10 offset:25088
  v_max_f32 v56, 0, v56
  v_mfma_f32_16x16x32_bf16 v[84:87], a[112:115], v[132:135], v[84:87]
  ds_read_b64_tr_b16 v[130:131], v11 offset:25088
  v_max_f32 v57, 0, v57
  v_mfma_f32_16x16x32_bf16 v[68:71], a[108:111], v[132:135], v[68:71]
  buffer_load_dwordx4 v[252:255], v6, s[8:11], s91 offen offset:768 sc1
  v_mul_f32 v56, v56, v58
  s_waitcnt lgkmcnt(10)
  v_mfma_f32_16x16x32_bf16 v[72:75], a[108:111], v[136:139], v[72:75]
  ds_read_b64_tr_b16 v[132:133], v10 offset:25344
  s_add_u32 s91, s32, 29388800
  v_mul_f32 v57, v57, v59
  v_mfma_f32_16x16x32_bf16 v[88:91], a[112:115], v[136:139], v[88:91]
  ds_read_b64_tr_b16 v[134:135], v11 offset:25344
  v_cvt_pk_bf16_f32 v50, v56, v57
  v_mfma_f32_16x16x32_bf16 v[104:107], a[116:119], v[136:139], v[104:107]
  buffer_load_dwordx4 a[192:195], v6, s[8:11], s91 offen offset:0 sc1
  v_max_f32 v60, 0, v60
  v_mfma_f32_16x16x32_bf16 v[108:111], a[116:119], v[140:143], v[108:111]
  ds_read_b64_tr_b16 v[136:137], v10 offset:26112
  v_max_f32 v61, 0, v61
  v_mfma_f32_16x16x32_bf16 v[92:95], a[112:115], v[140:143], v[92:95]
  ds_read_b64_tr_b16 v[138:139], v11 offset:26112
  v_mul_f32 v60, v60, v62
  v_mfma_f32_16x16x32_bf16 v[76:79], a[108:111], v[140:143], v[76:79]
  v_mul_f32 v61, v61, v63
  v_cvt_pk_bf16_f32 v51, v60, v61
  s_waitcnt lgkmcnt(10)
  v_mfma_f32_16x16x32_bf16 v[64:67], a[120:123], v[112:115], v[64:67]
  ds_read_b64_tr_b16 v[140:141], v10 offset:26368
  v_permlane32_swap_b32 v48, v50
  v_mfma_f32_16x16x32_bf16 v[80:83], a[124:127], v[112:115], v[80:83]
  ds_read_b64_tr_b16 v[142:143], v11 offset:26368
  v_permlane32_swap_b32 v49, v51
  v_mfma_f32_16x16x32_bf16 v[96:99], a[128:131], v[112:115], v[96:99]
  buffer_load_dwordx4 a[196:199], v6, s[8:11], s91 offen offset:256 sc1
  v_permlane16_swap_b32 v48, v49
  v_mfma_f32_16x16x32_bf16 v[100:103], a[128:131], v[116:119], v[100:103]
  ds_read_b64_tr_b16 v[112:113], v10 offset:33280
  v_permlane16_swap_b32 v50, v51
  v_mfma_f32_16x16x32_bf16 v[84:87], a[124:127], v[116:119], v[84:87]
  ds_read_b64_tr_b16 v[114:115], v11 offset:33280
  buffer_store_dwordx4 v[48:51], v13, s[8:11], s42 offen offset:0 sc1
  v_mfma_f32_16x16x32_bf16 v[68:71], a[120:123], v[116:119], v[68:71]
  buffer_load_dwordx4 a[200:203], v6, s[8:11], s91 offen offset:512 sc1
  v_max_f32 v16, 0, v16
  s_waitcnt lgkmcnt(10)
  v_mfma_f32_16x16x32_bf16 v[72:75], a[120:123], v[120:123], v[72:75]
  ds_read_b64_tr_b16 v[116:117], v10 offset:33536
  v_max_f32 v17, 0, v17
  v_mfma_f32_16x16x32_bf16 v[88:91], a[124:127], v[120:123], v[88:91]
  ds_read_b64_tr_b16 v[118:119], v11 offset:33536
  v_max_f32 v18, 0, v18
  v_mfma_f32_16x16x32_bf16 v[104:107], a[128:131], v[120:123], v[104:107]
  v_max_f32 v19, 0, v19
  v_max_f32 v20, 0, v20
  v_mfma_f32_16x16x32_bf16 v[108:111], a[128:131], v[124:127], v[108:111]
  ds_read_b64_tr_b16 v[120:121], v10 offset:34304
  v_max_f32 v21, 0, v21
  v_mfma_f32_16x16x32_bf16 v[92:95], a[124:127], v[124:127], v[92:95]
  ds_read_b64_tr_b16 v[122:123], v11 offset:34304
  v_max_f32 v22, 0, v22
  v_mfma_f32_16x16x32_bf16 v[76:79], a[120:123], v[124:127], v[76:79]
  buffer_load_dwordx4 a[204:207], v6, s[8:11], s91 offen offset:768 sc1
  v_max_f32 v23, 0, v23
  s_waitcnt lgkmcnt(10)
  v_mfma_f32_16x16x32_bf16 v[64:67], a[132:135], v[128:131], v[64:67]
  ds_read_b64_tr_b16 v[124:125], v10 offset:34560
  s_add_u32 s91, s32, 29392896
  v_max_f32 v24, 0, v24
  v_mfma_f32_16x16x32_bf16 v[80:83], a[136:139], v[128:131], v[80:83]
  ds_read_b64_tr_b16 v[126:127], v11 offset:34560
  v_max_f32 v25, 0, v25
  v_mfma_f32_16x16x32_bf16 v[96:99], a[140:143], v[128:131], v[96:99]
  buffer_load_dwordx4 a[208:211], v6, s[8:11], s91 offen offset:0 sc1
  v_max_f32 v26, 0, v26
  v_mfma_f32_16x16x32_bf16 v[100:103], a[140:143], v[132:135], v[100:103]
  ds_read_b64_tr_b16 v[128:129], v10 offset:41472
  v_max_f32 v27, 0, v27
  v_mfma_f32_16x16x32_bf16 v[84:87], a[136:139], v[132:135], v[84:87]
  ds_read_b64_tr_b16 v[130:131], v11 offset:41472
  v_max_f32 v28, 0, v28
  v_mfma_f32_16x16x32_bf16 v[68:71], a[132:135], v[132:135], v[68:71]
  v_max_f32 v29, 0, v29
  v_max_f32 v30, 0, v30
  s_waitcnt lgkmcnt(10)
  v_mfma_f32_16x16x32_bf16 v[72:75], a[132:135], v[136:139], v[72:75]
  ds_read_b64_tr_b16 v[132:133], v10 offset:41728
  v_max_f32 v31, 0, v31
  v_mfma_f32_16x16x32_bf16 v[88:91], a[136:139], v[136:139], v[88:91]
  ds_read_b64_tr_b16 v[134:135], v11 offset:41728
  v_mul_f32 v16, v16, v32
  v_mfma_f32_16x16x32_bf16 v[104:107], a[140:143], v[136:139], v[104:107]
  buffer_load_dwordx4 a[212:215], v6, s[8:11], s91 offen offset:256 sc1
  v_mul_f32 v17, v17, v33
  v_mfma_f32_16x16x32_bf16 v[108:111], a[140:143], v[140:143], v[108:111]
  ds_read_b64_tr_b16 v[136:137], v10 offset:42496
  v_mul_f32 v18, v18, v34
  v_mfma_f32_16x16x32_bf16 v[92:95], a[136:139], v[140:143], v[92:95]
  ds_read_b64_tr_b16 v[138:139], v11 offset:42496
  v_mul_f32 v19, v19, v35
  v_mfma_f32_16x16x32_bf16 v[76:79], a[132:135], v[140:143], v[76:79]
  buffer_load_dwordx4 a[216:219], v6, s[8:11], s91 offen offset:512 sc1
  v_mul_f32 v20, v20, v36
  s_waitcnt lgkmcnt(10)
  v_mfma_f32_16x16x32_bf16 v[64:67], a[144:147], v[112:115], v[64:67]
  ds_read_b64_tr_b16 v[140:141], v10 offset:42752
  v_mul_f32 v21, v21, v37
  v_mfma_f32_16x16x32_bf16 v[80:83], a[148:151], v[112:115], v[80:83]
  ds_read_b64_tr_b16 v[142:143], v11 offset:42752
  v_mul_f32 v22, v22, v38
  v_mfma_f32_16x16x32_bf16 v[96:99], a[152:155], v[112:115], v[96:99]
  v_mul_f32 v23, v23, v39
  v_cvt_pk_bf16_f32 v32, v16, v17
  v_mfma_f32_16x16x32_bf16 v[100:103], a[152:155], v[116:119], v[100:103]
  ds_read_b64_tr_b16 v[112:113], v10 offset:49664
  v_cvt_pk_bf16_f32 v33, v18, v19
  v_mfma_f32_16x16x32_bf16 v[84:87], a[148:151], v[116:119], v[84:87]
  ds_read_b64_tr_b16 v[114:115], v11 offset:49664
  v_cvt_pk_bf16_f32 v34, v20, v21
  v_mfma_f32_16x16x32_bf16 v[68:71], a[144:147], v[116:119], v[68:71]
  buffer_load_dwordx4 a[220:223], v6, s[8:11], s91 offen offset:768 sc1
  v_cvt_pk_bf16_f32 v35, v22, v23
  s_waitcnt lgkmcnt(10)
  v_mfma_f32_16x16x32_bf16 v[72:75], a[144:147], v[120:123], v[72:75]
  ds_read_b64_tr_b16 v[116:117], v10 offset:49920
  v_permlane16_swap_b32 v32, v34
  v_mfma_f32_16x16x32_bf16 v[88:91], a[148:151], v[120:123], v[88:91]
  ds_read_b64_tr_b16 v[118:119], v11 offset:49920
  v_permlane16_swap_b32 v33, v35
  v_mfma_f32_16x16x32_bf16 v[104:107], a[152:155], v[120:123], v[104:107]
  buffer_store_dwordx4 v[32:35], v5, s[8:11], s40 offen offset:0 sc1
  v_mul_f32 v24, v24, v40
  v_mfma_f32_16x16x32_bf16 v[108:111], a[152:155], v[124:127], v[108:111]
  ds_read_b64_tr_b16 v[120:121], v10 offset:50688
  v_mul_f32 v25, v25, v41
  v_mfma_f32_16x16x32_bf16 v[92:95], a[148:151], v[124:127], v[92:95]
  ds_read_b64_tr_b16 v[122:123], v11 offset:50688
  v_mul_f32 v26, v26, v42
  v_mfma_f32_16x16x32_bf16 v[76:79], a[144:147], v[124:127], v[76:79]
  v_mul_f32 v27, v27, v43
  v_mul_f32 v28, v28, v44
  s_waitcnt lgkmcnt(10)
  v_mfma_f32_16x16x32_bf16 v[64:67], a[156:159], v[128:131], v[64:67]
  ds_read_b64_tr_b16 v[124:125], v10 offset:50944
  v_mul_f32 v29, v29, v45
  v_mfma_f32_16x16x32_bf16 v[80:83], a[160:163], v[128:131], v[80:83]
  ds_read_b64_tr_b16 v[126:127], v11 offset:50944
  v_mul_f32 v30, v30, v46
  v_mfma_f32_16x16x32_bf16 v[96:99], a[164:167], v[128:131], v[96:99]
  v_mul_f32 v31, v31, v47
  v_cvt_pk_bf16_f32 v40, v24, v25
  v_mfma_f32_16x16x32_bf16 v[100:103], a[164:167], v[132:135], v[100:103]
  ds_read_b64_tr_b16 v[128:129], v10 offset:57856
  v_cvt_pk_bf16_f32 v41, v26, v27
  v_mfma_f32_16x16x32_bf16 v[84:87], a[160:163], v[132:135], v[84:87]
  ds_read_b64_tr_b16 v[130:131], v11 offset:57856
  v_cvt_pk_bf16_f32 v42, v28, v29
  v_mfma_f32_16x16x32_bf16 v[68:71], a[156:159], v[132:135], v[68:71]
  v_cvt_pk_bf16_f32 v43, v30, v31
  v_permlane16_swap_b32 v40, v42
  s_waitcnt lgkmcnt(10)
  v_mfma_f32_16x16x32_bf16 v[72:75], a[156:159], v[136:139], v[72:75]
  ds_read_b64_tr_b16 v[132:133], v10 offset:58112
  v_permlane16_swap_b32 v41, v43
  v_mfma_f32_16x16x32_bf16 v[88:91], a[160:163], v[136:139], v[88:91]
  ds_read_b64_tr_b16 v[134:135], v11 offset:58112
  buffer_store_dwordx4 v[40:43], v5, s[8:11], s41 offen offset:0 sc1
  v_mfma_f32_16x16x32_bf16 v[104:107], a[164:167], v[136:139], v[104:107]
  v_mfma_f32_16x16x32_bf16 v[108:111], a[164:167], v[140:143], v[108:111]
  ds_read_b64_tr_b16 v[136:137], v10 offset:58880
  v_mfma_f32_16x16x32_bf16 v[92:95], a[160:163], v[140:143], v[92:95]
  ds_read_b64_tr_b16 v[138:139], v11 offset:58880
  v_mfma_f32_16x16x32_bf16 v[76:79], a[156:159], v[140:143], v[76:79]
  ds_read_b64_tr_b16 v[140:141], v10 offset:59136
  ds_read_b64_tr_b16 v[142:143], v11 offset:59136
  s_waitcnt lgkmcnt(12)
  v_mfma_f32_16x16x32_bf16 v[96:99], a[176:179], v[112:115], v[96:99]
  v_mfma_f32_16x16x32_bf16 v[100:103], a[176:179], v[116:119], v[100:103]
  s_waitcnt lgkmcnt(8)
  v_mfma_f32_16x16x32_bf16 v[104:107], a[176:179], v[120:123], v[104:107]
  v_mfma_f32_16x16x32_bf16 v[108:111], a[176:179], v[124:127], v[108:111]
  s_waitcnt lgkmcnt(4)
  v_mfma_f32_16x16x32_bf16 v[96:99], a[188:191], v[128:131], v[96:99]
  v_mfma_f32_16x16x32_bf16 v[100:103], a[188:191], v[132:135], v[100:103]
  s_waitcnt lgkmcnt(2)
  v_mfma_f32_16x16x32_bf16 v[104:107], a[188:191], v[136:139], v[104:107]
  s_waitcnt lgkmcnt(0)
  v_mfma_f32_16x16x32_bf16 v[108:111], a[188:191], v[140:143], v[108:111]
  v_mfma_f32_16x16x32_bf16 v[64:67], a[168:171], v[112:115], v[64:67]
  v_mfma_f32_16x16x32_bf16 v[68:71], a[168:171], v[116:119], v[68:71]
  v_mfma_f32_16x16x32_bf16 v[72:75], a[168:171], v[120:123], v[72:75]
  v_max_f32 v96, 0, v96
  v_max_f32 v97, 0, v97
  v_mfma_f32_16x16x32_bf16 v[76:79], a[168:171], v[124:127], v[76:79]
  v_mul_f32 v96, v96, v98
  v_mul_f32 v97, v97, v99
  v_mfma_f32_16x16x32_bf16 v[64:67], a[180:183], v[128:131], v[64:67]
  v_cvt_pk_bf16_f32 v96, v96, v97
  v_max_f32 v100, 0, v100
  v_mfma_f32_16x16x32_bf16 v[68:71], a[180:183], v[132:135], v[68:71]
  v_max_f32 v101, 0, v101
  v_mul_f32 v100, v100, v102
  v_mfma_f32_16x16x32_bf16 v[72:75], a[180:183], v[136:139], v[72:75]
  v_mul_f32 v101, v101, v103
  v_cvt_pk_bf16_f32 v97, v100, v101
  v_mfma_f32_16x16x32_bf16 v[76:79], a[180:183], v[140:143], v[76:79]
  v_max_f32 v104, 0, v104
  v_max_f32 v105, 0, v105
  v_mfma_f32_16x16x32_bf16 v[80:83], a[172:175], v[112:115], v[80:83]
  v_mul_f32 v104, v104, v106
  v_mul_f32 v105, v105, v107
  v_mfma_f32_16x16x32_bf16 v[84:87], a[172:175], v[116:119], v[84:87]
  v_cvt_pk_bf16_f32 v98, v104, v105
  v_max_f32 v108, 0, v108
  v_mfma_f32_16x16x32_bf16 v[88:91], a[172:175], v[120:123], v[88:91]
  v_max_f32 v109, 0, v109
  v_mul_f32 v108, v108, v110
  v_mfma_f32_16x16x32_bf16 v[92:95], a[172:175], v[124:127], v[92:95]
  v_mul_f32 v109, v109, v111
  v_cvt_pk_bf16_f32 v99, v108, v109
  v_mfma_f32_16x16x32_bf16 v[80:83], a[184:187], v[128:131], v[80:83]
  v_permlane32_swap_b32 v96, v98
  v_permlane32_swap_b32 v97, v99
  v_mfma_f32_16x16x32_bf16 v[84:87], a[184:187], v[132:135], v[84:87]
  s_nop 0
  v_permlane16_swap_b32 v96, v97
  v_permlane16_swap_b32 v98, v99
  v_mfma_f32_16x16x32_bf16 v[88:91], a[184:187], v[136:139], v[88:91]
  buffer_store_dwordx4 v[96:99], v13, s[8:11], s42 offen offset:512 sc1
  v_max_f32 v64, 0, v64
  v_mfma_f32_16x16x32_bf16 v[92:95], a[184:187], v[140:143], v[92:95]
  v_max_f32 v65, 0, v65
  v_max_f32 v66, 0, v66
  v_max_f32 v67, 0, v67
  v_max_f32 v68, 0, v68
  v_max_f32 v69, 0, v69
  v_max_f32 v70, 0, v70
  v_max_f32 v71, 0, v71
  v_max_f32 v72, 0, v72
  v_max_f32 v73, 0, v73
  v_max_f32 v74, 0, v74
  v_max_f32 v75, 0, v75
  v_max_f32 v76, 0, v76
  v_max_f32 v77, 0, v77
  v_max_f32 v78, 0, v78
  v_max_f32 v79, 0, v79
  v_pk_mul_f32 v[64:65], v[64:65], v[80:81]
  v_pk_mul_f32 v[66:67], v[66:67], v[82:83]
  v_pk_mul_f32 v[68:69], v[68:69], v[84:85]
  v_pk_mul_f32 v[70:71], v[70:71], v[86:87]
  v_cvt_pk_bf16_f32 v80, v64, v65
  v_cvt_pk_bf16_f32 v81, v66, v67
  v_cvt_pk_bf16_f32 v82, v68, v69
  v_cvt_pk_bf16_f32 v83, v70, v71
  v_pk_mul_f32 v[72:73], v[72:73], v[88:89]
  v_pk_mul_f32 v[74:75], v[74:75], v[90:91]
  v_permlane16_swap_b32 v80, v82
  v_permlane16_swap_b32 v81, v83
  v_pk_mul_f32 v[76:77], v[76:77], v[92:93]
  v_pk_mul_f32 v[78:79], v[78:79], v[94:95]
  buffer_store_dwordx4 v[80:83], v5, s[8:11], s40 offen offset:512 sc1
  v_cvt_pk_bf16_f32 v88, v72, v73
  v_cvt_pk_bf16_f32 v89, v74, v75
  v_cvt_pk_bf16_f32 v90, v76, v77
  v_cvt_pk_bf16_f32 v91, v78, v79
  s_nop 0
  v_permlane16_swap_b32 v88, v90
  v_permlane16_swap_b32 v89, v91
  buffer_store_dwordx4 v[88:91], v5, s[8:11], s41 offen offset:512 sc1
G1_END0:
  s_mov_b32 s95, s24
  v_mov_b32 v4, 1
  v_mul_u32_u24 v5, 67584, v0
  s_mul_i32 s4, s53, 4224
  s_add_u32 s4, s4, 38660096
  s_cmp_lg_u32 s3, 0
  s_waitcnt vmcnt(0) lgkmcnt(0)
  s_barrier
  s_cbranch_scc1 Larr_16
  s_mov_b64 exec, 1
  buffer_atomic_add v4, v5, s[8:11], s4 offen sc1
  s_mov_b64 exec, -1
Larr_16:
  s_add_u32 s91, s32, 29396992
  buffer_load_dwordx4 a[224:227], v6, s[8:11], s91 offen offset:0 sc1
  buffer_load_dwordx4 a[228:231], v6, s[8:11], s91 offen offset:256 sc1
  buffer_load_dwordx4 a[232:235], v6, s[8:11], s91 offen offset:512 sc1
  buffer_load_dwordx4 a[236:239], v6, s[8:11], s91 offen offset:768 sc1
  s_add_u32 s91, s33, 29401088
  buffer_load_dwordx4 a[240:243], v6, s[8:11], s91 offen offset:0 sc1
  buffer_load_dwordx4 a[244:247], v6, s[8:11], s91 offen offset:256 sc1
  buffer_load_dwordx4 a[248:251], v6, s[8:11], s91 offen offset:512 sc1
  buffer_load_dwordx4 a[252:255], v6, s[8:11], s91 offen offset:768 sc1
  v_lshrrev_b32 v8, 3, v2
  v_lshlrev_b32 v9, 1, v8
  v_bfe_u32 v10, v2, 1, 2
  v_xor_b32 v9, v9, v10
  v_lshlrev_b32 v8, 11, v8
  v_lshl_add_u32 v8, v9, 6, v8
  v_lshl_add_u32 v8, v3, 4, v8
  v_and_b32 v9, 1, v2
  v_lshl_add_u32 v8, v9, 3, v8
  s_and_b32 s6, s55, 1
  s_lshl_b32 s6, s6, 10
  s_lshl_b32 s7, s3, 8
  s_add_u32 s6, s6, s7
  s_lshl_b32 s7, s56, 14
  s_add_u32 s31, s7, s6
  v_add_u32 v8, s31, v8
  s_lshl_b32 s24, s53, 17
  s_add_u32 s24, s24, 4194304
  s_add_u32 s25, s24, 4096
  s_add_u32 s26, s24, 8192
  s_add_u32 s30, s24, 12288
  s_cmp_lt_u32 s56, 4
  s_cselect_b32 s27, 65536, 0
  v_lshlrev_b32 v9, 4, v3
  s_lshl_b32 s7, s56, 6
  v_add_u32 v10, s7, v2
  v_cmp_ne_u32 vcc, 1, v10
  s_nop 1
  v_cndmask_b32 v10, 0, 1.0, vcc
  s_lshl_b32 s28, s55, 8
  s_lshl_b32 s7, s3, 6
  s_add_u32 s28, s28, s7
  s_add_u32 s29, s28, 33570816
  s_add_u32 s28, s28, 33562624
  s_cmp_eq_u32 s3, 3
  s_cselect_b32 s1, 46137344, s34
  s_xor_b32 s4, s3, 0
  s_mul_i32 s0, s4, 12288
  s_add_u32 s0, s0, s27
  s_lshl_b32 s4, s4, 8
  v_add_u32 v7, s4, v6
  s_xor_b32 s4, s3, 1
  s_mul_i32 s48, s4, 12288
  s_add_u32 s48, s48, s27
  s_lshl_b32 s4, s4, 8
  v_add_u32 v13, s4, v6
  s_xor_b32 s4, s3, 2
  s_mul_i32 s49, s4, 12288
  s_add_u32 s49, s49, s27
  s_lshl_b32 s4, s4, 8
  v_add_u32 v14, s4, v6
  s_xor_b32 s4, s3, 3
  s_mul_i32 s50, s4, 12288
  s_add_u32 s50, s50, s27
  s_lshl_b32 s4, s4, 8
  v_add_u32 v15, s4, v6
  s_add_u32 s91, s34, 10485760
  s_cmp_lg_u32 s3, 1
  s_cbranch_scc1 Lnt4_3003
  s_mov_b64 exec, 0
  s_branch Lstub4
Lret4_3003:
  s_mov_b64 exec, -1
Lnt4_3003:
  s_cmp_lg_u32 s3, 0
  s_cbranch_scc1 Lwait_17
  v_mul_u32_u24 v5, 4224, v0
  s_sleep 4
  s_mov_b64 exec, 1
  s_mul_i32 s4, s53, 4224
  s_add_u32 s4, s4, 38660096
  s_mov_b32 s7, 0x100000
Lpoll_18:
  buffer_load_dword v4, v5, s[8:11], s4 offen sc1
  s_sub_u32 s7, s7, 1
  s_cbranch_scc1 Ldone_19
  s_waitcnt vmcnt(0)
  v_cmp_gt_u32 vcc, 16, v4
  s_cbranch_vccnz Lpoll_18
Ldone_19:
  s_mov_b64 exec, -1
Lwait_17:
  s_barrier
  buffer_load_dwordx4 v[80:83], v13, s[8:11], s91 offen sc1
  s_add_u32 s91, s34, 10489856
  buffer_load_dwordx4 v[84:87], v13, s[8:11], s91 offen sc1
  s_add_u32 s91, s34, 10493952
  buffer_load_dwordx4 v[88:91], v13, s[8:11], s91 offen sc1
  s_add_u32 s91, s34, 10498048
  buffer_load_dwordx4 v[92:95], v13, s[8:11], s91 offen sc1
  s_add_u32 s91, s34, 10502144
  buffer_load_dwordx4 v[96:99], v13, s[8:11], s91 offen sc1
  s_add_u32 s91, s34, 10506240
  buffer_load_dwordx4 v[100:103], v13, s[8:11], s91 offen sc1
  s_add_u32 s91, s34, 10510336
  buffer_load_dwordx4 v[104:107], v13, s[8:11], s91 offen sc1
  s_add_u32 s91, s34, 10514432
  buffer_load_dwordx4 v[108:111], v13, s[8:11], s91 offen sc1
  s_add_u32 s91, s34, 10518528
  buffer_load_dwordx4 v[112:115], v13, s[8:11], s91 offen sc1
  s_add_u32 s91, s34, 10522624
  buffer_load_dwordx4 v[116:119], v13, s[8:11], s91 offen sc1
  s_add_u32 s91, s1, 10526720
  s_waitcnt vmcnt(9)
  v_mfma_f32_16x16x32_bf16 v[32:35], v[80:83], v[144:147], 0
  buffer_load_dwordx4 v[120:123], v13, s[8:11], s91 offen sc1
  v_mfma_f32_16x16x32_bf16 v[36:39], v[80:83], v[148:151], 0
  s_add_u32 s91, s34, 10485760
  v_mfma_f32_16x16x32_bf16 v[40:43], v[80:83], v[152:155], 0
  v_mfma_f32_16x16x32_bf16 v[44:47], v[80:83], v[156:159], 0
  s_waitcnt vmcnt(9)
  v_mfma_f32_16x16x32_bf16 v[32:35], v[84:87], v[160:163], v[32:35]
  buffer_load_dwordx4 v[124:127], v14, s[8:11], s91 offen sc1
  v_mfma_f32_16x16x32_bf16 v[36:39], v[84:87], v[164:167], v[36:39]
  s_add_u32 s91, s34, 10489856
  v_mfma_f32_16x16x32_bf16 v[40:43], v[84:87], v[168:171], v[40:43]
  v_mfma_f32_16x16x32_bf16 v[44:47], v[84:87], v[172:175], v[44:47]
  s_waitcnt vmcnt(9)
  v_mfma_f32_16x16x32_bf16 v[32:35], v[88:91], v[176:179], v[32:35]
  buffer_load_dwordx4 v[128:131], v14, s[8:11], s91 offen sc1
  v_mfma_f32_16x16x32_bf16 v[36:39], v[88:91], v[180:183], v[36:39]
  s_add_u32 s91, s34, 10493952
  v_mfma_f32_16x16x32_bf16 v[40:43], v[88:91], v[184:187], v[40:43]
  v_mfma_f32_16x16x32_bf16 v[44:47], v[88:91], v[188:191], v[44:47]
  s_waitcnt vmcnt(9)
  v_mfma_f32_16x16x32_bf16 v[32:35], v[92:95], v[192:195], v[32:35]
  buffer_load_dwordx4 v[132:135], v14, s[8:11], s91 offen sc1
  v_mfma_f32_16x16x32_bf16 v[36:39], v[92:95], v[196:199], v[36:39]
  s_add_u32 s91, s34, 10498048
  v_mfma_f32_16x16x32_bf16 v[40:43], v[92:95], v[200:203], v[40:43]
  v_mfma_f32_16x16x32_bf16 v[44:47], v[92:95], v[204:207], v[44:47]
  s_waitcnt vmcnt(9)
  v_mfma_f32_16x16x32_bf16 v[32:35], v[96:99], v[208:211], v[32:35]
  buffer_load_dwordx4 v[136:139], v14, s[8:11], s91 offen sc1
  v_mfma_f32_16x16x32_bf16 v[36:39], v[96:99], v[212:215], v[36:39]
  s_add_u32 s91, s34, 10502144
  v_mfma_f32_16x16x32_bf16 v[40:43], v[96:99], v[216:219], v[40:43]
  v_mfma_f32_16x16x32_bf16 v[44:47], v[96:99], v[220:223], v[44:47]
  s_waitcnt vmcnt(9)
  v_mfma_f32_16x16x32_bf16 v[32:35], v[100:103], v[224:227], v[32:35]
  buffer_load_dwordx4 v[140:143], v14, s[8:11], s91 offen sc1
  v_mfma_f32_16x16x32_bf16 v[36:39], v[100:103], v[228:231], v[36:39]
  s_add_u32 s91, s34, 10506240
  v_mfma_f32_16x16x32_bf16 v[40:43], v[100:103], v[232:235], v[40:43]
  v_mfma_f32_16x16x32_bf16 v[44:47], v[100:103], v[236:239], v[44:47]
  s_waitcnt vmcnt(9)
  v_mfma_f32_16x16x32_bf16 v[32:35], v[104:107], v[240:243], v[32:35]
  buffer_load_dwordx4 v[80:83], v14, s[8:11], s91 offen sc1
  v_mfma_f32_16x16x32_bf16 v[36:39], v[104:107], v[244:247], v[36:39]
  s_add_u32 s91, s34, 10510336
  v_mfma_f32_16x16x32_bf16 v[40:43], v[104:107], v[248:251], v[40:43]
  v_mfma_f32_16x16x32_bf16 v[44:47], v[104:107], v[252:255], v[44:47]
  s_waitcnt vmcnt(9)
  v_mfma_f32_16x16x32_bf16 v[32:35], v[108:111], a[192:195], v[32:35]
  buffer_load_dwordx4 v[84:87], v14, s[8:11], s91 offen sc1
  v_mfma_f32_16x16x32_bf16 v[36:39], v[108:111], a[196:199], v[36:39]
  s_add_u32 s91, s34, 10514432
  v_mfma_f32_16x16x32_bf16 v[40:43], v[108:111], a[200:203], v[40:43]
  v_mfma_f32_16x16x32_bf16 v[44:47], v[108:111], a[204:207], v[44:47]
  s_waitcnt vmcnt(9)
  v_mfma_f32_16x16x32_bf16 v[32:35], v[112:115], a[208:211], v[32:35]
  buffer_load_dwordx4 v[88:91], v14, s[8:11], s91 offen sc1
  v_mfma_f32_16x16x32_bf16 v[36:39], v[112:115], a[212:215], v[36:39]
  s_add_u32 s91, s34, 10518528
  v_mfma_f32_16x16x32_bf16 v[40:43], v[112:115], a[216:219], v[40:43]
  v_mfma_f32_16x16x32_bf16 v[44:47], v[112:115], a[220:223], v[44:47]
  s_waitcnt vmcnt(9)
  v_mfma_f32_16x16x32_bf16 v[32:35], v[116:119], a[224:227], v[32:35]
  buffer_load_dwordx4 v[92:95], v14, s[8:11], s91 offen sc1
  v_mfma_f32_16x16x32_bf16 v[36:39], v[116:119], a[228:231], v[36:39]
  s_add_u32 s91, s34, 10522624
  v_mfma_f32_16x16x32_bf16 v[40:43], v[116:119], a[232:235], v[40:43]
  v_mfma_f32_16x16x32_bf16 v[44:47], v[116:119], a[236:239], v[44:47]
  s_waitcnt vmcnt(9)
  v_mfma_f32_16x16x32_bf16 v[32:35], v[120:123], a[240:243], v[32:35]
  buffer_load_dwordx4 v[96:99], v14, s[8:11], s91 offen sc1
  v_mfma_f32_16x16x32_bf16 v[36:39], v[120:123], a[244:247], v[36:39]
  s_add_u32 s91, s1, 10526720
  v_mfma_f32_16x16x32_bf16 v[40:43], v[120:123], a[248:251], v[40:43]
  v_mfma_f32_16x16x32_bf16 v[44:47], v[120:123], a[252:255], v[44:47]
  s_waitcnt vmcnt(9)
  v_mfma_f32_16x16x32_bf16 v[48:51], v[124:127], v[144:147], 0
  buffer_load_dwordx4 v[100:103], v14, s[8:11], s91 offen sc1
  v_mfma_f32_16x16x32_bf16 v[52:55], v[124:127], v[148:151], 0
  s_add_u32 s91, s34, 10485760
  v_mfma_f32_16x16x32_bf16 v[56:59], v[124:127], v[152:155], 0
  v_add_u32 v11, s48, v1
  v_mfma_f32_16x16x32_bf16 v[60:63], v[124:127], v[156:159], 0
  s_waitcnt vmcnt(9)
  v_mfma_f32_16x16x32_bf16 v[48:51], v[128:131], v[160:163], v[48:51]
  buffer_load_dwordx4 v[104:107], v15, s[8:11], s91 offen sc1
  v_mfma_f32_16x16x32_bf16 v[52:55], v[128:131], v[164:167], v[52:55]
  s_add_u32 s91, s34, 10489856
Lstub4:
  s_cbranch_execz Lret4_3003
  v_mfma_f32_16x16x32_bf16 v[56:59], v[128:131], v[168:171], v[56:59]
  ds_write_b128 v11, v[32:35] offset:0
  v_mfma_f32_16x16x32_bf16 v[60:63], v[128:131], v[172:175], v[60:63]
  ds_write_b128 v11, v[36:39] offset:1024
  s_waitcnt vmcnt(9)
  v_mfma_f32_16x16x32_bf16 v[48:51], v[132:135], v[176:179], v[48:51]
  buffer_load_dwordx4 v[108:111], v15, s[8:11], s91 offen sc1
  v_mfma_f32_16x16x32_bf16 v[52:55], v[132:135], v[180:183], v[52:55]
  s_add_u32 s91, s34, 10493952
  v_mfma_f32_16x16x32_bf16 v[56:59], v[132:135], v[184:187], v[56:59]
  ds_write_b128 v11, v[40:43] offset:2048
  v_mfma_f32_16x16x32_bf16 v[60:63], v[132:135], v[188:191], v[60:63]
  ds_write_b128 v11, v[44:47] offset:3072
  s_waitcnt vmcnt(9)
  v_mfma_f32_16x16x32_bf16 v[48:51], v[136:139], v[192:195], v[48:51]
  buffer_load_dwordx4 v[112:115], v15, s[8:11], s91 offen sc1
  v_mfma_f32_16x16x32_bf16 v[52:55], v[136:139], v[196:199], v[52:55]
  s_add_u32 s91, s34, 10498048
  v_mfma_f32_16x16x32_bf16 v[56:59], v[136:139], v[200:203], v[56:59]
  v_mfma_f32_16x16x32_bf16 v[60:63], v[136:139], v[204:207], v[60:63]
  s_waitcnt vmcnt(9)
  v_mfma_f32_16x16x32_bf16 v[48:51], v[140:143], v[208:211], v[48:51]
  buffer_load_dwordx4 v[116:119], v15, s[8:11], s91 offen sc1
  v_mfma_f32_16x16x32_bf16 v[52:55], v[140:143], v[212:215], v[52:55]
  s_add_u32 s91, s34, 10502144
  v_mfma_f32_16x16x32_bf16 v[56:59], v[140:143], v[216:219], v[56:59]
  v_mfma_f32_16x16x32_bf16 v[60:63], v[140:143], v[220:223], v[60:63]
  s_waitcnt vmcnt(9)
  v_mfma_f32_16x16x32_bf16 v[48:51], v[80:83], v[224:227], v[48:51]
  buffer_load_dwordx4 v[120:123], v15, s[8:11], s91 offen sc1
  v_mfma_f32_16x16x32_bf16 v[52:55], v[80:83], v[228:231], v[52:55]
  s_add_u32 s91, s34, 10506240
  v_mfma_f32_16x16x32_bf16 v[56:59], v[80:83], v[232:235], v[56:59]
  v_mfma_f32_16x16x32_bf16 v[60:63], v[80:83], v[236:239], v[60:63]
  s_waitcnt vmcnt(9)
  v_mfma_f32_16x16x32_bf16 v[48:51], v[84:87], v[240:243], v[48:51]
  buffer_load_dwordx4 v[124:127], v15, s[8:11], s91 offen sc1
  v_mfma_f32_16x16x32_bf16 v[52:55], v[84:87], v[244:247], v[52:55]
  s_add_u32 s91, s34, 10510336
  v_mfma_f32_16x16x32_bf16 v[56:59], v[84:87], v[248:251], v[56:59]
  v_mfma_f32_16x16x32_bf16 v[60:63], v[84:87], v[252:255], v[60:63]
  s_waitcnt vmcnt(9)
  v_mfma_f32_16x16x32_bf16 v[48:51], v[88:91], a[192:195], v[48:51]
  buffer_load_dwordx4 v[128:131], v15, s[8:11], s91 offen sc1
  v_mfma_f32_16x16x32_bf16 v[52:55], v[88:91], a[196:199], v[52:55]
  s_add_u32 s91, s34, 10514432
  v_mfma_f32_16x16x32_bf16 v[56:59], v[88:91], a[200:203], v[56:59]
  v_mfma_f32_16x16x32_bf16 v[60:63], v[88:91], a[204:207], v[60:63]
  s_waitcnt vmcnt(9)
  v_mfma_f32_16x16x32_bf16 v[48:51], v[92:95], a[208:211], v[48:51]
  buffer_load_dwordx4 v[132:135], v15, s[8:11], s91 offen sc1
  v_mfma_f32_16x16x32_bf16 v[52:55], v[92:95], a[212:215], v[52:55]
  s_add_u32 s91, s34, 10518528
  v_mfma_f32_16x16x32_bf16 v[56:59], v[92:95], a[216:219], v[56:59]
  v_mfma_f32_16x16x32_bf16 v[60:63], v[92:95], a[220:223], v[60:63]
  s_waitcnt vmcnt(9)
  v_mfma_f32_16x16x32_bf16 v[48:51], v[96:99], a[224:227], v[48:51]
  buffer_load_dwordx4 v[136:139], v15, s[8:11], s91 offen sc1
  v_mfma_f32_16x16x32_bf16 v[52:55], v[96:99], a[228:231], v[52:55]
  s_add_u32 s91, s34, 10522624
  v_mfma_f32_16x16x32_bf16 v[56:59], v[96:99], a[232:235], v[56:59]
  ds_read_b64 v[32:33], v8 offset:0
  v_mfma_f32_16x16x32_bf16 v[60:63], v[96:99], a[236:239], v[60:63]
  ds_read_b64 v[34:35], v8 offset:4096
  s_waitcnt vmcnt(9)
  v_mfma_f32_16x16x32_bf16 v[48:51], v[100:103], a[240:243], v[48:51]
  buffer_load_dwordx4 v[140:143], v15, s[8:11], s91 offen sc1
  v_mfma_f32_16x16x32_bf16 v[52:55], v[100:103], a[244:247], v[52:55]
  s_add_u32 s91, s1, 10526720
  v_mfma_f32_16x16x32_bf16 v[56:59], v[100:103], a[248:251], v[56:59]
  ds_read_b64 v[36:37], v8 offset:8192
  v_mfma_f32_16x16x32_bf16 v[60:63], v[100:103], a[252:255], v[60:63]
  ds_read_b64 v[38:39], v8 offset:12288
  s_waitcnt vmcnt(9)
  v_mfma_f32_16x16x32_bf16 v[64:67], v[104:107], v[144:147], 0
  buffer_load_dwordx4 v[80:83], v15, s[8:11], s91 offen sc1
  v_mfma_f32_16x16x32_bf16 v[68:71], v[104:107], v[148:151], 0
  s_add_u32 s91, s34, 10485760
  v_mfma_f32_16x16x32_bf16 v[72:75], v[104:107], v[152:155], 0
  v_add_u32 v11, s49, v1
  v_mfma_f32_16x16x32_bf16 v[76:79], v[104:107], v[156:159], 0
  s_waitcnt vmcnt(9)
  v_mfma_f32_16x16x32_bf16 v[64:67], v[108:111], v[160:163], v[64:67]
  buffer_load_dwordx4 v[84:87], v7, s[8:11], s91 offen sc1
  v_mfma_f32_16x16x32_bf16 v[68:71], v[108:111], v[164:167], v[68:71]
  s_add_u32 s91, s34, 10489856
  v_mfma_f32_16x16x32_bf16 v[72:75], v[108:111], v[168:171], v[72:75]
  ds_write_b128 v11, v[48:51] offset:4096
  v_mfma_f32_16x16x32_bf16 v[76:79], v[108:111], v[172:175], v[76:79]
  ds_write_b128 v11, v[52:55] offset:5120
  s_waitcnt vmcnt(9)
  v_mfma_f32_16x16x32_bf16 v[64:67], v[112:115], v[176:179], v[64:67]
  buffer_load_dwordx4 v[88:91], v7, s[8:11], s91 offen sc1
  v_mfma_f32_16x16x32_bf16 v[68:71], v[112:115], v[180:183], v[68:71]
  s_add_u32 s91, s34, 10493952
  v_mfma_f32_16x16x32_bf16 v[72:75], v[112:115], v[184:187], v[72:75]
  ds_write_b128 v11, v[56:59] offset:6144
  v_mfma_f32_16x16x32_bf16 v[76:79], v[112:115], v[188:191], v[76:79]
  ds_write_b128 v11, v[60:63] offset:7168
  s_waitcnt vmcnt(9)
  v_mfma_f32_16x16x32_bf16 v[64:67], v[116:119], v[192:195], v[64:67]
  buffer_load_dwordx4 v[92:95], v7, s[8:11], s91 offen sc1
  v_mfma_f32_16x16x32_bf16 v[68:71], v[116:119], v[196:199], v[68:71]
  s_add_u32 s91, s34, 10498048
  v_mfma_f32_16x16x32_bf16 v[72:75], v[116:119], v[200:203], v[72:75]
  buffer_load_dwordx4 v[12:15], v9, s[8:11], s29 offen sc1
  v_mfma_f32_16x16x32_bf16 v[76:79], v[116:119], v[204:207], v[76:79]
  s_waitcnt vmcnt(10)
  v_mfma_f32_16x16x32_bf16 v[64:67], v[120:123], v[208:211], v[64:67]
  buffer_load_dwordx4 v[96:99], v7, s[8:11], s91 offen sc1
  v_mfma_f32_16x16x32_bf16 v[68:71], v[120:123], v[212:215], v[68:71]
  s_add_u32 s91, s34, 10502144
  v_mfma_f32_16x16x32_bf16 v[72:75], v[120:123], v[216:219], v[72:75]
  v_mfma_f32_16x16x32_bf16 v[76:79], v[120:123], v[220:223], v[76:79]
  s_waitcnt vmcnt(10)
  v_mfma_f32_16x16x32_bf16 v[64:67], v[124:127], v[224:227], v[64:67]
  buffer_load_dwordx4 v[100:103], v7, s[8:11], s91 offen sc1
  v_mfma_f32_16x16x32_bf16 v[68:71], v[124:127], v[228:231], v[68:71]
  s_add_u32 s91, s34, 10506240
  v_mfma_f32_16x16x32_bf16 v[72:75], v[124:127], v[232:235], v[72:75]
  v_mfma_f32_16x16x32_bf16 v[76:79], v[124:127], v[236:239], v[76:79]
  s_waitcnt vmcnt(10)
  v_mfma_f32_16x16x32_bf16 v[64:67], v[128:131], v[240:243], v[64:67]
  buffer_load_dwordx4 v[104:107], v7, s[8:11], s91 offen sc1
  v_mfma_f32_16x16x32_bf16 v[68:71], v[128:131], v[244:247], v[68:71]
  s_add_u32 s91, s34, 10510336
  v_mfma_f32_16x16x32_bf16 v[72:75], v[128:131], v[248:251], v[72:75]
  v_mfma_f32_16x16x32_bf16 v[76:79], v[128:131], v[252:255], v[76:79]
  s_waitcnt vmcnt(10)
  v_mfma_f32_16x16x32_bf16 v[64:67], v[132:135], a[192:195], v[64:67]
  buffer_load_dwordx4 v[108:111], v7, s[8:11], s91 offen sc1
  v_mfma_f32_16x16x32_bf16 v[68:71], v[132:135], a[196:199], v[68:71]
  s_add_u32 s91, s34, 10514432
  v_mfma_f32_16x16x32_bf16 v[72:75], v[132:135], a[200:203], v[72:75]
  v_mfma_f32_16x16x32_bf16 v[76:79], v[132:135], a[204:207], v[76:79]
  s_waitcnt vmcnt(10)
  v_mfma_f32_16x16x32_bf16 v[64:67], v[136:139], a[208:211], v[64:67]
  buffer_load_dwordx4 v[112:115], v7, s[8:11], s91 offen sc1
  v_mfma_f32_16x16x32_bf16 v[68:71], v[136:139], a[212:215], v[68:71]
  s_add_u32 s91, s34, 10518528
  v_mfma_f32_16x16x32_bf16 v[72:75], v[136:139], a[216:219], v[72:75]
  v_mfma_f32_16x16x32_bf16 v[76:79], v[136:139], a[220:223], v[76:79]
  s_waitcnt vmcnt(10)
  v_mfma_f32_16x16x32_bf16 v[64:67], v[140:143], a[224:227], v[64:67]
  buffer_load_dwordx4 v[116:119], v7, s[8:11], s91 offen sc1
  v_mfma_f32_16x16x32_bf16 v[68:71], v[140:143], a[228:231], v[68:71]
  s_add_u32 s91, s34, 10522624
  v_mfma_f32_16x16x32_bf16 v[72:75], v[140:143], a[232:235], v[72:75]
  v_mfma_f32_16x16x32_bf16 v[76:79], v[140:143], a[236:239], v[76:79]
  s_waitcnt vmcnt(10)
  v_mfma_f32_16x16x32_bf16 v[64:67], v[80:83], a[240:243], v[64:67]
  buffer_load_dwordx4 v[120:123], v7, s[8:11], s91 offen sc1
  s_add_u32 s91, s1, 10526720
  s_waitcnt lgkmcnt(0)
  v_mfma_f32_16x16x32_bf16 v[68:71], v[80:83], a[244:247], v[68:71]
  v_lshlrev_b32 v128, 16, v32
  v_and_b32 v129, s19, v32
  v_lshlrev_b32 v130, 16, v33
  v_mfma_f32_16x16x32_bf16 v[72:75], v[80:83], a[248:251], v[72:75]
  v_and_b32 v131, s19, v33
  v_lshlrev_b32 v132, 16, v34
  v_and_b32 v133, s19, v34
  v_mfma_f32_16x16x32_bf16 v[76:79], v[80:83], a[252:255], v[76:79]
  s_waitcnt vmcnt(10)
  v_mfma_f32_16x16x32_bf16 v[16:19], v[84:87], v[144:147], 0
  buffer_load_dwordx4 v[124:127], v7, s[8:11], s91 offen sc1
  v_add_u32 v11, s50, v1
  v_mfma_f32_16x16x32_bf16 v[20:23], v[84:87], v[148:151], 0
  v_lshlrev_b32 v134, 16, v35
  v_and_b32 v135, s19, v35
  v_mfma_f32_16x16x32_bf16 v[24:27], v[84:87], v[152:155], 0
  v_lshlrev_b32 v136, 16, v36
  v_and_b32 v137, s19, v36
  v_mfma_f32_16x16x32_bf16 v[28:31], v[84:87], v[156:159], 0
  s_waitcnt vmcnt(10)
  v_mfma_f32_16x16x32_bf16 v[16:19], v[88:91], v[160:163], v[16:19]
  ds_write_b128 v11, v[64:67] offset:8192
  ds_write_b128 v11, v[68:71] offset:9216
  v_mfma_f32_16x16x32_bf16 v[20:23], v[88:91], v[164:167], v[20:23]
  v_lshlrev_b32 v138, 16, v37
  v_and_b32 v139, s19, v37
  v_mfma_f32_16x16x32_bf16 v[24:27], v[88:91], v[168:171], v[24:27]
  v_lshlrev_b32 v140, 16, v38
  v_mfma_f32_16x16x32_bf16 v[28:31], v[88:91], v[172:175], v[28:31]
  s_waitcnt vmcnt(9)
  v_mfma_f32_16x16x32_bf16 v[16:19], v[92:95], v[176:179], v[16:19]
  ds_write_b128 v11, v[72:75] offset:10240
  ds_write_b128 v11, v[76:79] offset:11264
  v_mfma_f32_16x16x32_bf16 v[20:23], v[92:95], v[180:183], v[20:23]
  v_and_b32 v141, s19, v38
  v_lshlrev_b32 v142, 16, v39
  v_mfma_f32_16x16x32_bf16 v[24:27], v[92:95], v[184:187], v[24:27]
  v_and_b32 v143, s19, v39
  v_mfma_f32_16x16x32_bf16 v[28:31], v[92:95], v[188:191], v[28:31]
  s_waitcnt vmcnt(7)
  v_mfma_f32_16x16x32_bf16 v[16:19], v[96:99], v[192:195], v[16:19]
  v_and_b32 v9, 0x3c, v0
  v_mfma_f32_16x16x32_bf16 v[20:23], v[96:99], v[196:199], v[20:23]
  v_add_u32 v11, s0, v1
  v_mfma_f32_16x16x32_bf16 v[24:27], v[96:99], v[200:203], v[24:27]
  v_mfma_f32_16x16x32_bf16 v[28:31], v[96:99], v[204:207], v[28:31]
  s_waitcnt vmcnt(6)
  v_mfma_f32_16x16x32_bf16 v[16:19], v[100:103], v[208:211], v[16:19]
  s_waitcnt lgkmcnt(0)
  s_barrier
  v_mfma_f32_16x16x32_bf16 v[20:23], v[100:103], v[212:215], v[20:23]
  ds_read_b128 v[32:35], v11 offset:0
  ds_read_b128 v[36:39], v11 offset:1024
  v_mfma_f32_16x16x32_bf16 v[24:27], v[100:103], v[216:219], v[24:27]
  ds_read_b128 v[40:43], v11 offset:2048
  ds_read_b128 v[44:47], v11 offset:3072
  v_mfma_f32_16x16x32_bf16 v[28:31], v[100:103], v[220:223], v[28:31]
  s_waitcnt vmcnt(5)
  v_mfma_f32_16x16x32_bf16 v[16:19], v[104:107], v[224:227], v[16:19]
  ds_read_b128 v[48:51], v11 offset:4096
  ds_read_b128 v[52:55], v11 offset:5120
  v_mfma_f32_16x16x32_bf16 v[20:23], v[104:107], v[228:231], v[20:23]
  ds_read_b128 v[56:59], v11 offset:6144
  ds_read_b128 v[60:63], v11 offset:7168
  v_mfma_f32_16x16x32_bf16 v[24:27], v[104:107], v[232:235], v[24:27]
  ds_read_b128 v[64:67], v11 offset:8192
  ds_read_b128 v[68:71], v11 offset:9216
  v_mfma_f32_16x16x32_bf16 v[28:31], v[104:107], v[236:239], v[28:31]
  ds_read_b128 v[72:75], v11 offset:10240
  ds_read_b128 v[76:79], v11 offset:11264
  s_waitcnt vmcnt(4)
  v_mfma_f32_16x16x32_bf16 v[16:19], v[108:111], v[240:243], v[16:19]
  v_mfma_f32_16x16x32_bf16 v[20:23], v[108:111], v[244:247], v[20:23]
  v_mfma_f32_16x16x32_bf16 v[24:27], v[108:111], v[248:251], v[24:27]
  v_mfma_f32_16x16x32_bf16 v[28:31], v[108:111], v[252:255], v[28:31]
  s_waitcnt vmcnt(3)
  v_mfma_f32_16x16x32_bf16 v[16:19], v[112:115], a[192:195], v[16:19]
  s_waitcnt lgkmcnt(4)
  v_pk_add_f32 v[32:33], v[32:33], v[48:49]
  v_pk_add_f32 v[34:35], v[34:35], v[50:51]
  v_mfma_f32_16x16x32_bf16 v[20:23], v[112:115], a[196:199], v[20:23]
  v_pk_add_f32 v[36:37], v[36:37], v[52:53]
  v_pk_add_f32 v[38:39], v[38:39], v[54:55]
  v_pk_add_f32 v[40:41], v[40:41], v[56:57]
  v_mfma_f32_16x16x32_bf16 v[24:27], v[112:115], a[200:203], v[24:27]
  v_pk_add_f32 v[42:43], v[42:43], v[58:59]
  v_pk_add_f32 v[44:45], v[44:45], v[60:61]
  v_pk_add_f32 v[46:47], v[46:47], v[62:63]
  v_mfma_f32_16x16x32_bf16 v[28:31], v[112:115], a[204:207], v[28:31]
  s_waitcnt vmcnt(2)
  v_mfma_f32_16x16x32_bf16 v[16:19], v[116:119], a[208:211], v[16:19]
  s_waitcnt lgkmcnt(0)
  v_pk_add_f32 v[32:33], v[32:33], v[64:65]
  v_pk_add_f32 v[34:35], v[34:35], v[66:67]
  v_mfma_f32_16x16x32_bf16 v[20:23], v[116:119], a[212:215], v[20:23]
  v_pk_add_f32 v[36:37], v[36:37], v[68:69]
  v_pk_add_f32 v[38:39], v[38:39], v[70:71]
  v_pk_add_f32 v[40:41], v[40:41], v[72:73]
  v_mfma_f32_16x16x32_bf16 v[24:27], v[116:119], a[216:219], v[24:27]
  v_pk_add_f32 v[42:43], v[42:43], v[74:75]
  v_pk_add_f32 v[44:45], v[44:45], v[76:77]
  v_pk_add_f32 v[46:47], v[46:47], v[78:79]
  v_mfma_f32_16x16x32_bf16 v[28:31], v[116:119], a[220:223], v[28:31]
  s_waitcnt vmcnt(1)
  v_mfma_f32_16x16x32_bf16 v[16:19], v[120:123], a[224:227], v[16:19]
  v_pk_fma_f32 v[32:33], v[32:33], v[12:13], v[128:129]
  v_pk_fma_f32 v[34:35], v[34:35], v[14:15], v[130:131]
  v_mfma_f32_16x16x32_bf16 v[20:23], v[120:123], a[228:231], v[20:23]
  v_pk_fma_f32 v[36:37], v[36:37], v[12:13], v[132:133]
  v_pk_fma_f32 v[38:39], v[38:39], v[14:15], v[134:135]
  v_pk_fma_f32 v[40:41], v[40:41], v[12:13], v[136:137]
  v_mfma_f32_16x16x32_bf16 v[24:27], v[120:123], a[232:235], v[24:27]
  v_pk_fma_f32 v[42:43], v[42:43], v[14:15], v[138:139]
  v_pk_fma_f32 v[44:45], v[44:45], v[12:13], v[140:141]
  v_pk_fma_f32 v[46:47], v[46:47], v[14:15], v[142:143]
  v_mfma_f32_16x16x32_bf16 v[28:31], v[120:123], a[236:239], v[28:31]
  s_waitcnt vmcnt(0)
  v_mfma_f32_16x16x32_bf16 v[16:19], v[124:127], a[240:243], v[16:19]
  v_mfma_f32_16x16x32_bf16 v[20:23], v[124:127], a[244:247], v[20:23]
  v_mfma_f32_16x16x32_bf16 v[24:27], v[124:127], a[248:251], v[24:27]
  v_mfma_f32_16x16x32_bf16 v[28:31], v[124:127], a[252:255], v[28:31]
  s_nop 4
  v_pk_fma_f32 v[16:17], v[16:17], v[12:13], v[32:33]
  v_pk_fma_f32 v[18:19], v[18:19], v[14:15], v[34:35]
  v_cvt_pk_bf16_f32 v84, v16, v17
  v_cvt_pk_bf16_f32 v85, v18, v19
  buffer_store_dwordx2 v[84:85], v8, s[8:11], s24 offen sc1
  v_pk_fma_f32 v[20:21], v[20:21], v[12:13], v[36:37]
  v_pk_fma_f32 v[22:23], v[22:23], v[14:15], v[38:39]
  v_cvt_pk_bf16_f32 v86, v20, v21
  v_cvt_pk_bf16_f32 v87, v22, v23
  buffer_store_dwordx2 v[86:87], v8, s[8:11], s25 offen sc1
  v_pk_fma_f32 v[24:25], v[24:25], v[12:13], v[40:41]
  v_pk_fma_f32 v[26:27], v[26:27], v[14:15], v[42:43]
  v_cvt_pk_bf16_f32 v88, v24, v25
  v_cvt_pk_bf16_f32 v89, v26, v27
  buffer_store_dwordx2 v[88:89], v8, s[8:11], s26 offen sc1
  v_pk_fma_f32 v[28:29], v[28:29], v[12:13], v[44:45]
  v_pk_fma_f32 v[30:31], v[30:31], v[14:15], v[46:47]
  v_cvt_pk_bf16_f32 v90, v28, v29
  v_cvt_pk_bf16_f32 v91, v30, v31
  buffer_store_dwordx2 v[90:91], v8, s[8:11], s30 offen sc1
  v_pk_mul_f32 v[48:49], v[16:17], v[16:17]
  v_pk_mul_f32 v[50:51], v[18:19], v[18:19]
  v_pk_mul_f32 v[48:49], v[48:49], v[10:11] op_sel_hi:[1,0]
  v_pk_mul_f32 v[50:51], v[50:51], v[10:11] op_sel_hi:[1,0]
  v_pk_fma_f32 v[48:49], v[20:21], v[20:21], v[48:49]
  v_pk_fma_f32 v[50:51], v[22:23], v[22:23], v[50:51]
  v_pk_fma_f32 v[48:49], v[24:25], v[24:25], v[48:49]
  v_pk_fma_f32 v[50:51], v[26:27], v[26:27], v[50:51]
  v_pk_fma_f32 v[48:49], v[28:29], v[28:29], v[48:49]
  v_pk_fma_f32 v[50:51], v[30:31], v[30:31], v[50:51]
  s_nop 0
  v_add_f32_dpp v16, v48, v48 row_ror:8 row_mask:0xf bank_mask:0x3
  v_add_f32_dpp v17, v49, v49 row_ror:8 row_mask:0xf bank_mask:0x3
  s_nop 0
  v_add_f32_dpp v16, v50, v50 row_ror:8 row_mask:0xf bank_mask:0xc
  v_add_f32_dpp v17, v51, v51 row_ror:8 row_mask:0xf bank_mask:0xc
  s_nop 0
  v_add_f32_dpp v48, v16, v16 row_half_mirror row_mask:0xf bank_mask:0x5
  s_nop 1
  v_add_f32_dpp v48, v17, v17 row_half_mirror row_mask:0xf bank_mask:0xa
  s_nop 1
  v_add_f32_dpp v48, v48, v48 quad_perm:[1,0,3,2] row_mask:0xf bank_mask:0xf
  s_nop 1
  v_add_f32_dpp v48, v48, v48 quad_perm:[2,3,0,1] row_mask:0xf bank_mask:0xf
  s_mov_b32 exec_lo, 0x11111111
  s_mov_b32 exec_hi, 0x11111111
  buffer_atomic_add_f32 v48, v9, s[8:11], s28 offen sc1
  s_mov_b64 exec, -1
  s_lshl_b32 s4, s3, 13
  s_add_u32 s4, s4, 131072
  v_add_u32 v4, s4, v1
  ds_read_b128 v[176:179], v4 offset:0
  ds_read_b128 v[184:187], v4 offset:1024
  ds_read_b128 v[224:227], v4 offset:2048
  ds_read_b128 v[232:235], v4 offset:3072
  ds_read_b128 v[156:159], v4 offset:4096
  ds_read_b128 v[160:163], v4 offset:5120
  ds_read_b128 v[164:167], v4 offset:6144
  ds_read_b128 v[168:171], v4 offset:7168
  v_and_b32 v5, 1, v0
  v_mul_lo_u32 v5, v5, s18
  s_brev_b32 s4, 1
  s_waitcnt lgkmcnt(4)
  v_xor_b32 v180, v5, v176
  v_xor_b32 v188, v5, v184
  v_xor_b32 v181, v5, v177
  v_xor_b32 v189, v5, v185
  v_xor_b32 v182, v5, v178
  v_xor_b32 v190, v5, v186
  v_xor_b32 v183, v5, v179
  v_xor_b32 v191, v5, v187
  v_xor_b32 v228, s4, v224
  v_xor_b32 v236, s4, v232
  v_xor_b32 v229, s4, v225
  v_xor_b32 v237, s4, v233
  v_xor_b32 v230, s4, v226
  v_xor_b32 v238, s4, v234
  v_xor_b32 v231, s4, v227
  v_xor_b32 v239, s4, v235
  v_xor_b32 v240, s18, v184
  v_xor_b32 v241, s18, v185
  v_xor_b32 v242, s18, v186
  v_xor_b32 v243, s18, v187
  v_xor_b32 v244, s18, v188
  v_xor_b32 v245, s18, v189
  v_xor_b32 v246, s18, v190
  v_xor_b32 v247, s18, v191
  v_xor_b32 v248, s18, v232
  v_xor_b32 v249, s18, v233
  v_xor_b32 v250, s18, v234
  v_xor_b32 v251, s18, v235
  v_xor_b32 v252, s18, v236
  v_xor_b32 v253, s18, v237
  v_xor_b32 v254, s18, v238
  v_xor_b32 v255, s18, v239
  s_waitcnt lgkmcnt(0)
  v_cvt_f32_f16 v192, v156
  v_cvt_f32_f16_sdwa v196, v156 dst_sel:DWORD dst_unused:UNUSED_PAD src0_sel:WORD_1
  v_cvt_f32_f16 v193, v157
  v_cvt_f32_f16_sdwa v197, v157 dst_sel:DWORD dst_unused:UNUSED_PAD src0_sel:WORD_1
  v_cvt_f32_f16 v194, v158
  v_cvt_f32_f16_sdwa v198, v158 dst_sel:DWORD dst_unused:UNUSED_PAD src0_sel:WORD_1
  v_cvt_f32_f16 v195, v159
  v_cvt_f32_f16_sdwa v199, v159 dst_sel:DWORD dst_unused:UNUSED_PAD src0_sel:WORD_1
  v_cvt_f32_f16 v200, v160
  v_cvt_f32_f16_sdwa v204, v160 dst_sel:DWORD dst_unused:UNUSED_PAD src0_sel:WORD_1
  v_cvt_f32_f16 v201, v161
  v_cvt_f32_f16_sdwa v205, v161 dst_sel:DWORD dst_unused:UNUSED_PAD src0_sel:WORD_1
  v_cvt_f32_f16 v202, v162
  v_cvt_f32_f16_sdwa v206, v162 dst_sel:DWORD dst_unused:UNUSED_PAD src0_sel:WORD_1
  v_cvt_f32_f16 v203, v163
  v_cvt_f32_f16_sdwa v207, v163 dst_sel:DWORD dst_unused:UNUSED_PAD src0_sel:WORD_1
  v_cvt_f32_f16 v208, v164
  v_cvt_f32_f16_sdwa v212, v164 dst_sel:DWORD dst_unused:UNUSED_PAD src0_sel:WORD_1
  v_cvt_f32_f16 v209, v165
  v_cvt_f32_f16_sdwa v213, v165 dst_sel:DWORD dst_unused:UNUSED_PAD src0_sel:WORD_1
  v_cvt_f32_f16 v210, v166
  v_cvt_f32_f16_sdwa v214, v166 dst_sel:DWORD dst_unused:UNUSED_PAD src0_sel:WORD_1
  v_cvt_f32_f16 v211, v167
  v_cvt_f32_f16_sdwa v215, v167 dst_sel:DWORD dst_unused:UNUSED_PAD src0_sel:WORD_1
  v_cvt_f32_f16 v216, v168
  v_cvt_f32_f16_sdwa v220, v168 dst_sel:DWORD dst_unused:UNUSED_PAD src0_sel:WORD_1
  v_cvt_f32_f16 v217, v169
  v_cvt_f32_f16_sdwa v221, v169 dst_sel:DWORD dst_unused:UNUSED_PAD src0_sel:WORD_1
  v_cvt_f32_f16 v218, v170
  v_cvt_f32_f16_sdwa v222, v170 dst_sel:DWORD dst_unused:UNUSED_PAD src0_sel:WORD_1
  v_cvt_f32_f16 v219, v171
  v_cvt_f32_f16_sdwa v223, v171 dst_sel:DWORD dst_unused:UNUSED_PAD src0_sel:WORD_1
  v_lshrrev_b32 v8, 1, v3
  v_lshlrev_b32 v9, 17, v8
  v_and_b32 v10, 1, v3
  v_lshl_add_u32 v9, v10, 10, v9
  v_lshrrev_b32 v11, 2, v2
  v_lshl_add_u32 v9, v11, 8, v9
  v_and_b32 v11, 3, v2
  v_lshl_add_u32 v9, v11, 4, v9
  v_lshlrev_b32 v10, 3, v10
  v_lshl_add_u32 v10, v8, 8, v10
  v_lshl_add_u32 v10, v2, 4, v10
  v_add_u32 v10, s44, v10
  v_mov_b32 v14, 0x3727c5ac
  v_mov_b32 v15, v14
  s_lshr_b32 s4, s57, 1
  s_add_u32 s32, s32, s4
  s_add_u32 s33, s33, s4
  v_mov_b32 v4, 1
  v_mul_u32_u24 v5, 67584, v0
  s_and_b32 s4, s2, 15
  s_mul_i32 s4, s4, 4224
  s_add_u32 s4, s4, 37511168
  s_cmp_lg_u32 s3, 0
  s_waitcnt vmcnt(0) lgkmcnt(0)
  s_barrier
  s_cbranch_scc1 Larr_20
  s_mov_b64 exec, 0xff
  buffer_atomic_add v4, v5, s[8:11], s4 offen sc1
  s_mov_b64 exec, -1
Larr_20:
  buffer_load_dwordx4 v[112:115], v1, s[8:11], s39 offen offset:0 sc1
  buffer_load_dwordx4 v[116:119], v1, s[8:11], s39 offen offset:1024 sc1
  s_add_u32 s24, s43, 4194304
  s_add_u32 s25, s43, 5242880
  s_add_u32 s26, s43, 6291456
  s_add_u32 s27, s43, 7340032
  s_lshl_b32 s6, s3, 10
  s_add_u32 s28, s6, 33562624
  s_add_u32 s29, s28, 4096
  s_waitcnt vmcnt(0)
  v_lshlrev_b32 v16, 16, v112
  v_and_b32 v20, s19, v112
  v_lshlrev_b32 v17, 16, v113
  v_and_b32 v21, s19, v113
  v_lshlrev_b32 v18, 16, v114
  v_and_b32 v22, s19, v114
  v_lshlrev_b32 v19, 16, v115
  v_and_b32 v23, s19, v115
  v_lshlrev_b32 v24, 16, v116
  v_and_b32 v28, s19, v116
  v_lshlrev_b32 v25, 16, v117
  v_and_b32 v29, s19, v117
  v_lshlrev_b32 v26, 16, v118
  v_and_b32 v30, s19, v118
  v_lshlrev_b32 v27, 16, v119
  v_and_b32 v31, s19, v119
  s_cmp_lg_u32 s3, 1
  s_cbranch_scc1 Lnt5_3594
  s_mov_b64 exec, 0
  s_branch Lstub5
Lret5_3594:
  s_mov_b64 exec, -1
Lnt5_3594:
  s_cmp_lg_u32 s3, 0
  s_cbranch_scc1 Lwait_21
  v_mul_u32_u24 v5, 4224, v0
  s_sleep 12
  s_mov_b64 exec, 0xffff
  s_and_b32 s4, s2, 7
  s_mul_i32 s4, s4, 67584
  s_add_u32 s4, s4, 37511168
  s_mov_b32 s7, 0x100000
Lpoll_22:
  buffer_load_dword v4, v5, s[8:11], s4 offen sc1
  s_sub_u32 s7, s7, 1
  s_cbranch_scc1 Ldone_23
  s_waitcnt vmcnt(0)
  v_cmp_gt_u32 vcc, 16, v4
  s_cbranch_vccz Ldone_23
  s_mov_b64 exec, vcc
  s_branch Lpoll_22
Ldone_23:
  s_mov_b64 exec, -1
Lwait_21:
  s_barrier
  buffer_load_dwordx4 v[56:59], v1, s[8:11], s28 offen sc1
  buffer_load_dwordx4 v[60:63], v1, s[8:11], s29 offen sc1
  buffer_load_dwordx4 v[48:51], v9, s[8:11], s24 offen sc1
  buffer_load_dwordx4 v[52:55], v9, s[8:11], s25 offen sc1
  s_waitcnt vmcnt(2)
  v_pk_fma_f32 v[56:57], v[56:57], s[16:17], v[14:15]
  v_pk_fma_f32 v[58:59], v[58:59], s[16:17], v[14:15]
  v_pk_fma_f32 v[60:61], v[60:61], s[16:17], v[14:15]
  v_pk_fma_f32 v[62:63], v[62:63], s[16:17], v[14:15]
  v_rsq_f32 v56, v56
  v_rsq_f32 v57, v57
  v_rsq_f32 v58, v58
  v_rsq_f32 v59, v59
  v_rsq_f32 v60, v60
  v_rsq_f32 v61, v61
  v_rsq_f32 v62, v62
  v_rsq_f32 v63, v63
  s_waitcnt vmcnt(1)
  v_lshlrev_b32 v32, 16, v48
  v_and_b32 v33, s19, v48
  v_lshlrev_b32 v34, 16, v49
  v_and_b32 v35, s19, v49
  v_lshlrev_b32 v36, 16, v50
  v_and_b32 v37, s19, v50
  v_lshlrev_b32 v38, 16, v51
  v_and_b32 v39, s19, v51
  v_pk_mul_f32 v[80:81], v[32:33], v[56:57]
  v_pk_mul_f32 v[82:83], v[34:35], v[58:59]
  v_pk_mul_f32 v[84:85], v[36:37], v[56:57]
  v_pk_mul_f32 v[86:87], v[38:39], v[58:59]
  v_cvt_pk_bf16_f32 v96, v80, v81
  v_cvt_pk_bf16_f32 v97, v82, v83
  ds_write_b64 v10, v[96:97] offset:0
  v_cvt_pk_bf16_f32 v98, v84, v85
  v_cvt_pk_bf16_f32 v99, v86, v87
  v_and_b32 v98, s51, v98
  v_and_b32 v99, s51, v99
  ds_write_b64 v10, v[98:99] offset:1024
  s_waitcnt vmcnt(0)
  v_lshlrev_b32 v40, 16, v52
  v_and_b32 v41, s19, v52
  v_lshlrev_b32 v42, 16, v53
  v_and_b32 v43, s19, v53
  v_lshlrev_b32 v44, 16, v54
  v_and_b32 v45, s19, v54
  v_lshlrev_b32 v46, 16, v55
  v_and_b32 v47, s19, v55
  v_pk_mul_f32 v[88:89], v[40:41], v[60:61]
  v_pk_mul_f32 v[90:91], v[42:43], v[62:63]
  v_pk_mul_f32 v[92:93], v[44:45], v[60:61]
  v_pk_mul_f32 v[94:95], v[46:47], v[62:63]
  v_cvt_pk_bf16_f32 v100, v88, v89
  v_cvt_pk_bf16_f32 v101, v90, v91
  ds_write_b64 v10, v[100:101] offset:4096
  v_cvt_pk_bf16_f32 v102, v92, v93
  v_cvt_pk_bf16_f32 v103, v94, v95
  v_and_b32 v102, s51, v102
  v_and_b32 v103, s51, v103
  ds_write_b64 v10, v[102:103] offset:5120
  s_waitcnt lgkmcnt(0)
  s_barrier
  ds_read_b128 v[48:51], v1 offset:32768
  ds_read_b128 v[52:55], v1 offset:33792
  ds_read_b128 v[56:59], v1 offset:34816
  ds_read_b128 v[60:63], v1 offset:35840
  ds_read_b128 v[64:67], v1 offset:36864
  ds_read_b128 v[68:71], v1 offset:37888
  ds_read_b128 v[72:75], v1 offset:38912
  ds_read_b128 v[76:79], v1 offset:39936
  s_add_u32 s91, s32, 26505216
  buffer_load_dwordx4 a[192:195], v6, s[8:11], s91 offen offset:0 sc1
  buffer_load_dwordx4 a[196:199], v6, s[8:11], s91 offen offset:256 sc1
  s_sub_u32 s91, s91, s57
  buffer_load_dwordx4 a[200:203], v6, s[8:11], s91 offen offset:512 sc1
  buffer_load_dwordx4 a[204:207], v6, s[8:11], s91 offen offset:768 sc1
  s_waitcnt lgkmcnt(6)
  v_mfma_f32_16x16x32_bf16 v[80:83], v[48:51], v[176:179], 0
  v_mfma_f32_16x16x32_bf16 v[84:87], v[48:51], v[184:187], 0
  v_mfma_f32_16x16x32_bf16 v[80:83], v[52:55], v[240:243], v[80:83]
  v_mfma_f32_16x16x32_bf16 v[84:87], v[52:55], v[176:179], v[84:87]
  s_waitcnt lgkmcnt(4)
  v_mfma_f32_16x16x32_bf16 v[80:83], v[56:59], v[180:183], v[80:83]
  v_mfma_f32_16x16x32_bf16 v[84:87], v[56:59], v[188:191], v[84:87]
  v_mfma_f32_16x16x32_bf16 v[80:83], v[60:63], v[244:247], v[80:83]
  v_mfma_f32_16x16x32_bf16 v[84:87], v[60:63], v[180:183], v[84:87]
  s_waitcnt lgkmcnt(2)
  v_mfma_f32_16x16x32_bf16 v[88:91], v[64:67], v[176:179], 0
  v_mfma_f32_16x16x32_bf16 v[92:95], v[64:67], v[184:187], 0
  v_mfma_f32_16x16x32_bf16 v[88:91], v[68:71], v[240:243], v[88:91]
  s_nop 2
  v_mul_f32 v104, v80, v196
  v_mul_f32 v105, v81, v197
  v_mfma_f32_16x16x32_bf16 v[92:95], v[68:71], v[176:179], v[92:95]
  v_mul_f32 v106, v82, v198
  v_mul_f32 v107, v83, v199
  s_waitcnt lgkmcnt(0)
  v_mul_f32 v80, v80, v192
  v_mul_f32 v81, v81, v193
  v_mfma_f32_16x16x32_bf16 v[88:91], v[72:75], v[180:183], v[88:91]
  v_mul_f32 v82, v82, v194
  v_mul_f32 v83, v83, v195
  v_mfma_f32_16x16x32_bf16 v[92:95], v[72:75], v[188:191], v[92:95]
  v_fma_f32 v80, -v84, v196, v80
  v_fma_f32 v81, -v85, v197, v81
  v_mfma_f32_16x16x32_bf16 v[88:91], v[76:79], v[244:247], v[88:91]
  v_fma_f32 v82, -v86, v198, v82
  v_fma_f32 v83, -v87, v199, v83
  v_mfma_f32_16x16x32_bf16 v[92:95], v[76:79], v[180:183], v[92:95]
  v_fma_f32 v84, v84, v192, v104
  v_fma_f32 v85, v85, v193, v105
  v_fma_f32 v86, v86, v194, v106
  v_fma_f32 v87, v87, v195, v107
  v_cvt_pk_bf16_f32 v96, v80, v81
  v_cvt_pk_bf16_f32 v97, v82, v83
  v_cvt_pk_bf16_f32 v100, v84, v85
  v_cvt_pk_bf16_f32 v101, v86, v87
  v_pk_mul_f32 v[108:109], v[88:89], v[204:205]
  v_pk_mul_f32 v[110:111], v[90:91], v[206:207]
  v_pk_mul_f32 v[88:89], v[88:89], v[200:201]
  v_pk_mul_f32 v[90:91], v[90:91], v[202:203]
  v_pk_fma_f32 v[88:89], v[92:93], v[204:205], v[88:89] neg_lo:[1,0,0] neg_hi:[1,0,0]
  v_pk_fma_f32 v[90:91], v[94:95], v[206:207], v[90:91] neg_lo:[1,0,0] neg_hi:[1,0,0]
  v_pk_fma_f32 v[92:93], v[92:93], v[200:201], v[108:109]
  v_pk_fma_f32 v[94:95], v[94:95], v[202:203], v[110:111]
  v_cvt_pk_bf16_f32 v98, v88, v89
  v_cvt_pk_bf16_f32 v99, v90, v91
  v_cvt_pk_bf16_f32 v102, v92, v93
  v_cvt_pk_bf16_f32 v103, v94, v95
  v_mfma_f32_16x16x32_bf16 v[80:83], v[224:227], v[96:99], 0
  s_add_u32 s91, s32, 26509312
  buffer_load_dwordx4 a[208:211], v6, s[8:11], s91 offen offset:0 sc1
  v_mfma_f32_16x16x32_bf16 v[84:87], v[232:235], v[96:99], 0
  buffer_load_dwordx4 a[212:215], v6, s[8:11], s91 offen offset:256 sc1
  v_mfma_f32_16x16x32_bf16 v[80:83], v[248:251], v[100:103], v[80:83]
  v_mfma_f32_16x16x32_bf16 v[84:87], v[224:227], v[100:103], v[84:87]
  v_mfma_f32_16x16x32_bf16 v[88:91], v[228:231], v[96:99], 0
  v_mfma_f32_16x16x32_bf16 v[92:95], v[236:239], v[96:99], 0
Lstub5:
  s_cbranch_execz Lret5_3594
  v_mfma_f32_16x16x32_bf16 v[88:91], v[252:255], v[100:103], v[88:91]
  v_mfma_f32_16x16x32_bf16 v[92:95], v[228:231], v[100:103], v[92:95]
  s_nop 2
  v_pk_mul_f32 v[104:105], v[80:81], v[20:21]
  v_pk_mul_f32 v[106:107], v[82:83], v[22:23]
  v_pk_mul_f32 v[80:81], v[80:81], v[16:17]
  v_pk_mul_f32 v[82:83], v[82:83], v[18:19]
  v_pk_fma_f32 v[80:81], v[84:85], v[20:21], v[80:81] neg_lo:[1,0,0] neg_hi:[1,0,0]
  v_pk_fma_f32 v[82:83], v[86:87], v[22:23], v[82:83] neg_lo:[1,0,0] neg_hi:[1,0,0]
  v_pk_fma_f32 v[84:85], v[84:85], v[16:17], v[104:105]
  v_pk_fma_f32 v[86:87], v[86:87], v[18:19], v[106:107]
  v_cvt_pk_bf16_f32 v96, v80, v81
  v_cvt_pk_bf16_f32 v97, v82, v83
  v_cvt_pk_bf16_f32 v100, v84, v85
  v_cvt_pk_bf16_f32 v101, v86, v87
  v_pk_mul_f32 v[108:109], v[88:89], v[28:29]
  v_pk_mul_f32 v[110:111], v[90:91], v[30:31]
  v_pk_mul_f32 v[88:89], v[88:89], v[24:25]
  v_pk_mul_f32 v[90:91], v[90:91], v[26:27]
  v_pk_fma_f32 v[88:89], v[92:93], v[28:29], v[88:89] neg_lo:[1,0,0] neg_hi:[1,0,0]
  v_pk_fma_f32 v[90:91], v[94:95], v[30:31], v[90:91] neg_lo:[1,0,0] neg_hi:[1,0,0]
  v_pk_fma_f32 v[92:93], v[92:93], v[24:25], v[108:109]
  v_pk_fma_f32 v[94:95], v[94:95], v[26:27], v[110:111]
  v_cvt_pk_bf16_f32 v98, v88, v89
  v_cvt_pk_bf16_f32 v99, v90, v91
  v_cvt_pk_bf16_f32 v102, v92, v93
  v_cvt_pk_bf16_f32 v103, v94, v95
  v_mfma_f32_16x16x32_bf16 v[80:83], v[96:99], v[224:227], 0
  s_sub_u32 s91, s91, s57
  buffer_load_dwordx4 a[216:219], v6, s[8:11], s91 offen offset:512 sc1
  v_mfma_f32_16x16x32_bf16 v[84:87], v[96:99], v[248:251], 0
  buffer_load_dwordx4 a[220:223], v6, s[8:11], s91 offen offset:768 sc1
  v_mfma_f32_16x16x32_bf16 v[80:83], v[100:103], v[232:235], v[80:83]
  v_mfma_f32_16x16x32_bf16 v[84:87], v[100:103], v[224:227], v[84:87]
  v_mfma_f32_16x16x32_bf16 v[88:91], v[96:99], v[228:231], 0
  v_mfma_f32_16x16x32_bf16 v[92:95], v[96:99], v[252:255], 0
  v_mfma_f32_16x16x32_bf16 v[88:91], v[100:103], v[236:239], v[88:91]
  v_mfma_f32_16x16x32_bf16 v[92:95], v[100:103], v[228:231], v[92:95]
  s_nop 2
  v_pk_mul_f32 v[104:105], v[80:81], v[212:213]
  v_pk_mul_f32 v[106:107], v[82:83], v[214:215]
  v_pk_mul_f32 v[80:81], v[80:81], v[208:209]
  v_pk_mul_f32 v[82:83], v[82:83], v[210:211]
  v_pk_fma_f32 v[80:81], v[84:85], v[212:213], v[80:81] neg_lo:[1,0,0] neg_hi:[1,0,0]
  v_pk_fma_f32 v[82:83], v[86:87], v[214:215], v[82:83] neg_lo:[1,0,0] neg_hi:[1,0,0]
  v_pk_fma_f32 v[84:85], v[84:85], v[208:209], v[104:105]
  v_pk_fma_f32 v[86:87], v[86:87], v[210:211], v[106:107]
  v_cvt_pk_bf16_f32 v96, v80, v81
  v_cvt_pk_bf16_f32 v97, v82, v83
  ds_write_b64 v10, v[96:97] offset:8192
  v_cvt_pk_bf16_f32 v98, v84, v85
  v_cvt_pk_bf16_f32 v99, v86, v87
  ds_write_b64 v10, v[98:99] offset:9216
  v_pk_mul_f32 v[108:109], v[88:89], v[220:221]
  v_pk_mul_f32 v[110:111], v[90:91], v[222:223]
  v_pk_mul_f32 v[88:89], v[88:89], v[216:217]
  v_pk_mul_f32 v[90:91], v[90:91], v[218:219]
  v_pk_fma_f32 v[88:89], v[92:93], v[220:221], v[88:89] neg_lo:[1,0,0] neg_hi:[1,0,0]
  v_pk_fma_f32 v[90:91], v[94:95], v[222:223], v[90:91] neg_lo:[1,0,0] neg_hi:[1,0,0]
  v_pk_fma_f32 v[92:93], v[92:93], v[216:217], v[108:109]
  v_pk_fma_f32 v[94:95], v[94:95], v[218:219], v[110:111]
  v_cvt_pk_bf16_f32 v100, v88, v89
  v_cvt_pk_bf16_f32 v101, v90, v91
  ds_write_b64 v10, v[100:101] offset:12288
  v_cvt_pk_bf16_f32 v102, v92, v93
  v_cvt_pk_bf16_f32 v103, v94, v95
  ds_write_b64 v10, v[102:103] offset:13312
  s_waitcnt lgkmcnt(0)
  s_barrier
  ds_read_b128 v[48:51], v1 offset:40960
  ds_read_b128 v[52:55], v1 offset:41984
  ds_read_b128 v[56:59], v1 offset:43008
  ds_read_b128 v[60:63], v1 offset:44032
  ds_read_b128 v[64:67], v1 offset:45056
  ds_read_b128 v[68:71], v1 offset:46080
  ds_read_b128 v[72:75], v1 offset:47104
  ds_read_b128 v[76:79], v1 offset:48128
  s_add_u32 s91, s32, 26513408
  buffer_load_dwordx4 a[224:227], v6, s[8:11], s91 offen offset:0 sc1
  buffer_load_dwordx4 a[228:231], v6, s[8:11], s91 offen offset:256 sc1
  s_sub_u32 s91, s91, s57
  buffer_load_dwordx4 a[232:235], v6, s[8:11], s91 offen offset:512 sc1
  buffer_load_dwordx4 a[236:239], v6, s[8:11], s91 offen offset:768 sc1
  s_waitcnt lgkmcnt(6)
  v_cvt_pk_bf16_f32 v104, v36, v37
  v_mfma_f32_16x16x32_bf16 v[80:83], v[176:179], v[48:51], v[32:35]
  v_cvt_pk_bf16_f32 v105, v38, v39
  v_mfma_f32_16x16x32_bf16 v[84:87], v[240:243], v[48:51], v[36:39]
  v_cvt_pk_bf16_f32 v106, v44, v45
  v_mfma_f32_16x16x32_bf16 v[80:83], v[184:187], v[52:55], v[80:83]
  v_cvt_pk_bf16_f32 v107, v46, v47
  v_mfma_f32_16x16x32_bf16 v[84:87], v[176:179], v[52:55], v[84:87]
  s_waitcnt lgkmcnt(4)
  v_mfma_f32_16x16x32_bf16 v[80:83], v[180:183], v[56:59], v[80:83]
  v_mfma_f32_16x16x32_bf16 v[84:87], v[244:247], v[56:59], v[84:87]
  v_mfma_f32_16x16x32_bf16 v[80:83], v[188:191], v[60:63], v[80:83]
  v_mfma_f32_16x16x32_bf16 v[84:87], v[180:183], v[60:63], v[84:87]
  s_waitcnt lgkmcnt(2)
  v_mfma_f32_16x16x32_bf16 v[88:91], v[176:179], v[64:67], v[40:43]
  v_mfma_f32_16x16x32_bf16 v[92:95], v[240:243], v[64:67], v[44:47]
  v_mfma_f32_16x16x32_bf16 v[88:91], v[184:187], v[68:71], v[88:91]
  v_mfma_f32_16x16x32_bf16 v[92:95], v[176:179], v[68:71], v[92:95]
  s_nop 1
  v_cvt_pk_bf16_f32 v96, v80, v81
  v_cvt_pk_bf16_f32 v97, v82, v83
  s_waitcnt lgkmcnt(0)
  v_cvt_pk_bf16_f32 v98, v84, v85
  v_cvt_pk_bf16_f32 v99, v86, v87
  v_mfma_f32_16x16x32_bf16 v[88:91], v[180:183], v[72:75], v[88:91]
  v_bfi_b32 v98, s51, v98, v104
  v_bfi_b32 v99, s51, v99, v105
  v_mfma_f32_16x16x32_bf16 v[92:95], v[244:247], v[72:75], v[92:95]
  buffer_store_dwordx4 v[96:99], v9, s[8:11], s26 offen sc1
  v_mfma_f32_16x16x32_bf16 v[88:91], v[188:191], v[76:79], v[88:91]
  v_mfma_f32_16x16x32_bf16 v[92:95], v[180:183], v[76:79], v[92:95]
  s_nop 6
  v_cvt_pk_bf16_f32 v100, v88, v89
  v_cvt_pk_bf16_f32 v101, v90, v91
  v_cvt_pk_bf16_f32 v102, v92, v93
  v_cvt_pk_bf16_f32 v103, v94, v95
  v_bfi_b32 v102, s51, v102, v106
  v_bfi_b32 v103, s51, v103, v107
  buffer_store_dwordx4 v[100:103], v9, s[8:11], s27 offen sc1
  v_mov_b32 v4, 1
  v_mul_u32_u24 v5, 67584, v0
  s_and_b32 s4, s2, 15
  s_mul_i32 s4, s4, 4224
  s_add_u32 s4, s4, 38051840
  s_cmp_lg_u32 s3, 0
  s_waitcnt vmcnt(0) lgkmcnt(0)
  s_barrier
  s_cbranch_scc1 Larr_24
  s_mov_b64 exec, 0xff
  buffer_atomic_add v4, v5, s[8:11], s4 offen sc1
  s_mov_b64 exec, -1
Larr_24:
  s_add_u32 s91, s33, 26517504
  buffer_load_dwordx4 a[240:243], v6, s[8:11], s91 offen offset:0 sc1
  buffer_load_dwordx4 a[244:247], v6, s[8:11], s91 offen offset:256 sc1
  s_sub_u32 s91, s91, s57
  buffer_load_dwordx4 a[248:251], v6, s[8:11], s91 offen offset:512 sc1
  buffer_load_dwordx4 a[252:255], v6, s[8:11], s91 offen offset:768 sc1
  s_add_u32 s91, s32, 26476544
  buffer_load_dwordx4 v[144:147], v6, s[8:11], s91 offen offset:0 sc1
  buffer_load_dwordx4 v[148:151], v6, s[8:11], s91 offen offset:256 sc1
  s_sub_u32 s91, s91, s57
  buffer_load_dwordx4 v[152:155], v6, s[8:11], s91 offen offset:512 sc1
  buffer_load_dwordx4 v[156:159], v6, s[8:11], s91 offen offset:768 sc1
  s_add_u32 s28, s37, 6291456
  s_mov_b32 m0, s38
  v_lshlrev_b32 v8, 11, v3
  v_and_b32 v9, 1, v3
  v_lshl_add_u32 v8, v9, 7, v8
  v_lshrrev_b32 v9, 3, v2
  v_lshl_add_u32 v8, v9, 6, v8
  v_and_b32 v9, 3, v2
  v_lshl_add_u32 v8, v9, 4, v8
  v_bfe_u32 v9, v2, 2, 1
  v_lshl_add_u32 v8, v9, 3, v8
  v_xor_b32 v9, 128, v8
  v_add_u32 v10, 0x10000, v8
  v_add_u32 v11, 0x10000, v9
  v_lshrrev_b32 v13, 5, v0
  v_mul_u32_u24 v13, 175616, v13
  v_add_u32 v13, v13, v1
  v_add_u32 v13, 16777216, v13
  s_cmp_eq_u32 s3, 3
  s_cselect_b32 s4, 2146435072, 0
  v_add_u32 v14, s4, v6
  v_mov_b32 v7, 1
  v_mov_b32 v15, 0
  s_mul_i32 s24, s53, 4224
  s_add_u32 s24, s24, 38795264
  s_add_u32 s26, s24, 67584
  s_cmp_eq_u32 s3, 0
  s_cselect_b32 s25, s24, 46137344
  s_cselect_b32 s27, s26, 46137344
  s_lshl_b32 s30, s55, 8
  s_lshr_b32 s4, s35, 2
  s_add_u32 s31, s30, s4
  s_xor_b32 s4, s4, 64
  s_add_u32 s30, s30, s4
  s_lshl_b32 s88, s57, 5
  s_xor_b32 s88, s88, 0
  s_add_u32 s88, s88, s36
  s_lshl_b32 s89, s57, 5
  s_xor_b32 s89, s89, 16384
  s_add_u32 s89, s89, s36
  s_lshl_b32 s90, s57, 5
  s_xor_b32 s90, s90, 32768
  s_add_u32 s90, s90, s36
  s_lshl_b32 s94, s57, 5
  s_xor_b32 s94, s94, 49152
  s_add_u32 s94, s94, s36
  s_cmp_eq_u32 s54, 15
  s_cselect_b32 s29, 1, 0
  s_cmp_lg_u32 s3, 1
  s_cbranch_scc1 Lnt6_3950
  s_mov_b64 exec, 0
  s_branch Lstub6
Lret6_3950:
  s_mov_b64 exec, -1
Lnt6_3950:
  s_cmp_lg_u32 s3, 2
  s_cbranch_scc1 Lnt7_3950
  s_mov_b64 exec, 0
  s_branch Lstub7
Lret7_3950:
  s_mov_b64 exec, -1
Lnt7_3950:
  s_cmp_lg_u32 s3, 3
  s_cbranch_scc1 Lnt8_3950
  s_mov_b64 exec, 0
  s_branch Lstub8
Lret8_3950:
  s_mov_b64 exec, -1
Lnt8_3950:
  s_cmp_lg_u32 s3, 0
  s_cbranch_scc1 Lwait_25
  v_mul_u32_u24 v5, 4224, v0
  s_sleep 8
  s_mov_b64 exec, 0xffff
  s_and_b32 s4, s2, 7
  s_mul_i32 s4, s4, 67584
  s_add_u32 s4, s4, 38051840
  s_mov_b32 s7, 0x100000
Lpoll_26:
  buffer_load_dword v4, v5, s[8:11], s4 offen sc1
  s_sub_u32 s7, s7, 1
  s_cbranch_scc1 Ldone_27
  s_waitcnt vmcnt(0)
  v_cmp_gt_u32 vcc, 16, v4
  s_cbranch_vccz Ldone_27
  s_mov_b64 exec, vcc
  s_branch Lpoll_26
Ldone_27:
  s_mov_b64 exec, -1
Lwait_25:
  s_barrier
  buffer_load_dwordx4 v1, s[8:11], s28 offen sc1 lds
  buffer_load_dwordx4 v1, s[8:11], s28 offen offset:1024 sc1 lds
  s_add_u32 m0, m0, 8192
  s_add_u32 s28, s28, 8192
  buffer_load_dwordx4 v1, s[8:11], s28 offen sc1 lds
  buffer_load_dwordx4 v1, s[8:11], s28 offen offset:1024 sc1 lds
  s_add_u32 m0, m0, 8192
  s_add_u32 s28, s28, 8192
  buffer_load_dwordx4 v1, s[8:11], s28 offen sc1 lds
  buffer_load_dwordx4 v1, s[8:11], s28 offen offset:1024 sc1 lds
  s_add_u32 m0, m0, 8192
  s_add_u32 s28, s28, 8192
  buffer_load_dwordx4 v1, s[8:11], s28 offen sc1 lds
  buffer_load_dwordx4 v1, s[8:11], s28 offen offset:1024 sc1 lds
  s_add_u32 m0, m0, 8192
  s_add_u32 s28, s28, 8192
  buffer_load_dwordx4 v1, s[8:11], s28 offen sc1 lds
  buffer_load_dwordx4 v1, s[8:11], s28 offen offset:1024 sc1 lds
  s_add_u32 m0, m0, 8192
  s_add_u32 s28, s28, 8192
  v_lshrrev_b32 v5, 5, v0
  v_lshl_add_u32 v5, v5, 9, v1
  v_add_u32 v5, 16777216, v5
  s_cmp_eq_u32 s29, 1
  s_cbranch_scc1 G1_STATS1
  s_waitcnt vmcnt(8)
  s_barrier
  ds_read_b64_tr_b16 v[112:113], v8 offset:0
  ds_read_b64_tr_b16 v[114:115], v9 offset:0
  ds_read_b64_tr_b16 v[116:117], v8 offset:256
  ds_read_b64_tr_b16 v[118:119], v9 offset:256
  ds_read_b64_tr_b16 v[120:121], v8 offset:1024
  ds_read_b64_tr_b16 v[122:123], v9 offset:1024
  ds_read_b64_tr_b16 v[124:125], v8 offset:1280
  ds_read_b64_tr_b16 v[126:127], v9 offset:1280
  ds_read_b64_tr_b16 v[128:129], v8 offset:512
  ds_read_b64_tr_b16 v[130:131], v9 offset:512
  ds_read_b64_tr_b16 v[132:133], v8 offset:768
  ds_read_b64_tr_b16 v[134:135], v9 offset:768
  ds_read_b64_tr_b16 v[136:137], v8 offset:1536
  ds_read_b64_tr_b16 v[138:139], v9 offset:1536
  ds_read_b64_tr_b16 v[140:141], v8 offset:1792
  ds_read_b64_tr_b16 v[142:143], v9 offset:1792
  s_waitcnt lgkmcnt(12)
  v_mfma_f32_16x16x32_bf16 v[16:19], a[0:3], v[112:115], 0
  buffer_load_dwordx4 v1, s[8:11], s28 offen sc1 lds
  v_mfma_f32_16x16x32_bf16 v[32:35], a[4:7], v[112:115], 0
  v_mfma_f32_16x16x32_bf16 v[48:51], a[8:11], v[112:115], 0
  s_waitcnt vmcnt(7)
  s_barrier
  v_mfma_f32_16x16x32_bf16 v[52:55], a[8:11], v[116:119], 0
  ds_read_b64_tr_b16 v[112:113], v8 offset:8192
  v_mfma_f32_16x16x32_bf16 v[36:39], a[4:7], v[116:119], 0
  ds_read_b64_tr_b16 v[114:115], v9 offset:8192
  v_mfma_f32_16x16x32_bf16 v[20:23], a[0:3], v[116:119], 0
  s_waitcnt lgkmcnt(10)
  v_mfma_f32_16x16x32_bf16 v[24:27], a[0:3], v[120:123], 0
  ds_read_b64_tr_b16 v[116:117], v8 offset:8448
  v_mfma_f32_16x16x32_bf16 v[40:43], a[4:7], v[120:123], 0
  ds_read_b64_tr_b16 v[118:119], v9 offset:8448
  v_mfma_f32_16x16x32_bf16 v[56:59], a[8:11], v[120:123], 0
  buffer_load_dwordx4 v1, s[8:11], s28 offen offset:1024 sc1 lds
  v_mfma_f32_16x16x32_bf16 v[60:63], a[8:11], v[124:127], 0
  ds_read_b64_tr_b16 v[120:121], v8 offset:9216
  s_add_u32 m0, m0, 8192
  v_mfma_f32_16x16x32_bf16 v[44:47], a[4:7], v[124:127], 0
  ds_read_b64_tr_b16 v[122:123], v9 offset:9216
  s_add_u32 s28, s28, 8192
  v_mfma_f32_16x16x32_bf16 v[28:31], a[0:3], v[124:127], 0
  buffer_load_dwordx4 v1, s[8:11], s28 offen sc1 lds
  s_waitcnt lgkmcnt(10)
  v_mfma_f32_16x16x32_bf16 v[64:67], a[0:3], v[128:131], 0
  ds_read_b64_tr_b16 v[124:125], v8 offset:9472
  v_mfma_f32_16x16x32_bf16 v[80:83], a[4:7], v[128:131], 0
  ds_read_b64_tr_b16 v[126:127], v9 offset:9472
  v_mfma_f32_16x16x32_bf16 v[96:99], a[8:11], v[128:131], 0
  v_mfma_f32_16x16x32_bf16 v[100:103], a[8:11], v[132:135], 0
  ds_read_b64_tr_b16 v[128:129], v8 offset:8704
  v_mfma_f32_16x16x32_bf16 v[84:87], a[4:7], v[132:135], 0
  ds_read_b64_tr_b16 v[130:131], v9 offset:8704
  v_mfma_f32_16x16x32_bf16 v[68:71], a[0:3], v[132:135], 0
  buffer_load_dwordx4 v1, s[8:11], s28 offen offset:1024 sc1 lds
  s_waitcnt lgkmcnt(10)
  v_mfma_f32_16x16x32_bf16 v[72:75], a[0:3], v[136:139], 0
  ds_read_b64_tr_b16 v[132:133], v8 offset:8960
  s_add_u32 m0, m0, 8192
  v_mfma_f32_16x16x32_bf16 v[88:91], a[4:7], v[136:139], 0
  ds_read_b64_tr_b16 v[134:135], v9 offset:8960
  s_add_u32 s28, s28, 8192
  v_mfma_f32_16x16x32_bf16 v[104:107], a[8:11], v[136:139], 0
  buffer_load_dwordx4 v1, s[8:11], s28 offen sc1 lds
  v_mfma_f32_16x16x32_bf16 v[108:111], a[8:11], v[140:143], 0
  ds_read_b64_tr_b16 v[136:137], v8 offset:9728
  v_mfma_f32_16x16x32_bf16 v[92:95], a[4:7], v[140:143], 0
  ds_read_b64_tr_b16 v[138:139], v9 offset:9728
  v_mfma_f32_16x16x32_bf16 v[76:79], a[0:3], v[140:143], 0
  s_waitcnt lgkmcnt(10)
  v_mfma_f32_16x16x32_bf16 v[16:19], a[12:15], v[112:115], v[16:19]
  ds_read_b64_tr_b16 v[140:141], v8 offset:9984
  v_mfma_f32_16x16x32_bf16 v[32:35], a[16:19], v[112:115], v[32:35]
  ds_read_b64_tr_b16 v[142:143], v9 offset:9984
  v_mfma_f32_16x16x32_bf16 v[48:51], a[20:23], v[112:115], v[48:51]
  buffer_load_dwordx4 v1, s[8:11], s28 offen offset:1024 sc1 lds
  s_waitcnt vmcnt(10)
  s_barrier
  v_mfma_f32_16x16x32_bf16 v[52:55], a[20:23], v[116:119], v[52:55]
  ds_read_b64_tr_b16 v[112:113], v8 offset:16384
  s_add_u32 m0, m0, 8192
  v_mfma_f32_16x16x32_bf16 v[36:39], a[16:19], v[116:119], v[36:39]
  ds_read_b64_tr_b16 v[114:115], v9 offset:16384
  s_add_u32 s28, s28, 8192
  v_mfma_f32_16x16x32_bf16 v[20:23], a[12:15], v[116:119], v[20:23]
  buffer_load_dwordx4 v1, s[8:11], s28 offen sc1 lds
  s_waitcnt lgkmcnt(10)
  v_mfma_f32_16x16x32_bf16 v[24:27], a[12:15], v[120:123], v[24:27]
  ds_read_b64_tr_b16 v[116:117], v8 offset:16640
  v_mfma_f32_16x16x32_bf16 v[40:43], a[16:19], v[120:123], v[40:43]
  ds_read_b64_tr_b16 v[118:119], v9 offset:16640
  v_mfma_f32_16x16x32_bf16 v[56:59], a[20:23], v[120:123], v[56:59]
  v_mfma_f32_16x16x32_bf16 v[60:63], a[20:23], v[124:127], v[60:63]
  ds_read_b64_tr_b16 v[120:121], v8 offset:17408
  v_mfma_f32_16x16x32_bf16 v[44:47], a[16:19], v[124:127], v[44:47]
  ds_read_b64_tr_b16 v[122:123], v9 offset:17408
  v_mfma_f32_16x16x32_bf16 v[28:31], a[12:15], v[124:127], v[28:31]
  buffer_load_dwordx4 v1, s[8:11], s28 offen offset:1024 sc1 lds
  s_waitcnt lgkmcnt(10)
  v_mfma_f32_16x16x32_bf16 v[64:67], a[12:15], v[128:131], v[64:67]
  ds_read_b64_tr_b16 v[124:125], v8 offset:17664
  s_add_u32 m0, m0, 8192
  v_mfma_f32_16x16x32_bf16 v[80:83], a[16:19], v[128:131], v[80:83]
  ds_read_b64_tr_b16 v[126:127], v9 offset:17664
  s_add_u32 s28, s28, 8192
  v_mfma_f32_16x16x32_bf16 v[96:99], a[20:23], v[128:131], v[96:99]
  buffer_load_dwordx4 v1, s[8:11], s28 offen sc1 lds
  v_mfma_f32_16x16x32_bf16 v[100:103], a[20:23], v[132:135], v[100:103]
  ds_read_b64_tr_b16 v[128:129], v8 offset:16896
  v_mfma_f32_16x16x32_bf16 v[84:87], a[16:19], v[132:135], v[84:87]
  ds_read_b64_tr_b16 v[130:131], v9 offset:16896
  v_mfma_f32_16x16x32_bf16 v[68:71], a[12:15], v[132:135], v[68:71]
  s_waitcnt lgkmcnt(10)
  v_mfma_f32_16x16x32_bf16 v[72:75], a[12:15], v[136:139], v[72:75]
  ds_read_b64_tr_b16 v[132:133], v8 offset:17152
  v_mfma_f32_16x16x32_bf16 v[88:91], a[16:19], v[136:139], v[88:91]
  ds_read_b64_tr_b16 v[134:135], v9 offset:17152
  v_mfma_f32_16x16x32_bf16 v[104:107], a[20:23], v[136:139], v[104:107]
  buffer_load_dwordx4 v1, s[8:11], s28 offen offset:1024 sc1 lds
  v_mfma_f32_16x16x32_bf16 v[108:111], a[20:23], v[140:143], v[108:111]
  ds_read_b64_tr_b16 v[136:137], v8 offset:17920
  s_add_u32 m0, m0, 8192
  v_mfma_f32_16x16x32_bf16 v[92:95], a[16:19], v[140:143], v[92:95]
  ds_read_b64_tr_b16 v[138:139], v9 offset:17920
  s_add_u32 s28, s28, 8192
  v_mfma_f32_16x16x32_bf16 v[76:79], a[12:15], v[140:143], v[76:79]
  buffer_load_dwordx4 v1, s[8:11], s28 offen sc1 lds
  s_waitcnt lgkmcnt(10)
  v_mfma_f32_16x16x32_bf16 v[16:19], a[24:27], v[112:115], v[16:19]
  ds_read_b64_tr_b16 v[140:141], v8 offset:18176
  v_mfma_f32_16x16x32_bf16 v[32:35], a[28:31], v[112:115], v[32:35]
  ds_read_b64_tr_b16 v[142:143], v9 offset:18176
  v_mfma_f32_16x16x32_bf16 v[48:51], a[32:35], v[112:115], v[48:51]
  s_waitcnt vmcnt(11)
  s_barrier
  v_mfma_f32_16x16x32_bf16 v[52:55], a[32:35], v[116:119], v[52:55]
  ds_read_b64_tr_b16 v[112:113], v8 offset:24576
  v_mfma_f32_16x16x32_bf16 v[36:39], a[28:31], v[116:119], v[36:39]
  ds_read_b64_tr_b16 v[114:115], v9 offset:24576
  v_mfma_f32_16x16x32_bf16 v[20:23], a[24:27], v[116:119], v[20:23]
  buffer_load_dwordx4 v1, s[8:11], s28 offen offset:1024 sc1 lds
  s_waitcnt lgkmcnt(10)
  v_mfma_f32_16x16x32_bf16 v[24:27], a[24:27], v[120:123], v[24:27]
  ds_read_b64_tr_b16 v[116:117], v8 offset:24832
  s_add_u32 m0, m0, 8192
  v_mfma_f32_16x16x32_bf16 v[40:43], a[28:31], v[120:123], v[40:43]
  ds_read_b64_tr_b16 v[118:119], v9 offset:24832
  s_add_u32 s28, s28, 8192
  v_mfma_f32_16x16x32_bf16 v[56:59], a[32:35], v[120:123], v[56:59]
  buffer_load_dwordx4 v1, s[8:11], s28 offen sc1 lds
  v_mfma_f32_16x16x32_bf16 v[60:63], a[32:35], v[124:127], v[60:63]
  ds_read_b64_tr_b16 v[120:121], v8 offset:25600
  v_mfma_f32_16x16x32_bf16 v[44:47], a[28:31], v[124:127], v[44:47]
  ds_read_b64_tr_b16 v[122:123], v9 offset:25600
  v_mfma_f32_16x16x32_bf16 v[28:31], a[24:27], v[124:127], v[28:31]
  s_waitcnt lgkmcnt(10)
  v_mfma_f32_16x16x32_bf16 v[64:67], a[24:27], v[128:131], v[64:67]
  ds_read_b64_tr_b16 v[124:125], v8 offset:25856
  v_mfma_f32_16x16x32_bf16 v[80:83], a[28:31], v[128:131], v[80:83]
  ds_read_b64_tr_b16 v[126:127], v9 offset:25856
  v_mfma_f32_16x16x32_bf16 v[96:99], a[32:35], v[128:131], v[96:99]
  buffer_load_dwordx4 v1, s[8:11], s28 offen offset:1024 sc1 lds
  v_mfma_f32_16x16x32_bf16 v[100:103], a[32:35], v[132:135], v[100:103]
  ds_read_b64_tr_b16 v[128:129], v8 offset:32768
  s_add_u32 m0, m0, 8192
  v_mfma_f32_16x16x32_bf16 v[84:87], a[28:31], v[132:135], v[84:87]
  ds_read_b64_tr_b16 v[130:131], v9 offset:32768
  s_add_u32 s28, s28, 8192
  v_mfma_f32_16x16x32_bf16 v[68:71], a[24:27], v[132:135], v[68:71]
  buffer_load_dwordx4 v1, s[8:11], s28 offen sc1 lds
  s_waitcnt lgkmcnt(10)
  v_mfma_f32_16x16x32_bf16 v[72:75], a[24:27], v[136:139], v[72:75]
  ds_read_b64_tr_b16 v[132:133], v8 offset:33024
  v_mfma_f32_16x16x32_bf16 v[88:91], a[28:31], v[136:139], v[88:91]
  ds_read_b64_tr_b16 v[134:135], v9 offset:33024
  v_mfma_f32_16x16x32_bf16 v[104:107], a[32:35], v[136:139], v[104:107]
  v_mfma_f32_16x16x32_bf16 v[108:111], a[32:35], v[140:143], v[108:111]
  ds_read_b64_tr_b16 v[136:137], v8 offset:33792
  v_mfma_f32_16x16x32_bf16 v[92:95], a[28:31], v[140:143], v[92:95]
  ds_read_b64_tr_b16 v[138:139], v9 offset:33792
  v_mfma_f32_16x16x32_bf16 v[76:79], a[24:27], v[140:143], v[76:79]
  buffer_load_dwordx4 v1, s[8:11], s28 offen offset:1024 sc1 lds
  s_waitcnt lgkmcnt(10)
  v_mfma_f32_16x16x32_bf16 v[16:19], a[36:39], v[112:115], v[16:19]
  ds_read_b64_tr_b16 v[140:141], v8 offset:34048
  s_add_u32 m0, m0, 8192
  v_mfma_f32_16x16x32_bf16 v[32:35], a[40:43], v[112:115], v[32:35]
  ds_read_b64_tr_b16 v[142:143], v9 offset:34048
  s_add_u32 s28, s28, 8192
  v_mfma_f32_16x16x32_bf16 v[48:51], a[44:47], v[112:115], v[48:51]
  buffer_load_dwordx4 v1, s[8:11], s28 offen sc1 lds
  s_waitcnt vmcnt(13)
  s_barrier
  v_mfma_f32_16x16x32_bf16 v[52:55], a[44:47], v[116:119], v[52:55]
  ds_read_b64_tr_b16 v[112:113], v8 offset:40960
  v_mfma_f32_16x16x32_bf16 v[36:39], a[40:43], v[116:119], v[36:39]
  ds_read_b64_tr_b16 v[114:115], v9 offset:40960
  v_mfma_f32_16x16x32_bf16 v[20:23], a[36:39], v[116:119], v[20:23]
  s_waitcnt lgkmcnt(10)
  v_mfma_f32_16x16x32_bf16 v[24:27], a[36:39], v[120:123], v[24:27]
  ds_read_b64_tr_b16 v[116:117], v8 offset:41216
  v_mfma_f32_16x16x32_bf16 v[40:43], a[40:43], v[120:123], v[40:43]
  ds_read_b64_tr_b16 v[118:119], v9 offset:41216
  v_mfma_f32_16x16x32_bf16 v[56:59], a[44:47], v[120:123], v[56:59]
  buffer_load_dwordx4 v1, s[8:11], s28 offen offset:1024 sc1 lds
  v_mfma_f32_16x16x32_bf16 v[60:63], a[44:47], v[124:127], v[60:63]
  ds_read_b64_tr_b16 v[120:121], v8 offset:41984
  s_add_u32 m0, m0, 8192
  v_mfma_f32_16x16x32_bf16 v[44:47], a[40:43], v[124:127], v[44:47]
  ds_read_b64_tr_b16 v[122:123], v9 offset:41984
  s_add_u32 s28, s28, 8192
  v_mfma_f32_16x16x32_bf16 v[28:31], a[36:39], v[124:127], v[28:31]
  buffer_load_dwordx4 v1, s[8:11], s28 offen sc1 lds
  s_waitcnt lgkmcnt(10)
  v_mfma_f32_16x16x32_bf16 v[16:19], a[48:51], v[128:131], v[16:19]
  ds_read_b64_tr_b16 v[124:125], v8 offset:42240
  v_mfma_f32_16x16x32_bf16 v[32:35], a[52:55], v[128:131], v[32:35]
  ds_read_b64_tr_b16 v[126:127], v9 offset:42240
  v_mfma_f32_16x16x32_bf16 v[48:51], a[56:59], v[128:131], v[48:51]
  v_mfma_f32_16x16x32_bf16 v[52:55], a[56:59], v[132:135], v[52:55]
  ds_read_b64_tr_b16 v[128:129], v8 offset:49152
  v_mfma_f32_16x16x32_bf16 v[36:39], a[52:55], v[132:135], v[36:39]
  ds_read_b64_tr_b16 v[130:131], v9 offset:49152
  v_mfma_f32_16x16x32_bf16 v[20:23], a[48:51], v[132:135], v[20:23]
  buffer_load_dwordx4 v1, s[8:11], s28 offen offset:1024 sc1 lds
  s_waitcnt lgkmcnt(10)
  v_mfma_f32_16x16x32_bf16 v[24:27], a[48:51], v[136:139], v[24:27]
  ds_read_b64_tr_b16 v[132:133], v8 offset:49408
  s_add_u32 m0, m0, 8192
  v_mfma_f32_16x16x32_bf16 v[40:43], a[52:55], v[136:139], v[40:43]
  ds_read_b64_tr_b16 v[134:135], v9 offset:49408
  s_add_u32 s28, s28, 8192
  v_mfma_f32_16x16x32_bf16 v[56:59], a[56:59], v[136:139], v[56:59]
  buffer_load_dwordx4 v1, s[8:11], s28 offen sc1 lds
  v_mfma_f32_16x16x32_bf16 v[60:63], a[56:59], v[140:143], v[60:63]
  ds_read_b64_tr_b16 v[136:137], v8 offset:50176
  v_mfma_f32_16x16x32_bf16 v[44:47], a[52:55], v[140:143], v[44:47]
  ds_read_b64_tr_b16 v[138:139], v9 offset:50176
  v_mfma_f32_16x16x32_bf16 v[28:31], a[48:51], v[140:143], v[28:31]
  s_waitcnt lgkmcnt(10)
  v_mfma_f32_16x16x32_bf16 v[16:19], a[60:63], v[112:115], v[16:19]
  ds_read_b64_tr_b16 v[140:141], v8 offset:50432
  v_mfma_f32_16x16x32_bf16 v[32:35], a[64:67], v[112:115], v[32:35]
  ds_read_b64_tr_b16 v[142:143], v9 offset:50432
  v_mfma_f32_16x16x32_bf16 v[48:51], a[68:71], v[112:115], v[48:51]
  buffer_load_dwordx4 v1, s[8:11], s28 offen offset:1024 sc1 lds
  s_waitcnt vmcnt(12)
  s_barrier
  v_mfma_f32_16x16x32_bf16 v[52:55], a[68:71], v[116:119], v[52:55]
  ds_read_b64_tr_b16 v[112:113], v8 offset:57344
  s_add_u32 m0, m0, 8192
  v_mfma_f32_16x16x32_bf16 v[36:39], a[64:67], v[116:119], v[36:39]
  ds_read_b64_tr_b16 v[114:115], v9 offset:57344
  s_add_u32 s28, s28, 8192
  v_mfma_f32_16x16x32_bf16 v[20:23], a[60:63], v[116:119], v[20:23]
  s_add_u32 s91, s32, 26480640
  s_waitcnt lgkmcnt(10)
  v_mfma_f32_16x16x32_bf16 v[24:27], a[60:63], v[120:123], v[24:27]
  ds_read_b64_tr_b16 v[116:117], v8 offset:57600
  v_mfma_f32_16x16x32_bf16 v[40:43], a[64:67], v[120:123], v[40:43]
  ds_read_b64_tr_b16 v[118:119], v9 offset:57600
  v_mfma_f32_16x16x32_bf16 v[56:59], a[68:71], v[120:123], v[56:59]
  buffer_load_dwordx4 v[160:163], v6, s[8:11], s91 offen offset:0 sc1
  v_mfma_f32_16x16x32_bf16 v[60:63], a[68:71], v[124:127], v[60:63]
  ds_read_b64_tr_b16 v[120:121], v8 offset:58368
  v_mfma_f32_16x16x32_bf16 v[44:47], a[64:67], v[124:127], v[44:47]
  ds_read_b64_tr_b16 v[122:123], v9 offset:58368
  v_mfma_f32_16x16x32_bf16 v[28:31], a[60:63], v[124:127], v[28:31]
  buffer_load_dwordx4 v[164:167], v6, s[8:11], s91 offen offset:256 sc1
  s_waitcnt lgkmcnt(10)
  v_mfma_f32_16x16x32_bf16 v[16:19], a[72:75], v[128:131], v[16:19]
  ds_read_b64_tr_b16 v[124:125], v8 offset:58624
  s_sub_u32 s91, s91, s57
  v_mfma_f32_16x16x32_bf16 v[32:35], a[76:79], v[128:131], v[32:35]
  ds_read_b64_tr_b16 v[126:127], v9 offset:58624
  v_mfma_f32_16x16x32_bf16 v[48:51], a[80:83], v[128:131], v[48:51]
  v_mfma_f32_16x16x32_bf16 v[52:55], a[80:83], v[132:135], v[52:55]
  ds_read_b64_tr_b16 v[128:129], v10 offset:0
  v_mfma_f32_16x16x32_bf16 v[36:39], a[76:79], v[132:135], v[36:39]
  ds_read_b64_tr_b16 v[130:131], v11 offset:0
  v_mfma_f32_16x16x32_bf16 v[20:23], a[72:75], v[132:135], v[20:23]
  buffer_load_dwordx4 v[168:171], v6, s[8:11], s91 offen offset:512 sc1
  s_waitcnt lgkmcnt(10)
  v_mfma_f32_16x16x32_bf16 v[24:27], a[72:75], v[136:139], v[24:27]
  ds_read_b64_tr_b16 v[132:133], v10 offset:256
  v_mfma_f32_16x16x32_bf16 v[40:43], a[76:79], v[136:139], v[40:43]
  ds_read_b64_tr_b16 v[134:135], v11 offset:256
  v_mfma_f32_16x16x32_bf16 v[56:59], a[80:83], v[136:139], v[56:59]
  buffer_load_dwordx4 v[172:175], v6, s[8:11], s91 offen offset:768 sc1
  v_mfma_f32_16x16x32_bf16 v[60:63], a[80:83], v[140:143], v[60:63]
  ds_read_b64_tr_b16 v[136:137], v10 offset:1024
  s_add_u32 s91, s32, 26484736
  v_mfma_f32_16x16x32_bf16 v[44:47], a[76:79], v[140:143], v[44:47]
  ds_read_b64_tr_b16 v[138:139], v11 offset:1024
  v_mfma_f32_16x16x32_bf16 v[28:31], a[72:75], v[140:143], v[28:31]
  s_waitcnt lgkmcnt(10)
  v_mfma_f32_16x16x32_bf16 v[16:19], a[84:87], v[112:115], v[16:19]
  ds_read_b64_tr_b16 v[140:141], v10 offset:1280
  v_mfma_f32_16x16x32_bf16 v[32:35], a[88:91], v[112:115], v[32:35]
  ds_read_b64_tr_b16 v[142:143], v11 offset:1280
  v_mfma_f32_16x16x32_bf16 v[48:51], a[92:95], v[112:115], v[48:51]
  buffer_load_dwordx4 v[176:179], v6, s[8:11], s91 offen offset:0 sc1
  v_mfma_f32_16x16x32_bf16 v[52:55], a[92:95], v[116:119], v[52:55]
  ds_read_b64_tr_b16 v[112:113], v10 offset:8192
  v_mfma_f32_16x16x32_bf16 v[36:39], a[88:91], v[116:119], v[36:39]
  ds_read_b64_tr_b16 v[114:115], v11 offset:8192
  v_mfma_f32_16x16x32_bf16 v[20:23], a[84:87], v[116:119], v[20:23]
  buffer_load_dwordx4 v[180:183], v6, s[8:11], s91 offen offset:256 sc1
  s_waitcnt lgkmcnt(10)
  v_mfma_f32_16x16x32_bf16 v[24:27], a[84:87], v[120:123], v[24:27]
  ds_read_b64_tr_b16 v[116:117], v10 offset:8448
  s_sub_u32 s91, s91, s57
  v_mfma_f32_16x16x32_bf16 v[40:43], a[88:91], v[120:123], v[40:43]
  ds_read_b64_tr_b16 v[118:119], v11 offset:8448
Lstub6:
  s_cbranch_execz Lret6_3950
  v_mfma_f32_16x16x32_bf16 v[56:59], a[92:95], v[120:123], v[56:59]
  v_mfma_f32_16x16x32_bf16 v[60:63], a[92:95], v[124:127], v[60:63]
  ds_read_b64_tr_b16 v[120:121], v10 offset:9216
  v_mfma_f32_16x16x32_bf16 v[44:47], a[88:91], v[124:127], v[44:47]
  ds_read_b64_tr_b16 v[122:123], v11 offset:9216
  v_mfma_f32_16x16x32_bf16 v[28:31], a[84:87], v[124:127], v[28:31]
  buffer_load_dwordx4 v[184:187], v6, s[8:11], s91 offen offset:512 sc1
  s_waitcnt lgkmcnt(10)
  v_mfma_f32_16x16x32_bf16 v[16:19], a[96:99], v[128:131], v[16:19]
  ds_read_b64_tr_b16 v[124:125], v10 offset:9472
  v_mfma_f32_16x16x32_bf16 v[32:35], a[100:103], v[128:131], v[32:35]
  ds_read_b64_tr_b16 v[126:127], v11 offset:9472
  v_mfma_f32_16x16x32_bf16 v[48:51], a[104:107], v[128:131], v[48:51]
  buffer_load_dwordx4 v[188:191], v6, s[8:11], s91 offen offset:768 sc1
  s_waitcnt vmcnt(12)
  s_barrier
  v_mfma_f32_16x16x32_bf16 v[52:55], a[104:107], v[132:135], v[52:55]
  ds_read_b64_tr_b16 v[128:129], v10 offset:16384
  s_add_u32 s91, s32, 26488832
  v_mfma_f32_16x16x32_bf16 v[36:39], a[100:103], v[132:135], v[36:39]
  ds_read_b64_tr_b16 v[130:131], v11 offset:16384
  v_mfma_f32_16x16x32_bf16 v[20:23], a[96:99], v[132:135], v[20:23]
  s_waitcnt lgkmcnt(10)
  v_mfma_f32_16x16x32_bf16 v[24:27], a[96:99], v[136:139], v[24:27]
  ds_read_b64_tr_b16 v[132:133], v10 offset:16640
  v_mfma_f32_16x16x32_bf16 v[40:43], a[100:103], v[136:139], v[40:43]
  ds_read_b64_tr_b16 v[134:135], v11 offset:16640
  v_mfma_f32_16x16x32_bf16 v[56:59], a[104:107], v[136:139], v[56:59]
  buffer_load_dwordx4 v[192:195], v6, s[8:11], s91 offen offset:0 sc1
  v_mfma_f32_16x16x32_bf16 v[60:63], a[104:107], v[140:143], v[60:63]
  ds_read_b64_tr_b16 v[136:137], v10 offset:17408
  v_mfma_f32_16x16x32_bf16 v[44:47], a[100:103], v[140:143], v[44:47]
  ds_read_b64_tr_b16 v[138:139], v11 offset:17408
  v_mfma_f32_16x16x32_bf16 v[28:31], a[96:99], v[140:143], v[28:31]
  buffer_load_dwordx4 v[196:199], v6, s[8:11], s91 offen offset:256 sc1
  s_waitcnt lgkmcnt(10)
  v_mfma_f32_16x16x32_bf16 v[16:19], a[108:111], v[112:115], v[16:19]
  ds_read_b64_tr_b16 v[140:141], v10 offset:17664
  s_sub_u32 s91, s91, s57
  v_mfma_f32_16x16x32_bf16 v[32:35], a[112:115], v[112:115], v[32:35]
  ds_read_b64_tr_b16 v[142:143], v11 offset:17664
  v_mfma_f32_16x16x32_bf16 v[48:51], a[116:119], v[112:115], v[48:51]
  v_mfma_f32_16x16x32_bf16 v[52:55], a[116:119], v[116:119], v[52:55]
  ds_read_b64_tr_b16 v[112:113], v10 offset:24576
  v_mfma_f32_16x16x32_bf16 v[36:39], a[112:115], v[116:119], v[36:39]
  ds_read_b64_tr_b16 v[114:115], v11 offset:24576
  v_mfma_f32_16x16x32_bf16 v[20:23], a[108:111], v[116:119], v[20:23]
  buffer_load_dwordx4 v[200:203], v6, s[8:11], s91 offen offset:512 sc1
  s_waitcnt lgkmcnt(10)
  v_mfma_f32_16x16x32_bf16 v[24:27], a[108:111], v[120:123], v[24:27]
  ds_read_b64_tr_b16 v[116:117], v10 offset:24832
  v_mfma_f32_16x16x32_bf16 v[40:43], a[112:115], v[120:123], v[40:43]
  ds_read_b64_tr_b16 v[118:119], v11 offset:24832
  v_mfma_f32_16x16x32_bf16 v[56:59], a[116:119], v[120:123], v[56:59]
  buffer_load_dwordx4 v[204:207], v6, s[8:11], s91 offen offset:768 sc1
  v_mfma_f32_16x16x32_bf16 v[60:63], a[116:119], v[124:127], v[60:63]
  ds_read_b64_tr_b16 v[120:121], v10 offset:25600
  s_add_u32 s91, s32, 26492928
  v_mfma_f32_16x16x32_bf16 v[44:47], a[112:115], v[124:127], v[44:47]
  ds_read_b64_tr_b16 v[122:123], v11 offset:25600
  v_mfma_f32_16x16x32_bf16 v[28:31], a[108:111], v[124:127], v[28:31]
  s_waitcnt lgkmcnt(10)
  v_mfma_f32_16x16x32_bf16 v[16:19], a[120:123], v[128:131], v[16:19]
  ds_read_b64_tr_b16 v[124:125], v10 offset:25856
  v_mfma_f32_16x16x32_bf16 v[32:35], a[124:127], v[128:131], v[32:35]
  ds_read_b64_tr_b16 v[126:127], v11 offset:25856
  v_mfma_f32_16x16x32_bf16 v[48:51], a[128:131], v[128:131], v[48:51]
  buffer_load_dwordx4 v[208:211], v6, s[8:11], s91 offen offset:0 sc1
  v_mfma_f32_16x16x32_bf16 v[52:55], a[128:131], v[132:135], v[52:55]
  ds_read_b64_tr_b16 v[128:129], v10 offset:32768
  v_mfma_f32_16x16x32_bf16 v[36:39], a[124:127], v[132:135], v[36:39]
  ds_read_b64_tr_b16 v[130:131], v11 offset:32768
  v_mfma_f32_16x16x32_bf16 v[20:23], a[120:123], v[132:135], v[20:23]
  buffer_load_dwordx4 v[212:215], v6, s[8:11], s91 offen offset:256 sc1
  s_waitcnt lgkmcnt(10)
  v_mfma_f32_16x16x32_bf16 v[24:27], a[120:123], v[136:139], v[24:27]
  ds_read_b64_tr_b16 v[132:133], v10 offset:33024
  s_sub_u32 s91, s91, s57
  v_mfma_f32_16x16x32_bf16 v[40:43], a[124:127], v[136:139], v[40:43]
  ds_read_b64_tr_b16 v[134:135], v11 offset:33024
  v_mfma_f32_16x16x32_bf16 v[56:59], a[128:131], v[136:139], v[56:59]
  v_mfma_f32_16x16x32_bf16 v[60:63], a[128:131], v[140:143], v[60:63]
  ds_read_b64_tr_b16 v[136:137], v10 offset:33792
  v_mfma_f32_16x16x32_bf16 v[44:47], a[124:127], v[140:143], v[44:47]
  ds_read_b64_tr_b16 v[138:139], v11 offset:33792
  v_mfma_f32_16x16x32_bf16 v[28:31], a[120:123], v[140:143], v[28:31]
  buffer_load_dwordx4 v[216:219], v6, s[8:11], s91 offen offset:512 sc1
  s_waitcnt lgkmcnt(10)
  v_mfma_f32_16x16x32_bf16 v[16:19], a[132:135], v[112:115], v[16:19]
  ds_read_b64_tr_b16 v[140:141], v10 offset:34048
  v_mfma_f32_16x16x32_bf16 v[32:35], a[136:139], v[112:115], v[32:35]
  ds_read_b64_tr_b16 v[142:143], v11 offset:34048
  v_mfma_f32_16x16x32_bf16 v[48:51], a[140:143], v[112:115], v[48:51]
  buffer_load_dwordx4 v[220:223], v6, s[8:11], s91 offen offset:768 sc1
  v_mfma_f32_16x16x32_bf16 v[52:55], a[140:143], v[116:119], v[52:55]
  ds_read_b64_tr_b16 v[112:113], v10 offset:40960
  s_add_u32 s91, s32, 26497024
  v_mfma_f32_16x16x32_bf16 v[36:39], a[136:139], v[116:119], v[36:39]
  ds_read_b64_tr_b16 v[114:115], v11 offset:40960
  v_mfma_f32_16x16x32_bf16 v[20:23], a[132:135], v[116:119], v[20:23]
  s_waitcnt lgkmcnt(10)
  v_mfma_f32_16x16x32_bf16 v[24:27], a[132:135], v[120:123], v[24:27]
  ds_read_b64_tr_b16 v[116:117], v10 offset:41216
  v_mfma_f32_16x16x32_bf16 v[40:43], a[136:139], v[120:123], v[40:43]
  ds_read_b64_tr_b16 v[118:119], v11 offset:41216
  v_mfma_f32_16x16x32_bf16 v[56:59], a[140:143], v[120:123], v[56:59]
  buffer_load_dwordx4 v[224:227], v6, s[8:11], s91 offen offset:0 sc1
  v_mfma_f32_16x16x32_bf16 v[60:63], a[140:143], v[124:127], v[60:63]
  ds_read_b64_tr_b16 v[120:121], v10 offset:41984
  v_mfma_f32_16x16x32_bf16 v[44:47], a[136:139], v[124:127], v[44:47]
  ds_read_b64_tr_b16 v[122:123], v11 offset:41984
  v_mfma_f32_16x16x32_bf16 v[28:31], a[132:135], v[124:127], v[28:31]
  buffer_load_dwordx4 v[228:231], v6, s[8:11], s91 offen offset:256 sc1
  s_waitcnt lgkmcnt(10)
  v_mfma_f32_16x16x32_bf16 v[16:19], a[144:147], v[128:131], v[16:19]
  ds_read_b64_tr_b16 v[124:125], v10 offset:42240
  s_sub_u32 s91, s91, s57
  v_mfma_f32_16x16x32_bf16 v[32:35], a[148:151], v[128:131], v[32:35]
  ds_read_b64_tr_b16 v[126:127], v11 offset:42240
  v_mfma_f32_16x16x32_bf16 v[48:51], a[152:155], v[128:131], v[48:51]
  s_waitcnt vmcnt(18)
  s_barrier
  v_mfma_f32_16x16x32_bf16 v[52:55], a[152:155], v[132:135], v[52:55]
  ds_read_b64_tr_b16 v[128:129], v10 offset:49152
  v_mfma_f32_16x16x32_bf16 v[36:39], a[148:151], v[132:135], v[36:39]
  ds_read_b64_tr_b16 v[130:131], v11 offset:49152
  v_mfma_f32_16x16x32_bf16 v[20:23], a[144:147], v[132:135], v[20:23]
  buffer_load_dwordx4 v[232:235], v6, s[8:11], s91 offen offset:512 sc1
  s_waitcnt lgkmcnt(10)
  v_mfma_f32_16x16x32_bf16 v[24:27], a[144:147], v[136:139], v[24:27]
  ds_read_b64_tr_b16 v[132:133], v10 offset:49408
  v_mfma_f32_16x16x32_bf16 v[40:43], a[148:151], v[136:139], v[40:43]
  ds_read_b64_tr_b16 v[134:135], v11 offset:49408
  v_mfma_f32_16x16x32_bf16 v[56:59], a[152:155], v[136:139], v[56:59]
  buffer_load_dwordx4 v[236:239], v6, s[8:11], s91 offen offset:768 sc1
  v_mfma_f32_16x16x32_bf16 v[60:63], a[152:155], v[140:143], v[60:63]
  ds_read_b64_tr_b16 v[136:137], v10 offset:50176
  s_add_u32 s91, s32, 26501120
  v_mfma_f32_16x16x32_bf16 v[44:47], a[148:151], v[140:143], v[44:47]
  ds_read_b64_tr_b16 v[138:139], v11 offset:50176
  v_mfma_f32_16x16x32_bf16 v[28:31], a[144:147], v[140:143], v[28:31]
  s_waitcnt lgkmcnt(10)
  v_mfma_f32_16x16x32_bf16 v[16:19], a[156:159], v[112:115], v[16:19]
  ds_read_b64_tr_b16 v[140:141], v10 offset:50432
  v_mfma_f32_16x16x32_bf16 v[32:35], a[160:163], v[112:115], v[32:35]
  ds_read_b64_tr_b16 v[142:143], v11 offset:50432
  v_mfma_f32_16x16x32_bf16 v[48:51], a[164:167], v[112:115], v[48:51]
  buffer_load_dwordx4 v[240:243], v6, s[8:11], s91 offen offset:0 sc1
  v_mfma_f32_16x16x32_bf16 v[52:55], a[164:167], v[116:119], v[52:55]
  ds_read_b64_tr_b16 v[112:113], v10 offset:57344
  v_mfma_f32_16x16x32_bf16 v[36:39], a[160:163], v[116:119], v[36:39]
  ds_read_b64_tr_b16 v[114:115], v11 offset:57344
  v_mfma_f32_16x16x32_bf16 v[20:23], a[156:159], v[116:119], v[20:23]
  s_waitcnt lgkmcnt(10)
  v_mfma_f32_16x16x32_bf16 v[24:27], a[156:159], v[120:123], v[24:27]
  ds_read_b64_tr_b16 v[116:117], v10 offset:57600
  v_mfma_f32_16x16x32_bf16 v[40:43], a[160:163], v[120:123], v[40:43]
  ds_read_b64_tr_b16 v[118:119], v11 offset:57600
  v_mfma_f32_16x16x32_bf16 v[56:59], a[164:167], v[120:123], v[56:59]
  buffer_load_dwordx4 v[244:247], v6, s[8:11], s91 offen offset:256 sc1
  v_mfma_f32_16x16x32_bf16 v[60:63], a[164:167], v[124:127], v[60:63]
  ds_read_b64_tr_b16 v[120:121], v10 offset:58368
  s_sub_u32 s91, s91, s57
  v_mfma_f32_16x16x32_bf16 v[44:47], a[160:163], v[124:127], v[44:47]
  ds_read_b64_tr_b16 v[122:123], v11 offset:58368
  v_mfma_f32_16x16x32_bf16 v[28:31], a[156:159], v[124:127], v[28:31]
  buffer_load_dwordx4 v[248:251], v6, s[8:11], s91 offen offset:512 sc1
  s_waitcnt lgkmcnt(10)
  v_mfma_f32_16x16x32_bf16 v[16:19], a[168:171], v[128:131], v[16:19]
  ds_read_b64_tr_b16 v[124:125], v10 offset:58624
  v_mfma_f32_16x16x32_bf16 v[32:35], a[172:175], v[128:131], v[32:35]
  ds_read_b64_tr_b16 v[126:127], v11 offset:58624
  v_mfma_f32_16x16x32_bf16 v[48:51], a[176:179], v[128:131], v[48:51]
  v_mfma_f32_16x16x32_bf16 v[52:55], a[176:179], v[132:135], v[52:55]
  ds_read_b64_tr_b16 v[128:129], v8 offset:25088
  v_mfma_f32_16x16x32_bf16 v[36:39], a[172:175], v[132:135], v[36:39]
  ds_read_b64_tr_b16 v[130:131], v9 offset:25088
  v_mfma_f32_16x16x32_bf16 v[20:23], a[168:171], v[132:135], v[20:23]
  buffer_load_dwordx4 v[252:255], v6, s[8:11], s91 offen offset:768 sc1
  s_waitcnt lgkmcnt(10)
  v_mfma_f32_16x16x32_bf16 v[24:27], a[168:171], v[136:139], v[24:27]
  ds_read_b64_tr_b16 v[132:133], v8 offset:25344
  v_mfma_f32_16x16x32_bf16 v[40:43], a[172:175], v[136:139], v[40:43]
  ds_read_b64_tr_b16 v[134:135], v9 offset:25344
  v_mfma_f32_16x16x32_bf16 v[56:59], a[176:179], v[136:139], v[56:59]
  buffer_load_dwordx4 a[0:3], v1, s[8:11], s88 offen offset:0 sc1
  v_mfma_f32_16x16x32_bf16 v[60:63], a[176:179], v[140:143], v[60:63]
  ds_read_b64_tr_b16 v[136:137], v8 offset:26112
  v_mfma_f32_16x16x32_bf16 v[44:47], a[172:175], v[140:143], v[44:47]
  ds_read_b64_tr_b16 v[138:139], v9 offset:26112
  v_mfma_f32_16x16x32_bf16 v[28:31], a[168:171], v[140:143], v[28:31]
  s_waitcnt lgkmcnt(10)
  v_mfma_f32_16x16x32_bf16 v[16:19], a[180:183], v[112:115], v[16:19]
  ds_read_b64_tr_b16 v[140:141], v8 offset:26368
  v_mfma_f32_16x16x32_bf16 v[32:35], a[184:187], v[112:115], v[32:35]
  ds_read_b64_tr_b16 v[142:143], v9 offset:26368
  v_mfma_f32_16x16x32_bf16 v[48:51], a[188:191], v[112:115], v[48:51]
  buffer_load_dwordx4 a[4:7], v1, s[8:11], s89 offen offset:0 sc1
  v_mfma_f32_16x16x32_bf16 v[52:55], a[188:191], v[116:119], v[52:55]
  ds_read_b64_tr_b16 v[112:113], v8 offset:33280
  v_mfma_f32_16x16x32_bf16 v[36:39], a[184:187], v[116:119], v[36:39]
  ds_read_b64_tr_b16 v[114:115], v9 offset:33280
  v_mfma_f32_16x16x32_bf16 v[20:23], a[180:183], v[116:119], v[20:23]
  buffer_load_dwordx4 a[8:11], v1, s[8:11], s90 offen offset:0 sc1
  s_waitcnt lgkmcnt(10)
  v_mfma_f32_16x16x32_bf16 v[24:27], a[180:183], v[120:123], v[24:27]
  ds_read_b64_tr_b16 v[116:117], v8 offset:33536
  v_mfma_f32_16x16x32_bf16 v[40:43], a[184:187], v[120:123], v[40:43]
  ds_read_b64_tr_b16 v[118:119], v9 offset:33536
  v_mfma_f32_16x16x32_bf16 v[56:59], a[188:191], v[120:123], v[56:59]
  v_mfma_f32_16x16x32_bf16 v[60:63], a[188:191], v[124:127], v[60:63]
  ds_read_b64_tr_b16 v[120:121], v8 offset:34304
  v_mfma_f32_16x16x32_bf16 v[44:47], a[184:187], v[124:127], v[44:47]
  ds_read_b64_tr_b16 v[122:123], v9 offset:34304
  v_mfma_f32_16x16x32_bf16 v[28:31], a[180:183], v[124:127], v[28:31]
  buffer_load_dwordx4 a[12:15], v1, s[8:11], s94 offen offset:0 sc1
  s_waitcnt lgkmcnt(10)
  v_mfma_f32_16x16x32_bf16 v[64:67], a[36:39], v[128:131], v[64:67]
  ds_read_b64_tr_b16 v[124:125], v8 offset:34560
  v_mfma_f32_16x16x32_bf16 v[80:83], a[40:43], v[128:131], v[80:83]
  ds_read_b64_tr_b16 v[126:127], v9 offset:34560
  v_mfma_f32_16x16x32_bf16 v[96:99], a[44:47], v[128:131], v[96:99]
  buffer_load_dwordx4 a[16:19], v1, s[8:11], s88 offen offset:1024 sc1
  v_mfma_f32_16x16x32_bf16 v[100:103], a[44:47], v[132:135], v[100:103]
  ds_read_b64_tr_b16 v[128:129], v8 offset:41472
  v_mfma_f32_16x16x32_bf16 v[84:87], a[40:43], v[132:135], v[84:87]
  ds_read_b64_tr_b16 v[130:131], v9 offset:41472
  v_mfma_f32_16x16x32_bf16 v[68:71], a[36:39], v[132:135], v[68:71]
  s_waitcnt lgkmcnt(10)
  v_mfma_f32_16x16x32_bf16 v[72:75], a[36:39], v[136:139], v[72:75]
  ds_read_b64_tr_b16 v[132:133], v8 offset:41728
  v_max_f32 v48, 0, v48
  v_mfma_f32_16x16x32_bf16 v[88:91], a[40:43], v[136:139], v[88:91]
  ds_read_b64_tr_b16 v[134:135], v9 offset:41728
  v_max_f32 v49, 0, v49
  v_mfma_f32_16x16x32_bf16 v[104:107], a[44:47], v[136:139], v[104:107]
  buffer_load_dwordx4 a[20:23], v1, s[8:11], s89 offen offset:1024 sc1
  v_mul_f32 v48, v48, v50
  v_mfma_f32_16x16x32_bf16 v[108:111], a[44:47], v[140:143], v[108:111]
  ds_read_b64_tr_b16 v[136:137], v8 offset:42496
  v_mul_f32 v49, v49, v51
  v_mfma_f32_16x16x32_bf16 v[92:95], a[40:43], v[140:143], v[92:95]
  ds_read_b64_tr_b16 v[138:139], v9 offset:42496
  v_cvt_pk_bf16_f32 v48, v48, v49
  v_mfma_f32_16x16x32_bf16 v[76:79], a[36:39], v[140:143], v[76:79]
  buffer_load_dwordx4 a[24:27], v1, s[8:11], s90 offen offset:1024 sc1
  v_max_f32 v52, 0, v52
  s_waitcnt lgkmcnt(10)
  v_mfma_f32_16x16x32_bf16 v[64:67], a[48:51], v[112:115], v[64:67]
  ds_read_b64_tr_b16 v[140:141], v8 offset:42752
  v_max_f32 v53, 0, v53
  v_mfma_f32_16x16x32_bf16 v[80:83], a[52:55], v[112:115], v[80:83]
  ds_read_b64_tr_b16 v[142:143], v9 offset:42752
  v_mul_f32 v52, v52, v54
  v_mfma_f32_16x16x32_bf16 v[96:99], a[56:59], v[112:115], v[96:99]
  v_mul_f32 v53, v53, v55
  v_cvt_pk_bf16_f32 v49, v52, v53
  v_mfma_f32_16x16x32_bf16 v[100:103], a[56:59], v[116:119], v[100:103]
  ds_read_b64_tr_b16 v[112:113], v8 offset:49664
  v_max_f32 v56, 0, v56
  v_mfma_f32_16x16x32_bf16 v[84:87], a[52:55], v[116:119], v[84:87]
  ds_read_b64_tr_b16 v[114:115], v9 offset:49664
  v_max_f32 v57, 0, v57
  v_mfma_f32_16x16x32_bf16 v[68:71], a[48:51], v[116:119], v[68:71]
  buffer_load_dwordx4 a[28:31], v1, s[8:11], s94 offen offset:1024 sc1
  v_mul_f32 v56, v56, v58
  s_waitcnt lgkmcnt(10)
  v_mfma_f32_16x16x32_bf16 v[72:75], a[48:51], v[120:123], v[72:75]
  ds_read_b64_tr_b16 v[116:117], v8 offset:49920
  v_mul_f32 v57, v57, v59
  v_mfma_f32_16x16x32_bf16 v[88:91], a[52:55], v[120:123], v[88:91]
  ds_read_b64_tr_b16 v[118:119], v9 offset:49920
  v_cvt_pk_bf16_f32 v50, v56, v57
  v_mfma_f32_16x16x32_bf16 v[104:107], a[56:59], v[120:123], v[104:107]
  buffer_load_dwordx4 a[32:35], v1, s[8:11], s88 offen offset:2048 sc1
  v_max_f32 v60, 0, v60
  v_mfma_f32_16x16x32_bf16 v[108:111], a[56:59], v[124:127], v[108:111]
  ds_read_b64_tr_b16 v[120:121], v8 offset:50688
  v_max_f32 v61, 0, v61
  v_mfma_f32_16x16x32_bf16 v[92:95], a[52:55], v[124:127], v[92:95]
  ds_read_b64_tr_b16 v[122:123], v9 offset:50688
  v_mul_f32 v60, v60, v62
  v_mfma_f32_16x16x32_bf16 v[76:79], a[48:51], v[124:127], v[76:79]
  v_mul_f32 v61, v61, v63
  v_cvt_pk_bf16_f32 v51, v60, v61
  s_waitcnt lgkmcnt(10)
  v_mfma_f32_16x16x32_bf16 v[64:67], a[60:63], v[128:131], v[64:67]
  ds_read_b64_tr_b16 v[124:125], v8 offset:50944
  v_permlane32_swap_b32 v48, v50
  v_mfma_f32_16x16x32_bf16 v[80:83], a[64:67], v[128:131], v[80:83]
  ds_read_b64_tr_b16 v[126:127], v9 offset:50944
  v_permlane32_swap_b32 v49, v51
  v_mfma_f32_16x16x32_bf16 v[96:99], a[68:71], v[128:131], v[96:99]
  buffer_load_dwordx4 a[36:39], v1, s[8:11], s89 offen offset:2048 sc1
  v_permlane16_swap_b32 v48, v49
  v_mfma_f32_16x16x32_bf16 v[100:103], a[68:71], v[132:135], v[100:103]
  ds_read_b64_tr_b16 v[128:129], v8 offset:57856
  v_permlane16_swap_b32 v50, v51
  v_mfma_f32_16x16x32_bf16 v[84:87], a[64:67], v[132:135], v[84:87]
  ds_read_b64_tr_b16 v[130:131], v9 offset:57856
  buffer_store_dwordx4 v[48:51], v13, s[8:11], s42 offen offset:0 sc1
  v_mfma_f32_16x16x32_bf16 v[68:71], a[60:63], v[132:135], v[68:71]
  buffer_load_dwordx4 a[40:43], v1, s[8:11], s90 offen offset:2048 sc1
  v_max_f32 v16, 0, v16
  s_waitcnt lgkmcnt(10)
  v_mfma_f32_16x16x32_bf16 v[72:75], a[60:63], v[136:139], v[72:75]
  ds_read_b64_tr_b16 v[132:133], v8 offset:58112
  v_max_f32 v17, 0, v17
  v_mfma_f32_16x16x32_bf16 v[88:91], a[64:67], v[136:139], v[88:91]
  ds_read_b64_tr_b16 v[134:135], v9 offset:58112
  v_max_f32 v18, 0, v18
  v_mfma_f32_16x16x32_bf16 v[104:107], a[68:71], v[136:139], v[104:107]
  v_max_f32 v19, 0, v19
  v_max_f32 v20, 0, v20
  v_mfma_f32_16x16x32_bf16 v[108:111], a[68:71], v[140:143], v[108:111]
  ds_read_b64_tr_b16 v[136:137], v8 offset:58880
  v_max_f32 v21, 0, v21
  v_mfma_f32_16x16x32_bf16 v[92:95], a[64:67], v[140:143], v[92:95]
  ds_read_b64_tr_b16 v[138:139], v9 offset:58880
  v_max_f32 v22, 0, v22
  v_mfma_f32_16x16x32_bf16 v[76:79], a[60:63], v[140:143], v[76:79]
  buffer_load_dwordx4 a[44:47], v1, s[8:11], s94 offen offset:2048 sc1
  v_max_f32 v23, 0, v23
  s_waitcnt lgkmcnt(10)
  v_mfma_f32_16x16x32_bf16 v[64:67], a[72:75], v[112:115], v[64:67]
  ds_read_b64_tr_b16 v[140:141], v8 offset:59136
  v_max_f32 v24, 0, v24
  v_mfma_f32_16x16x32_bf16 v[80:83], a[76:79], v[112:115], v[80:83]
  ds_read_b64_tr_b16 v[142:143], v9 offset:59136
  v_max_f32 v25, 0, v25
  v_mfma_f32_16x16x32_bf16 v[96:99], a[80:83], v[112:115], v[96:99]
  buffer_load_dwordx4 a[48:51], v1, s[8:11], s88 offen offset:3072 sc1
  v_max_f32 v26, 0, v26
  v_mfma_f32_16x16x32_bf16 v[100:103], a[80:83], v[116:119], v[100:103]
  ds_read_b64_tr_b16 v[112:113], v10 offset:512
  v_max_f32 v27, 0, v27
  v_mfma_f32_16x16x32_bf16 v[84:87], a[76:79], v[116:119], v[84:87]
  ds_read_b64_tr_b16 v[114:115], v11 offset:512
  v_max_f32 v28, 0, v28
  v_mfma_f32_16x16x32_bf16 v[68:71], a[72:75], v[116:119], v[68:71]
  v_max_f32 v29, 0, v29
  v_max_f32 v30, 0, v30
  s_waitcnt lgkmcnt(10)
  v_mfma_f32_16x16x32_bf16 v[72:75], a[72:75], v[120:123], v[72:75]
  ds_read_b64_tr_b16 v[116:117], v10 offset:768
  v_max_f32 v31, 0, v31
  v_mfma_f32_16x16x32_bf16 v[88:91], a[76:79], v[120:123], v[88:91]
  ds_read_b64_tr_b16 v[118:119], v11 offset:768
  v_mul_f32 v16, v16, v32
  v_mfma_f32_16x16x32_bf16 v[104:107], a[80:83], v[120:123], v[104:107]
  buffer_load_dwordx4 a[52:55], v1, s[8:11], s89 offen offset:3072 sc1
  v_mul_f32 v17, v17, v33
  v_mfma_f32_16x16x32_bf16 v[108:111], a[80:83], v[124:127], v[108:111]
  ds_read_b64_tr_b16 v[120:121], v10 offset:1536
  v_mul_f32 v18, v18, v34
  v_mfma_f32_16x16x32_bf16 v[92:95], a[76:79], v[124:127], v[92:95]
  ds_read_b64_tr_b16 v[122:123], v11 offset:1536
  v_mul_f32 v19, v19, v35
  v_mfma_f32_16x16x32_bf16 v[76:79], a[72:75], v[124:127], v[76:79]
  buffer_load_dwordx4 a[56:59], v1, s[8:11], s90 offen offset:3072 sc1
  v_mul_f32 v20, v20, v36
  s_waitcnt lgkmcnt(10)
  v_mfma_f32_16x16x32_bf16 v[64:67], a[84:87], v[128:131], v[64:67]
  ds_read_b64_tr_b16 v[124:125], v10 offset:1792
  v_mul_f32 v21, v21, v37
  v_mfma_f32_16x16x32_bf16 v[80:83], a[88:91], v[128:131], v[80:83]
  ds_read_b64_tr_b16 v[126:127], v11 offset:1792
  v_mul_f32 v22, v22, v38
  v_mfma_f32_16x16x32_bf16 v[96:99], a[92:95], v[128:131], v[96:99]
  v_mul_f32 v23, v23, v39
  v_cvt_pk_bf16_f32 v32, v16, v17
  v_mfma_f32_16x16x32_bf16 v[100:103], a[92:95], v[132:135], v[100:103]
  ds_read_b64_tr_b16 v[128:129], v10 offset:8704
  v_cvt_pk_bf16_f32 v33, v18, v19
  v_mfma_f32_16x16x32_bf16 v[84:87], a[88:91], v[132:135], v[84:87]
  ds_read_b64_tr_b16 v[130:131], v11 offset:8704
  v_cvt_pk_bf16_f32 v34, v20, v21
  v_mfma_f32_16x16x32_bf16 v[68:71], a[84:87], v[132:135], v[68:71]
  buffer_load_dwordx4 a[60:63], v1, s[8:11], s94 offen offset:3072 sc1
  v_cvt_pk_bf16_f32 v35, v22, v23
  s_waitcnt lgkmcnt(10)
  v_mfma_f32_16x16x32_bf16 v[72:75], a[84:87], v[136:139], v[72:75]
  ds_read_b64_tr_b16 v[132:133], v10 offset:8960
  v_permlane16_swap_b32 v32, v34
  v_mfma_f32_16x16x32_bf16 v[88:91], a[88:91], v[136:139], v[88:91]
  ds_read_b64_tr_b16 v[134:135], v11 offset:8960
  v_permlane16_swap_b32 v33, v35
  v_mfma_f32_16x16x32_bf16 v[104:107], a[92:95], v[136:139], v[104:107]
  buffer_store_dwordx4 v[32:35], v5, s[8:11], s40 offen offset:0 sc1
  v_mul_f32 v24, v24, v40
  v_mfma_f32_16x16x32_bf16 v[108:111], a[92:95], v[140:143], v[108:111]
  ds_read_b64_tr_b16 v[136:137], v10 offset:9728
  v_mul_f32 v25, v25, v41
  v_mfma_f32_16x16x32_bf16 v[92:95], a[88:91], v[140:143], v[92:95]
  ds_read_b64_tr_b16 v[138:139], v11 offset:9728
  v_mul_f32 v26, v26, v42
  v_mfma_f32_16x16x32_bf16 v[76:79], a[84:87], v[140:143], v[76:79]
  v_mul_f32 v27, v27, v43
  v_mul_f32 v28, v28, v44
  s_waitcnt lgkmcnt(10)
  v_mfma_f32_16x16x32_bf16 v[64:67], a[96:99], v[112:115], v[64:67]
  ds_read_b64_tr_b16 v[140:141], v10 offset:9984
  v_mul_f32 v29, v29, v45
  v_mfma_f32_16x16x32_bf16 v[80:83], a[100:103], v[112:115], v[80:83]
  ds_read_b64_tr_b16 v[142:143], v11 offset:9984
  v_mul_f32 v30, v30, v46
  v_mfma_f32_16x16x32_bf16 v[96:99], a[104:107], v[112:115], v[96:99]
  v_mul_f32 v31, v31, v47
  v_cvt_pk_bf16_f32 v40, v24, v25
  v_mfma_f32_16x16x32_bf16 v[100:103], a[104:107], v[116:119], v[100:103]
  ds_read_b64_tr_b16 v[112:113], v10 offset:16896
  v_cvt_pk_bf16_f32 v41, v26, v27
  v_mfma_f32_16x16x32_bf16 v[84:87], a[100:103], v[116:119], v[84:87]
  ds_read_b64_tr_b16 v[114:115], v11 offset:16896
  v_cvt_pk_bf16_f32 v42, v28, v29
  v_mfma_f32_16x16x32_bf16 v[68:71], a[96:99], v[116:119], v[68:71]
  v_cvt_pk_bf16_f32 v43, v30, v31
  v_permlane16_swap_b32 v40, v42
  s_waitcnt lgkmcnt(10)
  v_mfma_f32_16x16x32_bf16 v[72:75], a[96:99], v[120:123], v[72:75]
  ds_read_b64_tr_b16 v[116:117], v10 offset:17152
  v_permlane16_swap_b32 v41, v43
  v_mfma_f32_16x16x32_bf16 v[88:91], a[100:103], v[120:123], v[88:91]
  ds_read_b64_tr_b16 v[118:119], v11 offset:17152
  buffer_store_dwordx4 v[40:43], v5, s[8:11], s41 offen offset:0 sc1
  v_mfma_f32_16x16x32_bf16 v[104:107], a[104:107], v[120:123], v[104:107]
  v_mfma_f32_16x16x32_bf16 v[108:111], a[104:107], v[124:127], v[108:111]
  ds_read_b64_tr_b16 v[120:121], v10 offset:17920
  v_mfma_f32_16x16x32_bf16 v[92:95], a[100:103], v[124:127], v[92:95]
  ds_read_b64_tr_b16 v[122:123], v11 offset:17920
  v_mfma_f32_16x16x32_bf16 v[76:79], a[96:99], v[124:127], v[76:79]
  s_waitcnt lgkmcnt(10)
  v_mfma_f32_16x16x32_bf16 v[64:67], a[108:111], v[128:131], v[64:67]
  ds_read_b64_tr_b16 v[124:125], v10 offset:18176
  v_mfma_f32_16x16x32_bf16 v[80:83], a[112:115], v[128:131], v[80:83]
  ds_read_b64_tr_b16 v[126:127], v11 offset:18176
  v_mfma_f32_16x16x32_bf16 v[96:99], a[116:119], v[128:131], v[96:99]
  v_mfma_f32_16x16x32_bf16 v[100:103], a[116:119], v[132:135], v[100:103]
  ds_read_b64_tr_b16 v[128:129], v10 offset:25088
  v_mfma_f32_16x16x32_bf16 v[84:87], a[112:115], v[132:135], v[84:87]
  ds_read_b64_tr_b16 v[130:131], v11 offset:25088
  v_mfma_f32_16x16x32_bf16 v[68:71], a[108:111], v[132:135], v[68:71]
  s_waitcnt lgkmcnt(10)
  v_mfma_f32_16x16x32_bf16 v[72:75], a[108:111], v[136:139], v[72:75]
  ds_read_b64_tr_b16 v[132:133], v10 offset:25344
  v_mfma_f32_16x16x32_bf16 v[88:91], a[112:115], v[136:139], v[88:91]
  ds_read_b64_tr_b16 v[134:135], v11 offset:25344
  v_mfma_f32_16x16x32_bf16 v[104:107], a[116:119], v[136:139], v[104:107]
  v_mfma_f32_16x16x32_bf16 v[108:111], a[116:119], v[140:143], v[108:111]
  ds_read_b64_tr_b16 v[136:137], v10 offset:26112
  v_mfma_f32_16x16x32_bf16 v[92:95], a[112:115], v[140:143], v[92:95]
  ds_read_b64_tr_b16 v[138:139], v11 offset:26112
  v_mfma_f32_16x16x32_bf16 v[76:79], a[108:111], v[140:143], v[76:79]
  s_waitcnt lgkmcnt(10)
  v_mfma_f32_16x16x32_bf16 v[64:67], a[120:123], v[112:115], v[64:67]
  ds_read_b64_tr_b16 v[140:141], v10 offset:26368
  v_mfma_f32_16x16x32_bf16 v[80:83], a[124:127], v[112:115], v[80:83]
  ds_read_b64_tr_b16 v[142:143], v11 offset:26368
  v_mfma_f32_16x16x32_bf16 v[96:99], a[128:131], v[112:115], v[96:99]
  v_mfma_f32_16x16x32_bf16 v[100:103], a[128:131], v[116:119], v[100:103]
  ds_read_b64_tr_b16 v[112:113], v10 offset:33280
  v_mfma_f32_16x16x32_bf16 v[84:87], a[124:127], v[116:119], v[84:87]
  ds_read_b64_tr_b16 v[114:115], v11 offset:33280
  v_mfma_f32_16x16x32_bf16 v[68:71], a[120:123], v[116:119], v[68:71]
  s_waitcnt lgkmcnt(10)
  v_mfma_f32_16x16x32_bf16 v[72:75], a[120:123], v[120:123], v[72:75]
  ds_read_b64_tr_b16 v[116:117], v10 offset:33536
  v_mfma_f32_16x16x32_bf16 v[88:91], a[124:127], v[120:123], v[88:91]
  ds_read_b64_tr_b16 v[118:119], v11 offset:33536
  v_mfma_f32_16x16x32_bf16 v[104:107], a[128:131], v[120:123], v[104:107]
  v_mfma_f32_16x16x32_bf16 v[108:111], a[128:131], v[124:127], v[108:111]
  ds_read_b64_tr_b16 v[120:121], v10 offset:34304
  v_mfma_f32_16x16x32_bf16 v[92:95], a[124:127], v[124:127], v[92:95]
  ds_read_b64_tr_b16 v[122:123], v11 offset:34304
  v_mfma_f32_16x16x32_bf16 v[76:79], a[120:123], v[124:127], v[76:79]
  s_waitcnt lgkmcnt(10)
  v_mfma_f32_16x16x32_bf16 v[64:67], a[132:135], v[128:131], v[64:67]
  ds_read_b64_tr_b16 v[124:125], v10 offset:34560
  v_mfma_f32_16x16x32_bf16 v[80:83], a[136:139], v[128:131], v[80:83]
  ds_read_b64_tr_b16 v[126:127], v11 offset:34560
  v_mfma_f32_16x16x32_bf16 v[96:99], a[140:143], v[128:131], v[96:99]
  v_mfma_f32_16x16x32_bf16 v[100:103], a[140:143], v[132:135], v[100:103]
  ds_read_b64_tr_b16 v[128:129], v10 offset:41472
  v_mfma_f32_16x16x32_bf16 v[84:87], a[136:139], v[132:135], v[84:87]
  ds_read_b64_tr_b16 v[130:131], v11 offset:41472
  v_mfma_f32_16x16x32_bf16 v[68:71], a[132:135], v[132:135], v[68:71]
  s_waitcnt lgkmcnt(10)
  v_mfma_f32_16x16x32_bf16 v[72:75], a[132:135], v[136:139], v[72:75]
  ds_read_b64_tr_b16 v[132:133], v10 offset:41728
  v_mfma_f32_16x16x32_bf16 v[88:91], a[136:139], v[136:139], v[88:91]
  ds_read_b64_tr_b16 v[134:135], v11 offset:41728
  v_mfma_f32_16x16x32_bf16 v[104:107], a[140:143], v[136:139], v[104:107]
  v_mfma_f32_16x16x32_bf16 v[108:111], a[140:143], v[140:143], v[108:111]
  ds_read_b64_tr_b16 v[136:137], v10 offset:42496
  v_mfma_f32_16x16x32_bf16 v[92:95], a[136:139], v[140:143], v[92:95]
  ds_read_b64_tr_b16 v[138:139], v11 offset:42496
  v_mfma_f32_16x16x32_bf16 v[76:79], a[132:135], v[140:143], v[76:79]
  s_waitcnt lgkmcnt(10)
  v_mfma_f32_16x16x32_bf16 v[64:67], a[144:147], v[112:115], v[64:67]
  ds_read_b64_tr_b16 v[140:141], v10 offset:42752
  v_mfma_f32_16x16x32_bf16 v[80:83], a[148:151], v[112:115], v[80:83]
  ds_read_b64_tr_b16 v[142:143], v11 offset:42752
  v_mfma_f32_16x16x32_bf16 v[96:99], a[152:155], v[112:115], v[96:99]
  v_mfma_f32_16x16x32_bf16 v[100:103], a[152:155], v[116:119], v[100:103]
  ds_read_b64_tr_b16 v[112:113], v10 offset:49664
  v_mfma_f32_16x16x32_bf16 v[84:87], a[148:151], v[116:119], v[84:87]
  ds_read_b64_tr_b16 v[114:115], v11 offset:49664
  v_mfma_f32_16x16x32_bf16 v[68:71], a[144:147], v[116:119], v[68:71]
  s_waitcnt lgkmcnt(10)
  v_mfma_f32_16x16x32_bf16 v[72:75], a[144:147], v[120:123], v[72:75]
  ds_read_b64_tr_b16 v[116:117], v10 offset:49920
  v_mfma_f32_16x16x32_bf16 v[88:91], a[148:151], v[120:123], v[88:91]
  ds_read_b64_tr_b16 v[118:119], v11 offset:49920
  v_mfma_f32_16x16x32_bf16 v[104:107], a[152:155], v[120:123], v[104:107]
  v_mfma_f32_16x16x32_bf16 v[108:111], a[152:155], v[124:127], v[108:111]
  ds_read_b64_tr_b16 v[120:121], v10 offset:50688
  v_mfma_f32_16x16x32_bf16 v[92:95], a[148:151], v[124:127], v[92:95]
  ds_read_b64_tr_b16 v[122:123], v11 offset:50688
  v_mfma_f32_16x16x32_bf16 v[76:79], a[144:147], v[124:127], v[76:79]
  s_waitcnt lgkmcnt(10)
  v_mfma_f32_16x16x32_bf16 v[64:67], a[156:159], v[128:131], v[64:67]
  ds_read_b64_tr_b16 v[124:125], v10 offset:50944
  v_mfma_f32_16x16x32_bf16 v[80:83], a[160:163], v[128:131], v[80:83]
  ds_read_b64_tr_b16 v[126:127], v11 offset:50944
  v_mfma_f32_16x16x32_bf16 v[96:99], a[164:167], v[128:131], v[96:99]
  v_mfma_f32_16x16x32_bf16 v[100:103], a[164:167], v[132:135], v[100:103]
  ds_read_b64_tr_b16 v[128:129], v10 offset:57856
  v_mfma_f32_16x16x32_bf16 v[84:87], a[160:163], v[132:135], v[84:87]
  ds_read_b64_tr_b16 v[130:131], v11 offset:57856
  v_mfma_f32_16x16x32_bf16 v[68:71], a[156:159], v[132:135], v[68:71]
  s_waitcnt vmcnt(0)
  s_barrier
  s_mov_b64 exec, 1
  buffer_atomic_add v7, v15, s[8:11], s25 offen sc1
  s_mov_b64 exec, -1
  s_waitcnt lgkmcnt(10)
  v_mfma_f32_16x16x32_bf16 v[72:75], a[156:159], v[136:139], v[72:75]
  ds_read_b64_tr_b16 v[132:133], v10 offset:58112
  v_mfma_f32_16x16x32_bf16 v[88:91], a[160:163], v[136:139], v[88:91]
  ds_read_b64_tr_b16 v[134:135], v11 offset:58112
  v_mfma_f32_16x16x32_bf16 v[104:107], a[164:167], v[136:139], v[104:107]
  v_mfma_f32_16x16x32_bf16 v[108:111], a[164:167], v[140:143], v[108:111]
  ds_read_b64_tr_b16 v[136:137], v10 offset:58880
  v_mfma_f32_16x16x32_bf16 v[92:95], a[160:163], v[140:143], v[92:95]
  ds_read_b64_tr_b16 v[138:139], v11 offset:58880
  v_mfma_f32_16x16x32_bf16 v[76:79], a[156:159], v[140:143], v[76:79]
  ds_read_b64_tr_b16 v[140:141], v10 offset:59136
  ds_read_b64_tr_b16 v[142:143], v11 offset:59136
  s_waitcnt lgkmcnt(12)
  v_mfma_f32_16x16x32_bf16 v[96:99], a[176:179], v[112:115], v[96:99]
  v_mfma_f32_16x16x32_bf16 v[100:103], a[176:179], v[116:119], v[100:103]
  s_waitcnt lgkmcnt(8)
  v_mfma_f32_16x16x32_bf16 v[104:107], a[176:179], v[120:123], v[104:107]
  v_mfma_f32_16x16x32_bf16 v[108:111], a[176:179], v[124:127], v[108:111]
  s_waitcnt lgkmcnt(4)
  v_mfma_f32_16x16x32_bf16 v[96:99], a[188:191], v[128:131], v[96:99]
  v_mfma_f32_16x16x32_bf16 v[100:103], a[188:191], v[132:135], v[100:103]
  s_waitcnt lgkmcnt(2)
  v_mfma_f32_16x16x32_bf16 v[104:107], a[188:191], v[136:139], v[104:107]
  s_waitcnt lgkmcnt(0)
  v_mfma_f32_16x16x32_bf16 v[108:111], a[188:191], v[140:143], v[108:111]
  v_mfma_f32_16x16x32_bf16 v[64:67], a[168:171], v[112:115], v[64:67]
  v_mfma_f32_16x16x32_bf16 v[68:71], a[168:171], v[116:119], v[68:71]
  v_mfma_f32_16x16x32_bf16 v[72:75], a[168:171], v[120:123], v[72:75]
  v_max_f32 v96, 0, v96
  v_max_f32 v97, 0, v97
  v_mfma_f32_16x16x32_bf16 v[76:79], a[168:171], v[124:127], v[76:79]
  v_mul_f32 v96, v96, v98
Lstub7:
  s_cbranch_execz Lret7_3950
  v_mul_f32 v97, v97, v99
  v_mfma_f32_16x16x32_bf16 v[64:67], a[180:183], v[128:131], v[64:67]
  v_cvt_pk_bf16_f32 v96, v96, v97
  v_max_f32 v100, 0, v100
  v_mfma_f32_16x16x32_bf16 v[68:71], a[180:183], v[132:135], v[68:71]
  v_max_f32 v101, 0, v101
  v_mul_f32 v100, v100, v102
  v_mfma_f32_16x16x32_bf16 v[72:75], a[180:183], v[136:139], v[72:75]
  v_mul_f32 v101, v101, v103
  v_cvt_pk_bf16_f32 v97, v100, v101
  v_mfma_f32_16x16x32_bf16 v[76:79], a[180:183], v[140:143], v[76:79]
  v_max_f32 v104, 0, v104
  v_max_f32 v105, 0, v105
  v_mfma_f32_16x16x32_bf16 v[80:83], a[172:175], v[112:115], v[80:83]
  v_mul_f32 v104, v104, v106
  v_mul_f32 v105, v105, v107
  v_mfma_f32_16x16x32_bf16 v[84:87], a[172:175], v[116:119], v[84:87]
  v_cvt_pk_bf16_f32 v98, v104, v105
  v_max_f32 v108, 0, v108
  v_mfma_f32_16x16x32_bf16 v[88:91], a[172:175], v[120:123], v[88:91]
  v_max_f32 v109, 0, v109
  v_mul_f32 v108, v108, v110
  v_mfma_f32_16x16x32_bf16 v[92:95], a[172:175], v[124:127], v[92:95]
  v_mul_f32 v109, v109, v111
  v_cvt_pk_bf16_f32 v99, v108, v109
  v_mfma_f32_16x16x32_bf16 v[80:83], a[184:187], v[128:131], v[80:83]
  v_permlane32_swap_b32 v96, v98
  v_permlane32_swap_b32 v97, v99
  v_mfma_f32_16x16x32_bf16 v[84:87], a[184:187], v[132:135], v[84:87]
  s_nop 0
  v_permlane16_swap_b32 v96, v97
  v_permlane16_swap_b32 v98, v99
  v_mfma_f32_16x16x32_bf16 v[88:91], a[184:187], v[136:139], v[88:91]
  buffer_store_dwordx4 v[96:99], v13, s[8:11], s42 offen offset:512 sc1
  v_max_f32 v64, 0, v64
  v_mfma_f32_16x16x32_bf16 v[92:95], a[184:187], v[140:143], v[92:95]
  v_max_f32 v65, 0, v65
  v_max_f32 v66, 0, v66
  v_max_f32 v67, 0, v67
  v_max_f32 v68, 0, v68
  v_max_f32 v69, 0, v69
  v_max_f32 v70, 0, v70
  v_max_f32 v71, 0, v71
  v_max_f32 v72, 0, v72
  v_max_f32 v73, 0, v73
  v_max_f32 v74, 0, v74
  v_max_f32 v75, 0, v75
  v_max_f32 v76, 0, v76
  v_max_f32 v77, 0, v77
  v_max_f32 v78, 0, v78
  v_max_f32 v79, 0, v79
  v_pk_mul_f32 v[64:65], v[64:65], v[80:81]
  v_pk_mul_f32 v[66:67], v[66:67], v[82:83]
  v_pk_mul_f32 v[68:69], v[68:69], v[84:85]
  v_pk_mul_f32 v[70:71], v[70:71], v[86:87]
  v_cvt_pk_bf16_f32 v80, v64, v65
  v_cvt_pk_bf16_f32 v81, v66, v67
  v_cvt_pk_bf16_f32 v82, v68, v69
  v_cvt_pk_bf16_f32 v83, v70, v71
  v_pk_mul_f32 v[72:73], v[72:73], v[88:89]
  v_pk_mul_f32 v[74:75], v[74:75], v[90:91]
  v_permlane16_swap_b32 v80, v82
  v_permlane16_swap_b32 v81, v83
  v_pk_mul_f32 v[76:77], v[76:77], v[92:93]
  v_pk_mul_f32 v[78:79], v[78:79], v[94:95]
  buffer_store_dwordx4 v[80:83], v5, s[8:11], s40 offen offset:512 sc1
  v_cvt_pk_bf16_f32 v88, v72, v73
  v_cvt_pk_bf16_f32 v89, v74, v75
  v_cvt_pk_bf16_f32 v90, v76, v77
  v_cvt_pk_bf16_f32 v91, v78, v79
  s_nop 0
  v_permlane16_swap_b32 v88, v90
  v_permlane16_swap_b32 v89, v91
  buffer_store_dwordx4 v[88:91], v5, s[8:11], s41 offen offset:512 sc1
  buffer_load_dword v4, v15, s[8:11], s24 offen sc1
G1_END1:
  s_mov_b32 s95, s24
  v_lshlrev_b32 v8, 11, v3
  v_and_b32 v9, 1, v3
  v_lshl_add_u32 v8, v9, 7, v8
  v_lshrrev_b32 v9, 3, v2
  v_lshl_add_u32 v8, v9, 6, v8
  v_and_b32 v9, 3, v2
  v_lshl_add_u32 v8, v9, 4, v8
  v_bfe_u32 v9, v2, 2, 1
  v_lshl_add_u32 v8, v9, 3, v8
  s_lshl_b32 s4, s3, 15
  s_and_b32 s5, s55, 1
  s_lshl_b32 s5, s5, 10
  s_add_u32 s4, s4, s5
  s_add_u32 s4, s4, s35
  v_add_u32 v8, s4, v8
  v_xor_b32 v9, 128, v8
  v_xor_b32 v10, 256, v8
  v_xor_b32 v12, 384, v8
  ds_read_b64_tr_b16 a[64:65], v10 offset:0
  ds_read_b64_tr_b16 a[66:67], v12 offset:0
  ds_read_b64_tr_b16 a[68:69], v10 offset:8192
  ds_read_b64_tr_b16 a[70:71], v12 offset:8192
  ds_read_b64_tr_b16 a[72:73], v10 offset:16384
  ds_read_b64_tr_b16 a[74:75], v12 offset:16384
  ds_read_b64_tr_b16 a[76:77], v10 offset:24576
  ds_read_b64_tr_b16 a[78:79], v12 offset:24576
  s_waitcnt lgkmcnt(0)
  v_mfma_f32_16x16x32_bf16 v[112:115], a[0:3], a[64:67], 0
  ds_read_b64_tr_b16 a[80:81], v8 offset:0
  v_mfma_f32_16x16x32_bf16 v[116:119], a[4:7], a[64:67], 0
  ds_read_b64_tr_b16 a[82:83], v9 offset:0
  v_mfma_f32_16x16x32_bf16 v[120:123], a[8:11], a[64:67], 0
  ds_read_b64_tr_b16 a[84:85], v8 offset:8192
  v_mfma_f32_16x16x32_bf16 v[124:127], a[12:15], a[64:67], 0
  ds_read_b64_tr_b16 a[86:87], v9 offset:8192
  v_mfma_f32_16x16x32_bf16 v[112:115], a[16:19], a[68:71], v[112:115]
  ds_read_b64_tr_b16 a[88:89], v8 offset:16384
  v_mfma_f32_16x16x32_bf16 v[116:119], a[20:23], a[68:71], v[116:119]
  ds_read_b64_tr_b16 a[90:91], v9 offset:16384
  v_mfma_f32_16x16x32_bf16 v[120:123], a[24:27], a[68:71], v[120:123]
  ds_read_b64_tr_b16 a[92:93], v8 offset:24576
  v_mfma_f32_16x16x32_bf16 v[124:127], a[28:31], a[68:71], v[124:127]
  ds_read_b64_tr_b16 a[94:95], v9 offset:24576
  v_mfma_f32_16x16x32_bf16 v[112:115], a[32:35], a[72:75], v[112:115]
  ds_read_b64_tr_b16 a[96:97], v10 offset:512
  v_mfma_f32_16x16x32_bf16 v[116:119], a[36:39], a[72:75], v[116:119]
  ds_read_b64_tr_b16 a[98:99], v12 offset:512
  v_mfma_f32_16x16x32_bf16 v[120:123], a[40:43], a[72:75], v[120:123]
  ds_read_b64_tr_b16 a[100:101], v10 offset:8704
  v_mfma_f32_16x16x32_bf16 v[124:127], a[44:47], a[72:75], v[124:127]
  ds_read_b64_tr_b16 a[102:103], v12 offset:8704
  v_mfma_f32_16x16x32_bf16 v[112:115], a[48:51], a[76:79], v[112:115]
  ds_read_b64_tr_b16 a[104:105], v10 offset:16896
  v_mfma_f32_16x16x32_bf16 v[116:119], a[52:55], a[76:79], v[116:119]
  ds_read_b64_tr_b16 a[106:107], v12 offset:16896
  v_mfma_f32_16x16x32_bf16 v[120:123], a[56:59], a[76:79], v[120:123]
  ds_read_b64_tr_b16 a[108:109], v10 offset:25088
  v_mfma_f32_16x16x32_bf16 v[124:127], a[60:63], a[76:79], v[124:127]
  ds_read_b64_tr_b16 a[110:111], v12 offset:25088
  s_waitcnt lgkmcnt(8)
  v_mfma_f32_16x16x32_bf16 v[128:131], a[0:3], a[80:83], 0
  ds_read_b64_tr_b16 a[112:113], v8 offset:512
  ds_read_b64_tr_b16 a[114:115], v9 offset:512
  v_mfma_f32_16x16x32_bf16 v[132:135], a[4:7], a[80:83], 0
  ds_read_b64_tr_b16 a[116:117], v8 offset:8704
  ds_read_b64_tr_b16 a[118:119], v9 offset:8704
  v_mfma_f32_16x16x32_bf16 v[136:139], a[8:11], a[80:83], 0
  ds_read_b64_tr_b16 a[120:121], v8 offset:16896
  ds_read_b64_tr_b16 a[122:123], v9 offset:16896
  v_mfma_f32_16x16x32_bf16 v[140:143], a[12:15], a[80:83], 0
  ds_read_b64_tr_b16 a[124:125], v8 offset:25088
  ds_read_b64_tr_b16 a[126:127], v9 offset:25088
  v_mfma_f32_16x16x32_bf16 v[128:131], a[16:19], a[84:87], v[128:131]
  s_xor_b32 s4, s3, 0
  s_mul_i32 s47, s4, 8192
  v_mfma_f32_16x16x32_bf16 v[132:135], a[20:23], a[84:87], v[132:135]
  s_xor_b32 s4, s3, 2
  s_mul_i32 s48, s4, 8192
  v_mfma_f32_16x16x32_bf16 v[136:139], a[24:27], a[84:87], v[136:139]
  s_xor_b32 s4, s3, 3
  s_mul_i32 s49, s4, 8192
  v_mfma_f32_16x16x32_bf16 v[140:143], a[28:31], a[84:87], v[140:143]
  s_xor_b32 s4, s3, 1
  s_mul_i32 s50, s4, 8192
  v_mfma_f32_16x16x32_bf16 v[128:131], a[32:35], a[88:91], v[128:131]
  s_lshr_b32 s5, s57, 7
  v_lshrrev_b32 v5, 3, v0
  v_mfma_f32_16x16x32_bf16 v[132:135], a[36:39], a[88:91], v[132:135]
  v_add_u32 v5, s5, v5
  v_and_b32 v13, 3, v5
  v_mfma_f32_16x16x32_bf16 v[136:139], a[40:43], a[88:91], v[136:139]
  v_lshlrev_b32 v13, 15, v13
  v_lshrrev_b32 v9, 2, v5
  v_mfma_f32_16x16x32_bf16 v[140:143], a[44:47], a[88:91], v[140:143]
  v_lshl_add_u32 v13, v9, 10, v13
  v_and_b32 v9, 7, v0
  v_mfma_f32_16x16x32_bf16 v[128:131], a[48:51], a[92:95], v[128:131]
  v_lshl_add_u32 v13, v9, 4, v13
  v_and_b32 v9, 3, v0
  v_mfma_f32_16x16x32_bf16 v[132:135], a[52:55], a[92:95], v[132:135]
  v_lshl_add_u32 v8, v9, 2, v5
  v_and_b32 v8, 15, v8
  v_mfma_f32_16x16x32_bf16 v[136:139], a[56:59], a[92:95], v[136:139]
  v_lshlrev_b32 v9, 8, v9
  v_lshl_add_u32 v9, v8, 4, v9
  v_mfma_f32_16x16x32_bf16 v[140:143], a[60:63], a[92:95], v[140:143]
  s_waitcnt vmcnt(1) lgkmcnt(0)
  s_barrier
  s_mov_b64 exec, 1
  buffer_atomic_add v7, v15, s[8:11], s27 offen sc1
  s_mov_b64 exec, -1
  s_waitcnt vmcnt(1)
  v_cmp_gt_u32 vcc, 16, v4
  s_cbranch_vccnz Lsl_28
Lbk_29:
  v_lshlrev_b32 v4, 2, v2
  s_add_u32 s0, s30, 33579008
  s_add_u32 s1, s31, 33579008
  buffer_load_dword v100, v4, s[8:11], s0 offen offset:0 sc1
  buffer_load_dword v101, v4, s[8:11], s1 offen offset:0 sc1
  buffer_load_dword v102, v4, s[8:11], s0 offen offset:128 sc1
  buffer_load_dword v103, v4, s[8:11], s1 offen offset:128 sc1
  s_add_u32 s0, s92, 16777216
  buffer_load_dwordx4 v[16:19], v6, s[8:11], s0 offen sc1
  s_add_u32 s0, s92, 16781312
  buffer_load_dwordx4 v[20:23], v6, s[8:11], s0 offen sc1
  s_add_u32 s0, s92, 16785408
  buffer_load_dwordx4 v[24:27], v6, s[8:11], s0 offen sc1
  v_mfma_f32_16x16x32_bf16 v[64:67], a[0:3], a[96:99], 0
  s_add_u32 s0, s92, 16789504
  v_bfe_u32 v8, v0, 2, 1
  buffer_load_dwordx4 v[28:31], v6, s[8:11], s0 offen sc1
  v_mfma_f32_16x16x32_bf16 v[68:71], a[4:7], a[96:99], 0
  v_lshl_add_u32 v9, v8, 13, v9
  s_add_u32 s0, s92, 16793600
  s_lshl_b32 s5, s35, 6
  v_mfma_f32_16x16x32_bf16 v[72:75], a[8:11], a[96:99], 0
  buffer_load_dwordx4 v[32:35], v6, s[8:11], s0 offen sc1
  v_add_u32 v9, s5, v9
  s_add_u32 s0, s92, 16797696
  v_mfma_f32_16x16x32_bf16 v[76:79], a[12:15], a[96:99], 0
  v_lshlrev_b32 v5, 2, v5
  buffer_load_dwordx4 v[36:39], v6, s[8:11], s0 offen sc1
  v_lshl_add_u32 v8, v3, 2, v2
  v_mfma_f32_16x16x32_bf16 v[64:67], a[16:19], a[100:103], v[64:67]
  s_add_u32 s0, s92, 16801792
  v_and_b32 v8, 15, v8
  buffer_load_dwordx4 v[40:43], v6, s[8:11], s0 offen sc1
  v_mfma_f32_16x16x32_bf16 v[68:71], a[20:23], a[100:103], v[68:71]
  v_lshlrev_b32 v8, 4, v8
  s_add_u32 s0, s92, 16805888
  v_lshl_add_u32 v8, v3, 8, v8
  v_mfma_f32_16x16x32_bf16 v[72:75], a[24:27], a[100:103], v[72:75]
  buffer_load_dwordx4 v[44:47], v6, s[8:11], s0 offen sc1
  s_lshr_b32 s24, s55, 4
  s_add_u32 s0, s92, 16809984
  v_mfma_f32_16x16x32_bf16 v[76:79], a[28:31], a[100:103], v[76:79]
  s_lshl_b32 s24, s24, 14
  buffer_load_dwordx4 v[48:51], v6, s[8:11], s0 offen sc1
  s_and_b32 s5, s55, 15
  v_mfma_f32_16x16x32_bf16 v[64:67], a[32:35], a[104:107], v[64:67]
  s_add_u32 s0, s92, 16814080
  s_lshl_b32 s5, s5, 17
  buffer_load_dwordx4 v[52:55], v6, s[8:11], s0 offen sc1
  v_mfma_f32_16x16x32_bf16 v[68:71], a[36:39], a[104:107], v[68:71]
  s_add_u32 s24, s24, s5
  s_add_u32 s0, s92, 16818176
  s_lshl_b32 s5, s35, 4
  v_mfma_f32_16x16x32_bf16 v[72:75], a[40:43], a[104:107], v[72:75]
  buffer_load_dwordx4 v[56:59], v14, s[8:11], s0 offen sc1
  s_add_u32 s24, s24, s5
  s_lshl_b32 s5, s56, 7
  v_mfma_f32_16x16x32_bf16 v[76:79], a[44:47], a[104:107], v[76:79]
  s_add_u32 s24, s24, s5
  s_add_u32 s25, s24, 8192
  v_mfma_f32_16x16x32_bf16 v[64:67], a[48:51], a[108:111], v[64:67]
  v_mfma_f32_16x16x32_bf16 v[68:71], a[52:55], a[108:111], v[68:71]
  v_mfma_f32_16x16x32_bf16 v[72:75], a[56:59], a[108:111], v[72:75]
  v_mfma_f32_16x16x32_bf16 v[76:79], a[60:63], a[108:111], v[76:79]
  v_mfma_f32_16x16x32_bf16 v[80:83], a[0:3], a[112:115], 0
  s_add_u32 s0, s93, 16777216
  v_mfma_f32_16x16x32_bf16 v[84:87], a[4:7], a[112:115], 0
  buffer_load_dwordx4 v[60:63], v6, s[8:11], s0 offen sc1
  v_mfma_f32_16x16x32_bf16 v[88:91], a[8:11], a[112:115], 0
  s_add_u32 s0, s93, 16781312
  v_mfma_f32_16x16x32_bf16 v[92:95], a[12:15], a[112:115], 0
  buffer_load_dwordx4 a[128:131], v6, s[8:11], s0 offen sc1
  v_mfma_f32_16x16x32_bf16 v[80:83], a[16:19], a[116:119], v[80:83]
  v_mfma_f32_16x16x32_bf16 v[84:87], a[20:23], a[116:119], v[84:87]
  v_mfma_f32_16x16x32_bf16 v[88:91], a[24:27], a[116:119], v[88:91]
  v_mfma_f32_16x16x32_bf16 v[92:95], a[28:31], a[116:119], v[92:95]
  v_mfma_f32_16x16x32_bf16 v[80:83], a[32:35], a[120:123], v[80:83]
  v_mfma_f32_16x16x32_bf16 v[84:87], a[36:39], a[120:123], v[84:87]
  v_mfma_f32_16x16x32_bf16 v[88:91], a[40:43], a[120:123], v[88:91]
  v_mfma_f32_16x16x32_bf16 v[92:95], a[44:47], a[120:123], v[92:95]
  v_mfma_f32_16x16x32_bf16 v[80:83], a[48:51], a[124:127], v[80:83]
  v_mfma_f32_16x16x32_bf16 v[84:87], a[52:55], a[124:127], v[84:87]
  v_mfma_f32_16x16x32_bf16 v[88:91], a[56:59], a[124:127], v[88:91]
  v_mfma_f32_16x16x32_bf16 v[92:95], a[60:63], a[124:127], v[92:95]
  s_waitcnt vmcnt(13)
  v_rcp_f32 v104, v100
  v_rcp_f32 v106, v101
  v_rcp_f32 v108, v102
  v_rcp_f32 v110, v103
  v_pk_mul_f32 v[112:113], v[112:113], v[104:105] op_sel_hi:[1,0]
  v_pk_mul_f32 v[114:115], v[114:115], v[104:105] op_sel_hi:[1,0]
  v_pk_mul_f32 v[116:117], v[116:117], v[104:105] op_sel_hi:[1,0]
  v_pk_mul_f32 v[118:119], v[118:119], v[104:105] op_sel_hi:[1,0]
  v_pk_mul_f32 v[120:121], v[120:121], v[104:105] op_sel_hi:[1,0]
  v_pk_mul_f32 v[122:123], v[122:123], v[104:105] op_sel_hi:[1,0]
  v_pk_mul_f32 v[124:125], v[124:125], v[104:105] op_sel_hi:[1,0]
  v_pk_mul_f32 v[126:127], v[126:127], v[104:105] op_sel_hi:[1,0]
  v_pk_mul_f32 v[128:129], v[128:129], v[106:107] op_sel_hi:[1,0]
  v_pk_mul_f32 v[130:131], v[130:131], v[106:107] op_sel_hi:[1,0]
  v_pk_mul_f32 v[132:133], v[132:133], v[106:107] op_sel_hi:[1,0]
  v_pk_mul_f32 v[134:135], v[134:135], v[106:107] op_sel_hi:[1,0]
  v_pk_mul_f32 v[136:137], v[136:137], v[106:107] op_sel_hi:[1,0]
  v_pk_mul_f32 v[138:139], v[138:139], v[106:107] op_sel_hi:[1,0]
  v_pk_mul_f32 v[140:141], v[140:141], v[106:107] op_sel_hi:[1,0]
  v_pk_mul_f32 v[142:143], v[142:143], v[106:107] op_sel_hi:[1,0]
  v_pk_mul_f32 v[64:65], v[64:65], v[108:109] op_sel_hi:[1,0]
  v_pk_mul_f32 v[66:67], v[66:67], v[108:109] op_sel_hi:[1,0]
  v_pk_mul_f32 v[68:69], v[68:69], v[108:109] op_sel_hi:[1,0]
  v_pk_mul_f32 v[70:71], v[70:71], v[108:109] op_sel_hi:[1,0]
  v_pk_mul_f32 v[72:73], v[72:73], v[108:109] op_sel_hi:[1,0]
  v_pk_mul_f32 v[74:75], v[74:75], v[108:109] op_sel_hi:[1,0]
  v_pk_mul_f32 v[76:77], v[76:77], v[108:109] op_sel_hi:[1,0]
  v_pk_mul_f32 v[78:79], v[78:79], v[108:109] op_sel_hi:[1,0]
  v_pk_mul_f32 v[80:81], v[80:81], v[110:111] op_sel_hi:[1,0]
  v_pk_mul_f32 v[82:83], v[82:83], v[110:111] op_sel_hi:[1,0]
  v_pk_mul_f32 v[84:85], v[84:85], v[110:111] op_sel_hi:[1,0]
  v_pk_mul_f32 v[86:87], v[86:87], v[110:111] op_sel_hi:[1,0]
  v_pk_mul_f32 v[88:89], v[88:89], v[110:111] op_sel_hi:[1,0]
  v_pk_mul_f32 v[90:91], v[90:91], v[110:111] op_sel_hi:[1,0]
  v_pk_mul_f32 v[92:93], v[92:93], v[110:111] op_sel_hi:[1,0]
  v_pk_mul_f32 v[94:95], v[94:95], v[110:111] op_sel_hi:[1,0]
  buffer_load_dword v4, v15, s[8:11], s26 offen sc1
  s_waitcnt vmcnt(13)
  v_mfma_f32_16x16x32_bf16 v[112:115], v[144:147], v[16:19], v[112:115]
  v_mfma_f32_16x16x32_bf16 v[116:119], v[148:151], v[16:19], v[116:119]
  v_mfma_f32_16x16x32_bf16 v[120:123], v[152:155], v[16:19], v[120:123]
  v_mfma_f32_16x16x32_bf16 v[124:127], v[156:159], v[16:19], v[124:127]
  s_waitcnt vmcnt(12)
  v_mfma_f32_16x16x32_bf16 v[112:115], v[160:163], v[20:23], v[112:115]
  s_add_u32 s0, s93, 16785408
  v_mfma_f32_16x16x32_bf16 v[116:119], v[164:167], v[20:23], v[116:119]
  buffer_load_dwordx4 a[132:135], v6, s[8:11], s0 offen sc1
  v_mfma_f32_16x16x32_bf16 v[120:123], v[168:171], v[20:23], v[120:123]
  s_add_u32 s1, s31, 33579008
  v_mfma_f32_16x16x32_bf16 v[124:127], v[172:175], v[20:23], v[124:127]
  s_waitcnt vmcnt(12)
  v_mfma_f32_16x16x32_bf16 v[112:115], v[176:179], v[24:27], v[112:115]
  s_add_u32 s0, s93, 16789504
  v_mfma_f32_16x16x32_bf16 v[116:119], v[180:183], v[24:27], v[116:119]
  buffer_load_dwordx4 a[136:139], v6, s[8:11], s0 offen sc1
  v_mfma_f32_16x16x32_bf16 v[120:123], v[184:187], v[24:27], v[120:123]
  buffer_load_dword v100, v5, s[8:11], s1 offen offset:0 sc1
  v_mfma_f32_16x16x32_bf16 v[124:127], v[188:191], v[24:27], v[124:127]
  buffer_load_dword v102, v5, s[8:11], s1 offen offset:128 sc1
  s_waitcnt vmcnt(14)
  v_mfma_f32_16x16x32_bf16 v[112:115], v[192:195], v[28:31], v[112:115]
  s_add_u32 s0, s93, 16793600
  v_mfma_f32_16x16x32_bf16 v[116:119], v[196:199], v[28:31], v[116:119]
  buffer_load_dwordx4 a[140:143], v6, s[8:11], s0 offen sc1
  v_mfma_f32_16x16x32_bf16 v[120:123], v[200:203], v[28:31], v[120:123]
  v_mfma_f32_16x16x32_bf16 v[124:127], v[204:207], v[28:31], v[124:127]
  s_waitcnt vmcnt(14)
  v_mfma_f32_16x16x32_bf16 v[112:115], v[208:211], v[32:35], v[112:115]
  s_add_u32 s0, s93, 16797696
  v_mfma_f32_16x16x32_bf16 v[116:119], v[212:215], v[32:35], v[116:119]
  buffer_load_dwordx4 a[144:147], v6, s[8:11], s0 offen sc1
  v_mfma_f32_16x16x32_bf16 v[120:123], v[216:219], v[32:35], v[120:123]
  v_mfma_f32_16x16x32_bf16 v[124:127], v[220:223], v[32:35], v[124:127]
  s_waitcnt vmcnt(14)
  v_mfma_f32_16x16x32_bf16 v[112:115], v[224:227], v[36:39], v[112:115]
  s_add_u32 s0, s93, 16801792
  v_mfma_f32_16x16x32_bf16 v[116:119], v[228:231], v[36:39], v[116:119]
  buffer_load_dwordx4 a[148:151], v6, s[8:11], s0 offen sc1
  v_mfma_f32_16x16x32_bf16 v[120:123], v[232:235], v[36:39], v[120:123]
  v_mfma_f32_16x16x32_bf16 v[124:127], v[236:239], v[36:39], v[124:127]
  s_waitcnt vmcnt(14)
  v_mfma_f32_16x16x32_bf16 v[112:115], v[240:243], v[40:43], v[112:115]
  s_add_u32 s0, s93, 16805888
  v_mfma_f32_16x16x32_bf16 v[116:119], v[244:247], v[40:43], v[116:119]
  buffer_load_dwordx4 a[152:155], v6, s[8:11], s0 offen sc1
  v_mfma_f32_16x16x32_bf16 v[120:123], v[248:251], v[40:43], v[120:123]
  v_mfma_f32_16x16x32_bf16 v[124:127], v[252:255], v[40:43], v[124:127]
  s_waitcnt vmcnt(14)
  v_mfma_f32_16x16x32_bf16 v[112:115], a[192:195], v[44:47], v[112:115]
  s_add_u32 s0, s93, 16809984
  v_mfma_f32_16x16x32_bf16 v[116:119], a[196:199], v[44:47], v[116:119]
  buffer_load_dwordx4 a[156:159], v6, s[8:11], s0 offen sc1
  v_mfma_f32_16x16x32_bf16 v[120:123], a[200:203], v[44:47], v[120:123]
  v_mfma_f32_16x16x32_bf16 v[124:127], a[204:207], v[44:47], v[124:127]
  s_waitcnt vmcnt(14)
  v_mfma_f32_16x16x32_bf16 v[112:115], a[208:211], v[48:51], v[112:115]
  s_add_u32 s0, s93, 16814080
  v_mfma_f32_16x16x32_bf16 v[116:119], a[212:215], v[48:51], v[116:119]
  buffer_load_dwordx4 a[160:163], v6, s[8:11], s0 offen sc1
  v_mfma_f32_16x16x32_bf16 v[120:123], a[216:219], v[48:51], v[120:123]
  v_mfma_f32_16x16x32_bf16 v[124:127], a[220:223], v[48:51], v[124:127]
  s_waitcnt vmcnt(10)
  v_cmp_gt_u32 vcc, 16, v4
  s_cbranch_vccnz Lsl_30
Lbk_31:
  v_mfma_f32_16x16x32_bf16 v[112:115], a[224:227], v[52:55], v[112:115]
  s_add_u32 s0, s93, 16818176
  v_mfma_f32_16x16x32_bf16 v[116:119], a[228:231], v[52:55], v[116:119]
  buffer_load_dwordx4 a[164:167], v14, s[8:11], s0 offen sc1
  v_mfma_f32_16x16x32_bf16 v[120:123], a[232:235], v[52:55], v[120:123]
  v_mfma_f32_16x16x32_bf16 v[124:127], a[236:239], v[52:55], v[124:127]
  v_mfma_f32_16x16x32_bf16 v[112:115], a[240:243], v[56:59], v[112:115]
  s_add_u32 s0, s92, 16777728
  v_mfma_f32_16x16x32_bf16 v[116:119], a[244:247], v[56:59], v[116:119]
  buffer_load_dwordx4 a[168:171], v6, s[8:11], s0 offen sc1
  v_mfma_f32_16x16x32_bf16 v[120:123], a[248:251], v[56:59], v[120:123]
  v_mfma_f32_16x16x32_bf16 v[124:127], a[252:255], v[56:59], v[124:127]
  v_mfma_f32_16x16x32_bf16 v[128:131], v[144:147], v[60:63], v[128:131]
  s_add_u32 s0, s92, 16781824
  v_mfma_f32_16x16x32_bf16 v[132:135], v[148:151], v[60:63], v[132:135]
  buffer_load_dwordx4 a[172:175], v6, s[8:11], s0 offen sc1
  v_mfma_f32_16x16x32_bf16 v[136:139], v[152:155], v[60:63], v[136:139]
  v_mfma_f32_16x16x32_bf16 v[140:143], v[156:159], v[60:63], v[140:143]
  v_mfma_f32_16x16x32_bf16 v[128:131], v[160:163], a[128:131], v[128:131]
  s_add_u32 s0, s92, 16785920
  v_mfma_f32_16x16x32_bf16 v[132:135], v[164:167], a[128:131], v[132:135]
  buffer_load_dwordx4 a[176:179], v6, s[8:11], s0 offen sc1
  v_mfma_f32_16x16x32_bf16 v[136:139], v[168:171], a[128:131], v[136:139]
  v_add_u32 v11, s48, v8
  v_mfma_f32_16x16x32_bf16 v[140:143], v[172:175], a[128:131], v[140:143]
  ds_write_b128 v11, v[112:115] offset:0
  s_waitcnt vmcnt(13)
  v_mfma_f32_16x16x32_bf16 v[128:131], v[176:179], a[132:135], v[128:131]
  s_add_u32 s0, s92, 16790016
  v_mfma_f32_16x16x32_bf16 v[132:135], v[180:183], a[132:135], v[132:135]
  buffer_load_dwordx4 a[180:183], v6, s[8:11], s0 offen sc1
  v_mfma_f32_16x16x32_bf16 v[136:139], v[184:187], a[132:135], v[136:139]
  ds_write_b128 v11, v[116:119] offset:1024
  v_mfma_f32_16x16x32_bf16 v[140:143], v[188:191], a[132:135], v[140:143]
  s_waitcnt vmcnt(13)
  v_mfma_f32_16x16x32_bf16 v[128:131], v[192:195], a[136:139], v[128:131]
  s_add_u32 s0, s92, 16794112
  v_mfma_f32_16x16x32_bf16 v[132:135], v[196:199], a[136:139], v[132:135]
  buffer_load_dwordx4 a[184:187], v6, s[8:11], s0 offen sc1
  v_mfma_f32_16x16x32_bf16 v[136:139], v[200:203], a[136:139], v[136:139]
  v_add_u32 v11, s49, v8
  v_mfma_f32_16x16x32_bf16 v[140:143], v[204:207], a[136:139], v[140:143]
  ds_write_b128 v11, v[120:123] offset:2048
  s_waitcnt vmcnt(11)
  v_mfma_f32_16x16x32_bf16 v[128:131], v[208:211], a[140:143], v[128:131]
  s_add_u32 s0, s92, 16798208
  v_mfma_f32_16x16x32_bf16 v[132:135], v[212:215], a[140:143], v[132:135]
  buffer_load_dwordx4 a[188:191], v6, s[8:11], s0 offen sc1
  v_mfma_f32_16x16x32_bf16 v[136:139], v[216:219], a[140:143], v[136:139]
  ds_write_b128 v11, v[124:127] offset:3072
  v_mfma_f32_16x16x32_bf16 v[140:143], v[220:223], a[140:143], v[140:143]
  s_waitcnt vmcnt(11)
  v_mfma_f32_16x16x32_bf16 v[128:131], v[224:227], a[144:147], v[128:131]
  s_add_u32 s0, s92, 16802304
  v_mfma_f32_16x16x32_bf16 v[132:135], v[228:231], a[144:147], v[132:135]
  buffer_load_dwordx4 v[16:19], v6, s[8:11], s0 offen sc1
  v_mfma_f32_16x16x32_bf16 v[136:139], v[232:235], a[144:147], v[136:139]
  v_mfma_f32_16x16x32_bf16 v[140:143], v[236:239], a[144:147], v[140:143]
  s_waitcnt vmcnt(11)
  v_mfma_f32_16x16x32_bf16 v[128:131], v[240:243], a[148:151], v[128:131]
  s_add_u32 s0, s92, 16806400
  v_mfma_f32_16x16x32_bf16 v[132:135], v[244:247], a[148:151], v[132:135]
  buffer_load_dwordx4 v[20:23], v6, s[8:11], s0 offen sc1
  v_mfma_f32_16x16x32_bf16 v[136:139], v[248:251], a[148:151], v[136:139]
  v_mfma_f32_16x16x32_bf16 v[140:143], v[252:255], a[148:151], v[140:143]
  s_waitcnt vmcnt(11)
  v_mfma_f32_16x16x32_bf16 v[128:131], a[192:195], a[152:155], v[128:131]
  s_add_u32 s0, s92, 16810496
  v_mfma_f32_16x16x32_bf16 v[132:135], a[196:199], a[152:155], v[132:135]
  buffer_load_dwordx4 v[24:27], v6, s[8:11], s0 offen sc1
  v_mfma_f32_16x16x32_bf16 v[136:139], a[200:203], a[152:155], v[136:139]
  v_mfma_f32_16x16x32_bf16 v[140:143], a[204:207], a[152:155], v[140:143]
  s_waitcnt vmcnt(11)
  v_mfma_f32_16x16x32_bf16 v[128:131], a[208:211], a[156:159], v[128:131]
  s_add_u32 s0, s92, 16814592
  v_mfma_f32_16x16x32_bf16 v[132:135], a[212:215], a[156:159], v[132:135]
  buffer_load_dwordx4 v[28:31], v6, s[8:11], s0 offen sc1
  v_mfma_f32_16x16x32_bf16 v[136:139], a[216:219], a[156:159], v[136:139]
  v_mfma_f32_16x16x32_bf16 v[140:143], a[220:223], a[156:159], v[140:143]
  s_waitcnt vmcnt(11)
  v_mfma_f32_16x16x32_bf16 v[128:131], a[224:227], a[160:163], v[128:131]
  s_add_u32 s0, s92, 16818688
  v_mfma_f32_16x16x32_bf16 v[132:135], a[228:231], a[160:163], v[132:135]
  buffer_load_dwordx4 v[32:35], v14, s[8:11], s0 offen sc1
  v_mfma_f32_16x16x32_bf16 v[136:139], a[232:235], a[160:163], v[136:139]
  v_mfma_f32_16x16x32_bf16 v[140:143], a[236:239], a[160:163], v[140:143]
  s_waitcnt vmcnt(11)
  v_mfma_f32_16x16x32_bf16 v[136:139], a[248:251], a[164:167], v[136:139]
  s_add_u32 s0, s93, 16777728
  v_mfma_f32_16x16x32_bf16 v[140:143], a[252:255], a[164:167], v[140:143]
  buffer_load_dwordx4 v[36:39], v6, s[8:11], s0 offen sc1
  v_mfma_f32_16x16x32_bf16 v[128:131], a[240:243], a[164:167], v[128:131]
  v_mfma_f32_16x16x32_bf16 v[132:135], a[244:247], a[164:167], v[132:135]
  s_waitcnt vmcnt(11)
  v_mfma_f32_16x16x32_bf16 v[64:67], v[144:147], a[168:171], v[64:67]
  s_add_u32 s0, s93, 16781824
  v_mfma_f32_16x16x32_bf16 v[68:71], v[148:151], a[168:171], v[68:71]
  buffer_load_dwordx4 v[40:43], v6, s[8:11], s0 offen sc1
  v_mfma_f32_16x16x32_bf16 v[72:75], v[152:155], a[168:171], v[72:75]
  v_mfma_f32_16x16x32_bf16 v[76:79], v[156:159], a[168:171], v[76:79]
  s_waitcnt vmcnt(11)
  v_mfma_f32_16x16x32_bf16 v[64:67], v[160:163], a[172:175], v[64:67]
  s_add_u32 s0, s93, 16785920
  v_mfma_f32_16x16x32_bf16 v[68:71], v[164:167], a[172:175], v[68:71]
  buffer_load_dwordx4 v[44:47], v6, s[8:11], s0 offen sc1
  v_mfma_f32_16x16x32_bf16 v[72:75], v[168:171], a[172:175], v[72:75]
  v_add_u32 v11, s50, v8
  v_mfma_f32_16x16x32_bf16 v[76:79], v[172:175], a[172:175], v[76:79]
  ds_write_b128 v11, v[136:139] offset:4096
  s_waitcnt vmcnt(11)
  v_mfma_f32_16x16x32_bf16 v[64:67], v[176:179], a[176:179], v[64:67]
  s_add_u32 s0, s93, 16790016
  v_mfma_f32_16x16x32_bf16 v[68:71], v[180:183], a[176:179], v[68:71]
  buffer_load_dwordx4 v[48:51], v6, s[8:11], s0 offen sc1
  v_mfma_f32_16x16x32_bf16 v[72:75], v[184:187], a[176:179], v[72:75]
  ds_write_b128 v11, v[140:143] offset:5120
  v_mfma_f32_16x16x32_bf16 v[76:79], v[188:191], a[176:179], v[76:79]
  s_waitcnt vmcnt(11)
  v_mfma_f32_16x16x32_bf16 v[64:67], v[192:195], a[180:183], v[64:67]
  s_add_u32 s0, s93, 16794112
  v_mfma_f32_16x16x32_bf16 v[68:71], v[196:199], a[180:183], v[68:71]
  buffer_load_dwordx4 v[52:55], v6, s[8:11], s0 offen sc1
  v_mfma_f32_16x16x32_bf16 v[72:75], v[200:203], a[180:183], v[72:75]
  v_add_u32 v12, s47, v8
  v_mfma_f32_16x16x32_bf16 v[76:79], v[204:207], a[180:183], v[76:79]
  ds_write_b128 v12, v[128:131] offset:6144
  s_waitcnt vmcnt(11)
  v_mfma_f32_16x16x32_bf16 v[64:67], v[208:211], a[184:187], v[64:67]
  s_add_u32 s0, s93, 16798208
  v_mfma_f32_16x16x32_bf16 v[68:71], v[212:215], a[184:187], v[68:71]
  buffer_load_dwordx4 v[56:59], v6, s[8:11], s0 offen sc1
  v_mfma_f32_16x16x32_bf16 v[72:75], v[216:219], a[184:187], v[72:75]
  ds_write_b128 v12, v[132:135] offset:7168
  v_mfma_f32_16x16x32_bf16 v[76:79], v[220:223], a[184:187], v[76:79]
  s_waitcnt vmcnt(11)
  v_mfma_f32_16x16x32_bf16 v[64:67], v[224:227], a[188:191], v[64:67]
  s_add_u32 s0, s93, 16802304
  v_mfma_f32_16x16x32_bf16 v[68:71], v[228:231], a[188:191], v[68:71]
  buffer_load_dwordx4 v[60:63], v6, s[8:11], s0 offen sc1
  v_mfma_f32_16x16x32_bf16 v[72:75], v[232:235], a[188:191], v[72:75]
  v_mfma_f32_16x16x32_bf16 v[76:79], v[236:239], a[188:191], v[76:79]
  s_waitcnt vmcnt(11)
  v_mfma_f32_16x16x32_bf16 v[64:67], v[240:243], v[16:19], v[64:67]
  s_add_u32 s0, s93, 16806400
  v_mfma_f32_16x16x32_bf16 v[68:71], v[244:247], v[16:19], v[68:71]
  buffer_load_dwordx4 a[128:131], v6, s[8:11], s0 offen sc1
  v_mfma_f32_16x16x32_bf16 v[72:75], v[248:251], v[16:19], v[72:75]
  v_mfma_f32_16x16x32_bf16 v[76:79], v[252:255], v[16:19], v[76:79]
  s_waitcnt vmcnt(11)
  v_mfma_f32_16x16x32_bf16 v[64:67], a[192:195], v[20:23], v[64:67]
  s_add_u32 s0, s93, 16810496
  v_mfma_f32_16x16x32_bf16 v[68:71], a[196:199], v[20:23], v[68:71]
  buffer_load_dwordx4 a[132:135], v6, s[8:11], s0 offen sc1
  v_mfma_f32_16x16x32_bf16 v[72:75], a[200:203], v[20:23], v[72:75]
  v_mfma_f32_16x16x32_bf16 v[76:79], a[204:207], v[20:23], v[76:79]
  s_waitcnt vmcnt(11)
  v_mfma_f32_16x16x32_bf16 v[64:67], a[208:211], v[24:27], v[64:67]
  s_add_u32 s0, s93, 16814592
  v_mfma_f32_16x16x32_bf16 v[68:71], a[212:215], v[24:27], v[68:71]
  buffer_load_dwordx4 a[136:139], v6, s[8:11], s0 offen sc1
  v_mfma_f32_16x16x32_bf16 v[72:75], a[216:219], v[24:27], v[72:75]
  v_mfma_f32_16x16x32_bf16 v[76:79], a[220:223], v[24:27], v[76:79]
  s_waitcnt vmcnt(11)
  v_mfma_f32_16x16x32_bf16 v[64:67], a[224:227], v[28:31], v[64:67]
  s_add_u32 s0, s93, 16818688
  v_mfma_f32_16x16x32_bf16 v[68:71], a[228:231], v[28:31], v[68:71]
  buffer_load_dwordx4 a[140:143], v14, s[8:11], s0 offen sc1
  v_mfma_f32_16x16x32_bf16 v[72:75], a[232:235], v[28:31], v[72:75]
  v_mfma_f32_16x16x32_bf16 v[76:79], a[236:239], v[28:31], v[76:79]
  s_waitcnt vmcnt(11)
  v_mfma_f32_16x16x32_bf16 v[64:67], a[240:243], v[32:35], v[64:67]
  v_mfma_f32_16x16x32_bf16 v[68:71], a[244:247], v[32:35], v[68:71]
  v_mfma_f32_16x16x32_bf16 v[72:75], a[248:251], v[32:35], v[72:75]
  v_mfma_f32_16x16x32_bf16 v[76:79], a[252:255], v[32:35], v[76:79]
  s_waitcnt vmcnt(10)
  v_mfma_f32_16x16x32_bf16 v[80:83], v[144:147], v[36:39], v[80:83]
  v_mfma_f32_16x16x32_bf16 v[84:87], v[148:151], v[36:39], v[84:87]
  v_mfma_f32_16x16x32_bf16 v[88:91], v[152:155], v[36:39], v[88:91]
  v_mfma_f32_16x16x32_bf16 v[92:95], v[156:159], v[36:39], v[92:95]
  s_waitcnt vmcnt(9)
  v_mfma_f32_16x16x32_bf16 v[80:83], v[160:163], v[40:43], v[80:83]
  v_add_u32 v11, s48, v8
  v_mfma_f32_16x16x32_bf16 v[84:87], v[164:167], v[40:43], v[84:87]
  ds_write_b128 v11, v[64:67] offset:32768
  v_mfma_f32_16x16x32_bf16 v[88:91], v[168:171], v[40:43], v[88:91]
  v_mfma_f32_16x16x32_bf16 v[92:95], v[172:175], v[40:43], v[92:95]
  s_waitcnt vmcnt(8)
  v_mfma_f32_16x16x32_bf16 v[80:83], v[176:179], v[44:47], v[80:83]
  ds_write_b128 v11, v[68:71] offset:33792
  v_mfma_f32_16x16x32_bf16 v[84:87], v[180:183], v[44:47], v[84:87]
  v_mfma_f32_16x16x32_bf16 v[88:91], v[184:187], v[44:47], v[88:91]
  v_mfma_f32_16x16x32_bf16 v[92:95], v[188:191], v[44:47], v[92:95]
  s_waitcnt vmcnt(7)
  v_mfma_f32_16x16x32_bf16 v[80:83], v[192:195], v[48:51], v[80:83]
  v_add_u32 v11, s49, v8
  v_mfma_f32_16x16x32_bf16 v[84:87], v[196:199], v[48:51], v[84:87]
  ds_write_b128 v11, v[72:75] offset:34816
  v_mfma_f32_16x16x32_bf16 v[88:91], v[200:203], v[48:51], v[88:91]
  v_mfma_f32_16x16x32_bf16 v[92:95], v[204:207], v[48:51], v[92:95]
  s_waitcnt vmcnt(6)
  v_mfma_f32_16x16x32_bf16 v[80:83], v[208:211], v[52:55], v[80:83]
Lstub8:
  s_cbranch_execz Lret8_3950
  ds_write_b128 v11, v[76:79] offset:35840
  v_mfma_f32_16x16x32_bf16 v[84:87], v[212:215], v[52:55], v[84:87]
  v_mfma_f32_16x16x32_bf16 v[88:91], v[216:219], v[52:55], v[88:91]
  v_mfma_f32_16x16x32_bf16 v[92:95], v[220:223], v[52:55], v[92:95]
  s_waitcnt vmcnt(5)
  v_mfma_f32_16x16x32_bf16 v[80:83], v[224:227], v[56:59], v[80:83]
  v_mfma_f32_16x16x32_bf16 v[84:87], v[228:231], v[56:59], v[84:87]
  v_mfma_f32_16x16x32_bf16 v[88:91], v[232:235], v[56:59], v[88:91]
  v_mfma_f32_16x16x32_bf16 v[92:95], v[236:239], v[56:59], v[92:95]
  s_waitcnt vmcnt(4)
  v_mfma_f32_16x16x32_bf16 v[80:83], v[240:243], v[60:63], v[80:83]
  s_waitcnt lgkmcnt(0)
  v_mfma_f32_16x16x32_bf16 v[84:87], v[244:247], v[60:63], v[84:87]
  s_barrier
  v_mfma_f32_16x16x32_bf16 v[88:91], v[248:251], v[60:63], v[88:91]
  ds_read_b128 v[112:115], v9 offset:0
  v_mfma_f32_16x16x32_bf16 v[92:95], v[252:255], v[60:63], v[92:95]
  ds_read_b128 v[116:119], v9 offset:1024
  s_waitcnt vmcnt(3)
  v_mfma_f32_16x16x32_bf16 v[80:83], a[192:195], a[128:131], v[80:83]
  ds_read_b128 v[120:123], v9 offset:2048
  v_mfma_f32_16x16x32_bf16 v[84:87], a[196:199], a[128:131], v[84:87]
  ds_read_b128 v[124:127], v9 offset:3072
  v_mfma_f32_16x16x32_bf16 v[88:91], a[200:203], a[128:131], v[88:91]
  ds_read_b128 v[128:131], v9 offset:4096
  v_mfma_f32_16x16x32_bf16 v[92:95], a[204:207], a[128:131], v[92:95]
  s_waitcnt vmcnt(2)
  v_mfma_f32_16x16x32_bf16 v[80:83], a[208:211], a[132:135], v[80:83]
  ds_read_b128 v[132:135], v9 offset:5120
  v_mfma_f32_16x16x32_bf16 v[84:87], a[212:215], a[132:135], v[84:87]
  ds_read_b128 v[136:139], v9 offset:6144
  v_mfma_f32_16x16x32_bf16 v[88:91], a[216:219], a[132:135], v[88:91]
  ds_read_b128 v[140:143], v9 offset:7168
  v_mfma_f32_16x16x32_bf16 v[92:95], a[220:223], a[132:135], v[92:95]
  ds_read_b128 v[16:19], v9 offset:32768
  s_waitcnt vmcnt(1)
  v_mfma_f32_16x16x32_bf16 v[80:83], a[224:227], a[136:139], v[80:83]
  ds_read_b128 v[20:23], v9 offset:33792
  v_mfma_f32_16x16x32_bf16 v[84:87], a[228:231], a[136:139], v[84:87]
  ds_read_b128 v[24:27], v9 offset:34816
  v_mfma_f32_16x16x32_bf16 v[88:91], a[232:235], a[136:139], v[88:91]
  ds_read_b128 v[28:31], v9 offset:35840
  v_mfma_f32_16x16x32_bf16 v[92:95], a[236:239], a[136:139], v[92:95]
  s_waitcnt vmcnt(0)
  v_mfma_f32_16x16x32_bf16 v[88:91], a[248:251], a[140:143], v[88:91]
  v_add_u32 v10, s50, v8
  v_mfma_f32_16x16x32_bf16 v[92:95], a[252:255], a[140:143], v[92:95]
  v_mfma_f32_16x16x32_bf16 v[80:83], a[240:243], a[140:143], v[80:83]
  v_mfma_f32_16x16x32_bf16 v[84:87], a[244:247], a[140:143], v[84:87]
  s_waitcnt lgkmcnt(4)
  v_pk_add_f32 v[112:113], v[112:113], v[120:121]
  v_pk_add_f32 v[114:115], v[114:115], v[122:123]
  v_pk_add_f32 v[116:117], v[116:117], v[124:125]
  v_pk_add_f32 v[118:119], v[118:119], v[126:127]
  ds_write_b128 v10, v[88:91] offset:36864
  ds_write_b128 v10, v[92:95] offset:37888
  ds_write_b128 v12, v[80:83] offset:38912
  ds_write_b128 v12, v[84:87] offset:39936
  v_pk_add_f32 v[128:129], v[128:129], v[136:137]
  v_pk_add_f32 v[130:131], v[130:131], v[138:139]
  v_pk_add_f32 v[132:133], v[132:133], v[140:141]
  v_pk_add_f32 v[134:135], v[134:135], v[142:143]
  v_pk_add_f32 v[128:129], v[128:129], v[112:113]
  v_pk_add_f32 v[130:131], v[130:131], v[114:115]
  v_pk_add_f32 v[132:133], v[132:133], v[116:117]
  v_pk_add_f32 v[134:135], v[134:135], v[118:119]
  s_waitcnt lgkmcnt(0)
  s_barrier
  ds_read_b128 v[112:115], v9 offset:36864
  ds_read_b128 v[116:119], v9 offset:37888
  ds_read_b128 v[120:123], v9 offset:38912
  ds_read_b128 v[124:127], v9 offset:39936
  v_pk_mul_f32 v[128:129], v[128:129], v[100:101] op_sel_hi:[1,0]
  v_pk_mul_f32 v[130:131], v[130:131], v[100:101] op_sel_hi:[1,0]
  v_pk_mul_f32 v[132:133], v[132:133], v[100:101] op_sel_hi:[1,0]
  v_pk_mul_f32 v[134:135], v[134:135], v[100:101] op_sel_hi:[1,0]
  v_cvt_pk_bf16_f32 v96, v128, v129
  v_cvt_pk_bf16_f32 v97, v130, v131
  v_cvt_pk_bf16_f32 v98, v132, v133
  v_cvt_pk_bf16_f32 v99, v134, v135
  buffer_store_dwordx4 v[96:99], v13, s[20:23], s24 offen sc1
  v_pk_add_f32 v[16:17], v[16:17], v[24:25]
  v_pk_add_f32 v[18:19], v[18:19], v[26:27]
  v_pk_add_f32 v[20:21], v[20:21], v[28:29]
  v_pk_add_f32 v[22:23], v[22:23], v[30:31]
  s_waitcnt lgkmcnt(2)
  v_pk_add_f32 v[16:17], v[16:17], v[112:113]
  v_pk_add_f32 v[18:19], v[18:19], v[114:115]
  v_pk_add_f32 v[20:21], v[20:21], v[116:117]
  v_pk_add_f32 v[22:23], v[22:23], v[118:119]
  s_waitcnt lgkmcnt(0)
  v_pk_add_f32 v[16:17], v[16:17], v[120:121]
  v_pk_add_f32 v[18:19], v[18:19], v[122:123]
  v_pk_add_f32 v[20:21], v[20:21], v[124:125]
  v_pk_add_f32 v[22:23], v[22:23], v[126:127]
  v_pk_mul_f32 v[16:17], v[16:17], v[102:103] op_sel_hi:[1,0]
  v_pk_mul_f32 v[18:19], v[18:19], v[102:103] op_sel_hi:[1,0]
  v_pk_mul_f32 v[20:21], v[20:21], v[102:103] op_sel_hi:[1,0]
  v_pk_mul_f32 v[22:23], v[22:23], v[102:103] op_sel_hi:[1,0]
  v_cvt_pk_bf16_f32 v108, v16, v17
  v_cvt_pk_bf16_f32 v109, v18, v19
  v_cvt_pk_bf16_f32 v110, v20, v21
  v_cvt_pk_bf16_f32 v111, v22, v23
  buffer_store_dwordx4 v[108:111], v13, s[20:23], s25 offen sc1
  s_endpgm
Lsl_28:
  s_mov_b32 s7, 0x100000
Lpoll_32:
  buffer_load_dword v4, v15, s[8:11], s95 offen sc1
  s_sub_u32 s7, s7, 1
  s_cbranch_scc1 Ldone_33
  s_waitcnt vmcnt(0)
  v_cmp_gt_u32 vcc, 16, v4
  s_cbranch_vccz Ldone_33
  s_sleep 4
  s_branch Lpoll_32
Ldone_33:
  s_branch Lbk_29
Lsl_30:
  s_mov_b32 s7, 0x100000
Lpoll_34:
  buffer_load_dword v4, v15, s[8:11], s26 offen sc1
  s_sub_u32 s7, s7, 1
  s_cbranch_scc1 Ldone_35
  s_waitcnt vmcnt(0)
  v_cmp_gt_u32 vcc, 16, v4
  s_cbranch_vccz Ldone_35
  s_sleep 4
  s_branch Lpoll_34
Ldone_35:
  s_branch Lbk_31
C0_SP:
  s_mov_b32 s7, 0x100000
Lpoll_10:
  buffer_load_dword v4, v13, s[8:11], s31 offen sc1
  s_sub_u32 s7, s7, 1
  s_cbranch_scc1 Ldone_11
  s_waitcnt vmcnt(0)
  v_cmp_gt_u32 vcc, s30, v4
  s_cbranch_vccz Ldone_11
  s_sleep 2
  s_branch Lpoll_10
Ldone_11:
  s_branch C0_BK
G1_DTB:
  s_bitcmp1_b32 s45, 0
  s_cbranch_scc0 G1_NODb
  v_lshrrev_b32 v8, 2, v2
  v_lshlrev_b32 v8, 10, v8
  v_and_b32 v9, 3, v2
  v_lshl_add_u32 v8, v9, 4, v8
  v_lshrrev_b32 v9, 1, v3
  v_lshl_add_u32 v8, v9, 6, v8
  v_and_b32 v9, 1, v3
  v_lshl_add_u32 v8, v9, 3, v8
  s_lshl_b32 s4, s3, 13
  v_add_u32 v8, s4, v8
  s_add_u32 s5, s46, 26476544
G1_DTb:
  ds_read_b64_tr_b16 v[16:17], v8 offset:0
  ds_read_b64_tr_b16 v[18:19], v8 offset:4096
  ds_read_b64_tr_b16 v[20:21], v8 offset:128
  ds_read_b64_tr_b16 v[22:23], v8 offset:4224
  ds_read_b64_tr_b16 v[24:25], v8 offset:256
  ds_read_b64_tr_b16 v[26:27], v8 offset:4352
  ds_read_b64_tr_b16 v[28:29], v8 offset:384
  ds_read_b64_tr_b16 v[30:31], v8 offset:4480
  ds_read_b64_tr_b16 v[32:33], v8 offset:512
  ds_read_b64_tr_b16 v[34:35], v8 offset:4608
  ds_read_b64_tr_b16 v[36:37], v8 offset:640
  ds_read_b64_tr_b16 v[38:39], v8 offset:4736
  s_waitcnt lgkmcnt(8)
  ds_read_b64_tr_b16 v[40:41], v8 offset:768
  ds_read_b64_tr_b16 v[42:43], v8 offset:4864
  ds_read_b64_tr_b16 v[44:45], v8 offset:896
  ds_read_b64_tr_b16 v[46:47], v8 offset:4992
  s_waitcnt lgkmcnt(0)
  buffer_store_dwordx4 v[16:19], v1, s[8:11], s5 offen sc1
  s_add_u32 s5, s5, 176128
  buffer_store_dwordx4 v[20:23], v1, s[8:11], s5 offen sc1
  s_add_u32 s5, s5, 176128
  buffer_store_dwordx4 v[24:27], v1, s[8:11], s5 offen sc1
  s_add_u32 s5, s5, 176128
  buffer_store_dwordx4 v[28:31], v1, s[8:11], s5 offen sc1
  s_add_u32 s5, s5, 176128
  buffer_store_dwordx4 v[32:35], v1, s[8:11], s5 offen sc1
  s_add_u32 s5, s5, 176128
  buffer_store_dwordx4 v[36:39], v1, s[8:11], s5 offen sc1
  s_add_u32 s5, s5, 176128
  buffer_store_dwordx4 v[40:43], v1, s[8:11], s5 offen sc1
  s_add_u32 s5, s5, 176128
  buffer_store_dwordx4 v[44:47], v1, s[8:11], s5 offen sc1
  s_cmp_eq_u32 s45, 3
  s_mov_b32 s45, 1
  s_cbranch_scc0 G1_NODb
  v_add_u32 v8, 98304, v8
  s_lshl_b32 s5, s1, 10
  s_add_u32 s5, s5, 26476544
  s_branch G1_DTb
G1_NODb:
  s_branch G1_DTR
G1_STATS0:
  buffer_load_dwordx4 v1, s[8:11], s28 offen sc1 lds
  buffer_load_dwordx4 v1, s[8:11], s28 offen offset:1024 sc1 lds
  s_add_u32 m0, m0, 8192
  s_add_u32 s28, s28, 8192
  buffer_load_dwordx4 v1, s[8:11], s28 offen sc1 lds
  buffer_load_dwordx4 v1, s[8:11], s28 offen offset:1024 sc1 lds
  s_add_u32 m0, m0, 8192
  s_add_u32 s28, s28, 8192
  buffer_load_dwordx4 v1, s[8:11], s28 offen sc1 lds
  buffer_load_dwordx4 v1, s[8:11], s28 offen offset:1024 sc1 lds
  s_add_u32 m0, m0, 8192
  s_add_u32 s28, s28, 8192
  buffer_load_dwordx4 v1, s[8:11], s28 offen sc1 lds
  buffer_load_dwordx4 v1, s[8:11], s28 offen offset:1024 sc1 lds
  s_add_u32 m0, m0, 8192
  s_add_u32 s28, s28, 8192
  buffer_load_dwordx4 v1, s[8:11], s28 offen sc1 lds
  buffer_load_dwordx4 v1, s[8:11], s28 offen offset:1024 sc1 lds
  s_add_u32 m0, m0, 8192
  s_add_u32 s28, s28, 8192
  buffer_load_dwordx4 v1, s[8:11], s28 offen sc1 lds
  buffer_load_dwordx4 v1, s[8:11], s28 offen offset:1024 sc1 lds
  s_add_u32 m0, m0, 8192
  s_add_u32 s28, s28, 8192
  buffer_load_dwordx4 v1, s[8:11], s28 offen sc1 lds
  buffer_load_dwordx4 v1, s[8:11], s28 offen offset:1024 sc1 lds
  s_add_u32 m0, m0, 8192
  s_add_u32 s28, s28, 8192
  buffer_load_dwordx4 v1, s[8:11], s28 offen sc1 lds
  buffer_load_dwordx4 v1, s[8:11], s28 offen offset:1024 sc1 lds
  s_add_u32 m0, m0, 8192
  s_add_u32 s28, s28, 8192
  buffer_load_dwordx4 v1, s[8:11], s28 offen sc1 lds
  buffer_load_dwordx4 v1, s[8:11], s28 offen offset:1024 sc1 lds
  s_add_u32 m0, m0, 8192
  s_add_u32 s28, s28, 8192
  buffer_load_dwordx4 v1, s[8:11], s28 offen sc1 lds
  buffer_load_dwordx4 v1, s[8:11], s28 offen offset:1024 sc1 lds
  s_add_u32 m0, m0, 8192
  s_add_u32 s28, s28, 8192
  buffer_load_dwordx4 v1, s[8:11], s28 offen sc1 lds
  buffer_load_dwordx4 v1, s[8:11], s28 offen offset:1024 sc1 lds
  s_add_u32 m0, m0, 8192
  s_add_u32 s28, s28, 8192
  s_lshl_b32 s1, s53, 15
  s_lshl_b32 s4, s3, 13
  s_add_u32 s1, s1, s4
  s_add_u32 s4, s1, 40960
  s_add_u32 s5, s4, 4096
  s_add_u32 s91, s32, 29360128
  buffer_load_dwordx4 v[144:147], v6, s[8:11], s91 offen offset:0 sc1
  buffer_load_dwordx4 v[148:151], v6, s[8:11], s91 offen offset:256 sc1
  buffer_load_dwordx4 v[152:155], v6, s[8:11], s91 offen offset:512 sc1
  buffer_load_dwordx4 v[156:159], v6, s[8:11], s91 offen offset:768 sc1
  s_add_u32 s91, s32, 29364224
  buffer_load_dwordx4 v[160:163], v6, s[8:11], s91 offen offset:0 sc1
  buffer_load_dwordx4 v[164:167], v6, s[8:11], s91 offen offset:256 sc1
  buffer_load_dwordx4 v[168:171], v6, s[8:11], s91 offen offset:512 sc1
  buffer_load_dwordx4 v[172:175], v6, s[8:11], s91 offen offset:768 sc1
  s_add_u32 s91, s32, 29368320
  buffer_load_dwordx4 v[176:179], v6, s[8:11], s91 offen offset:0 sc1
  buffer_load_dwordx4 v[180:183], v6, s[8:11], s91 offen offset:256 sc1
  s_lshl_b32 s6, s3, 9
  v_add_u32 v8, s6, v8
  v_add_u32 v9, s6, v9
  v_add_u32 v10, s6, v10
  v_add_u32 v11, s6, v11
  v_mov_b32 v88, -1
  v_mov_b32 v89, 0xffff
  v_cmp_gt_u32 vcc, 16, v0
  s_nop 1
  v_cndmask_b32 v88, v88, v89, vcc
  s_waitcnt vmcnt(10)
  s_barrier
  ds_read_b64_tr_b16 v[16:17], v8 offset:0
  ds_read_b64_tr_b16 v[18:19], v9 offset:0
  ds_read_b64_tr_b16 v[20:21], v8 offset:256
  ds_read_b64_tr_b16 v[22:23], v9 offset:256
  buffer_load_dwordx4 v[184:187], v6, s[8:11], s91 offen offset:512 sc1
  ds_read_b64_tr_b16 v[24:25], v8 offset:8192
  ds_read_b64_tr_b16 v[26:27], v9 offset:8192
  ds_read_b64_tr_b16 v[28:29], v8 offset:8448
  ds_read_b64_tr_b16 v[30:31], v9 offset:8448
  buffer_load_dwordx4 v[188:191], v6, s[8:11], s91 offen offset:768 sc1
  s_waitcnt lgkmcnt(4)
  ds_read_b64_tr_b16 v[32:33], v8 offset:16384
  ds_read_b64_tr_b16 v[34:35], v9 offset:16384
  ds_read_b64_tr_b16 v[36:37], v8 offset:16640
  ds_read_b64_tr_b16 v[38:39], v9 offset:16640
  s_add_u32 s91, s32, 29372416
  ds_read_b64_tr_b16 v[40:41], v8 offset:24576
  ds_read_b64_tr_b16 v[42:43], v9 offset:24576
  ds_read_b64_tr_b16 v[44:45], v8 offset:24832
  ds_read_b64_tr_b16 v[46:47], v9 offset:24832
  buffer_load_dwordx4 v[192:195], v6, s[8:11], s91 offen offset:0 sc1
  s_waitcnt lgkmcnt(4)
  ds_read_b64_tr_b16 v[48:49], v8 offset:32768
  ds_read_b64_tr_b16 v[50:51], v9 offset:32768
  ds_read_b64_tr_b16 v[52:53], v8 offset:33024
  ds_read_b64_tr_b16 v[54:55], v9 offset:33024
  buffer_load_dwordx4 v[196:199], v6, s[8:11], s91 offen offset:256 sc1
  ds_read_b64_tr_b16 v[56:57], v8 offset:40960
  ds_read_b64_tr_b16 v[58:59], v9 offset:40960
  ds_read_b64_tr_b16 v[60:61], v8 offset:41216
  ds_read_b64_tr_b16 v[62:63], v9 offset:41216
  buffer_load_dwordx4 v[200:203], v6, s[8:11], s91 offen offset:512 sc1
  s_waitcnt lgkmcnt(4)
  ds_read_b64_tr_b16 v[64:65], v8 offset:49152
  ds_read_b64_tr_b16 v[66:67], v9 offset:49152
  ds_read_b64_tr_b16 v[68:69], v8 offset:49408
  ds_read_b64_tr_b16 v[70:71], v9 offset:49408
  buffer_load_dwordx4 v[204:207], v6, s[8:11], s91 offen offset:768 sc1
  ds_read_b64_tr_b16 v[72:73], v8 offset:57344
  ds_read_b64_tr_b16 v[74:75], v9 offset:57344
  ds_read_b64_tr_b16 v[76:77], v8 offset:57600
  ds_read_b64_tr_b16 v[78:79], v9 offset:57600
  s_add_u32 s91, s32, 29376512
  s_waitcnt lgkmcnt(4)
  s_waitcnt lgkmcnt(0)
  v_and_b32 v16, v16, v88
  v_and_b32 v20, v20, v88
  s_nop 0
  v_mfma_f32_16x16x32_bf16 v[80:83], v[16:19], v[16:19], 0
  v_mfma_f32_16x16x32_bf16 v[84:87], v[20:23], v[20:23], 0
  buffer_load_dwordx4 v[208:211], v6, s[8:11], s91 offen offset:0 sc1
  v_mfma_f32_16x16x32_bf16 v[80:83], v[24:27], v[24:27], v[80:83]
  v_mfma_f32_16x16x32_bf16 v[84:87], v[28:31], v[28:31], v[84:87]
  v_mfma_f32_16x16x32_bf16 v[80:83], v[32:35], v[32:35], v[80:83]
  v_mfma_f32_16x16x32_bf16 v[84:87], v[36:39], v[36:39], v[84:87]
  buffer_load_dwordx4 v[212:215], v6, s[8:11], s91 offen offset:256 sc1
  v_mfma_f32_16x16x32_bf16 v[80:83], v[40:43], v[40:43], v[80:83]
  v_mfma_f32_16x16x32_bf16 v[84:87], v[44:47], v[44:47], v[84:87]
  v_mfma_f32_16x16x32_bf16 v[80:83], v[48:51], v[48:51], v[80:83]
  v_mfma_f32_16x16x32_bf16 v[84:87], v[52:55], v[52:55], v[84:87]
  buffer_load_dwordx4 v[216:219], v6, s[8:11], s91 offen offset:512 sc1
  v_mfma_f32_16x16x32_bf16 v[80:83], v[56:59], v[56:59], v[80:83]
  v_mfma_f32_16x16x32_bf16 v[84:87], v[60:63], v[60:63], v[84:87]
  v_mfma_f32_16x16x32_bf16 v[80:83], v[64:67], v[64:67], v[80:83]
  v_mfma_f32_16x16x32_bf16 v[84:87], v[68:71], v[68:71], v[84:87]
  buffer_load_dwordx4 v[220:223], v6, s[8:11], s91 offen offset:768 sc1
  v_mfma_f32_16x16x32_bf16 v[80:83], v[72:75], v[72:75], v[80:83]
  v_mfma_f32_16x16x32_bf16 v[84:87], v[76:79], v[76:79], v[84:87]
  ds_read_b64_tr_b16 v[16:17], v10 offset:0
  ds_read_b64_tr_b16 v[18:19], v11 offset:0
  s_add_u32 s91, s32, 29380608
  ds_read_b64_tr_b16 v[20:21], v10 offset:256
  ds_read_b64_tr_b16 v[22:23], v11 offset:256
  ds_read_b64_tr_b16 v[24:25], v10 offset:8192
  ds_read_b64_tr_b16 v[26:27], v11 offset:8192
  buffer_load_dwordx4 v[224:227], v6, s[8:11], s91 offen offset:0 sc1
  ds_read_b64_tr_b16 v[28:29], v10 offset:8448
  ds_read_b64_tr_b16 v[30:31], v11 offset:8448
  s_waitcnt lgkmcnt(4)
  ds_read_b64_tr_b16 v[32:33], v10 offset:16384
  ds_read_b64_tr_b16 v[34:35], v11 offset:16384
  buffer_load_dwordx4 v[228:231], v6, s[8:11], s91 offen offset:256 sc1
  ds_read_b64_tr_b16 v[36:37], v10 offset:16640
  ds_read_b64_tr_b16 v[38:39], v11 offset:16640
  ds_read_b64_tr_b16 v[40:41], v10 offset:24576
  ds_read_b64_tr_b16 v[42:43], v11 offset:24576
  buffer_load_dwordx4 v[232:235], v6, s[8:11], s91 offen offset:512 sc1
  ds_read_b64_tr_b16 v[44:45], v10 offset:24832
  ds_read_b64_tr_b16 v[46:47], v11 offset:24832
  s_waitcnt lgkmcnt(4)
  ds_read_b64_tr_b16 v[48:49], v10 offset:32768
  ds_read_b64_tr_b16 v[50:51], v11 offset:32768
  buffer_load_dwordx4 v[236:239], v6, s[8:11], s91 offen offset:768 sc1
  ds_read_b64_tr_b16 v[52:53], v10 offset:33024
  ds_read_b64_tr_b16 v[54:55], v11 offset:33024
  ds_read_b64_tr_b16 v[56:57], v10 offset:40960
  ds_read_b64_tr_b16 v[58:59], v11 offset:40960
  s_add_u32 s91, s32, 29384704
  ds_read_b64_tr_b16 v[60:61], v10 offset:41216
  ds_read_b64_tr_b16 v[62:63], v11 offset:41216
  s_waitcnt lgkmcnt(4)
  ds_read_b64_tr_b16 v[64:65], v10 offset:49152
  ds_read_b64_tr_b16 v[66:67], v11 offset:49152
  buffer_load_dwordx4 v[240:243], v6, s[8:11], s91 offen offset:0 sc1
  ds_read_b64_tr_b16 v[68:69], v10 offset:49408
  ds_read_b64_tr_b16 v[70:71], v11 offset:49408
  ds_read_b64_tr_b16 v[72:73], v10 offset:57344
  ds_read_b64_tr_b16 v[74:75], v11 offset:57344
  buffer_load_dwordx4 v[244:247], v6, s[8:11], s91 offen offset:256 sc1
  ds_read_b64_tr_b16 v[76:77], v10 offset:57600
  ds_read_b64_tr_b16 v[78:79], v11 offset:57600
  s_waitcnt lgkmcnt(4)
  s_waitcnt lgkmcnt(0)
  v_mfma_f32_16x16x32_bf16 v[80:83], v[16:19], v[16:19], v[80:83]
  v_mfma_f32_16x16x32_bf16 v[84:87], v[20:23], v[20:23], v[84:87]
  v_mfma_f32_16x16x32_bf16 v[80:83], v[24:27], v[24:27], v[80:83]
  v_mfma_f32_16x16x32_bf16 v[84:87], v[28:31], v[28:31], v[84:87]
  v_mfma_f32_16x16x32_bf16 v[80:83], v[32:35], v[32:35], v[80:83]
  v_mfma_f32_16x16x32_bf16 v[84:87], v[36:39], v[36:39], v[84:87]
  v_mfma_f32_16x16x32_bf16 v[80:83], v[40:43], v[40:43], v[80:83]
  v_mfma_f32_16x16x32_bf16 v[84:87], v[44:47], v[44:47], v[84:87]
  v_mfma_f32_16x16x32_bf16 v[80:83], v[48:51], v[48:51], v[80:83]
  v_mfma_f32_16x16x32_bf16 v[84:87], v[52:55], v[52:55], v[84:87]
  v_mfma_f32_16x16x32_bf16 v[80:83], v[56:59], v[56:59], v[80:83]
  v_mfma_f32_16x16x32_bf16 v[84:87], v[60:63], v[60:63], v[84:87]
  v_mfma_f32_16x16x32_bf16 v[80:83], v[64:67], v[64:67], v[80:83]
  v_mfma_f32_16x16x32_bf16 v[84:87], v[68:71], v[68:71], v[84:87]
  v_mfma_f32_16x16x32_bf16 v[80:83], v[72:75], v[72:75], v[80:83]
  v_mfma_f32_16x16x32_bf16 v[84:87], v[76:79], v[76:79], v[84:87]
  v_and_b32 v89, 3, v2
  v_mov_b32 v90, 0x3727c5ac
  v_cmp_eq_u32 vcc, 1, v89
  s_nop 3
  v_cndmask_b32 v80, v80, v81, vcc
  v_cndmask_b32 v84, v84, v85, vcc
  v_cmp_eq_u32 vcc, 2, v89
  s_nop 1
  v_cndmask_b32 v80, v80, v82, vcc
  v_cndmask_b32 v84, v84, v86, vcc
  v_cmp_eq_u32 vcc, 3, v89
  s_nop 1
  v_cndmask_b32 v80, v80, v83, vcc
  v_cndmask_b32 v84, v84, v87, vcc
  v_fma_f32 v80, v80, s16, v90
  v_fma_f32 v84, v84, s16, v90
  v_rcp_f32 v81, v80
  v_rcp_f32 v85, v84
  buffer_load_dwordx4 v[248:251], v6, s[8:11], s91 offen offset:512 sc1
  buffer_load_dwordx4 v[252:255], v6, s[8:11], s91 offen offset:768 sc1
  s_add_u32 s91, s32, 29388800
  buffer_load_dwordx4 a[192:195], v6, s[8:11], s91 offen offset:0 sc1
  buffer_load_dwordx4 a[196:199], v6, s[8:11], s91 offen offset:256 sc1
  buffer_load_dwordx4 a[200:203], v6, s[8:11], s91 offen offset:512 sc1
  buffer_load_dwordx4 a[204:207], v6, s[8:11], s91 offen offset:768 sc1
  s_add_u32 s91, s32, 29392896
  buffer_load_dwordx4 a[208:211], v6, s[8:11], s91 offen offset:0 sc1
  buffer_load_dwordx4 a[212:215], v6, s[8:11], s91 offen offset:256 sc1
  buffer_load_dwordx4 a[216:219], v6, s[8:11], s91 offen offset:512 sc1
  buffer_load_dwordx4 a[220:223], v6, s[8:11], s91 offen offset:768 sc1
  v_lshlrev_b32 v88, 2, v2
  s_lshl_b32 s6, s53, 9
  s_add_u32 s6, s6, 33570816
  s_lshl_b32 s7, s3, 7
  s_add_u32 s6, s6, s7
  v_lshrrev_b32 v89, 2, v2
  v_cmp_eq_u32 vcc, v89, v3
  s_nop 0
  s_mov_b64 exec, vcc
  buffer_store_dword v81, v88, s[8:11], s6 offen offset:0 sc1
  buffer_store_dword v85, v88, s[8:11], s6 offen offset:64 sc1
  s_mov_b64 exec, -1
  s_waitcnt vmcnt(40)
  s_add_u32 s4, s1, 25952256
  s_add_u32 s5, s4, 4096
  buffer_store_dwordx4 a[160:163], v1, s[8:11], s4 offen offset:0 sc1
  buffer_store_dwordx4 a[164:167], v1, s[8:11], s4 offen offset:1024 sc1
  buffer_store_dwordx4 a[168:171], v1, s[8:11], s4 offen offset:2048 sc1
  buffer_store_dwordx4 a[172:175], v1, s[8:11], s4 offen offset:3072 sc1
  buffer_store_dwordx4 a[176:179], v1, s[8:11], s5 offen offset:0 sc1
  buffer_store_dwordx4 a[180:183], v1, s[8:11], s5 offen offset:1024 sc1
  buffer_store_dwordx4 a[184:187], v1, s[8:11], s5 offen offset:2048 sc1
  buffer_store_dwordx4 a[188:191], v1, s[8:11], s5 offen offset:3072 sc1
  s_branch G1_END0
G1_STATS1:
  buffer_load_dwordx4 v1, s[8:11], s28 offen sc1 lds
  buffer_load_dwordx4 v1, s[8:11], s28 offen offset:1024 sc1 lds
  s_add_u32 m0, m0, 8192
  s_add_u32 s28, s28, 8192
  buffer_load_dwordx4 v1, s[8:11], s28 offen sc1 lds
  buffer_load_dwordx4 v1, s[8:11], s28 offen offset:1024 sc1 lds
  s_add_u32 m0, m0, 8192
  s_add_u32 s28, s28, 8192
  buffer_load_dwordx4 v1, s[8:11], s28 offen sc1 lds
  buffer_load_dwordx4 v1, s[8:11], s28 offen offset:1024 sc1 lds
  s_add_u32 m0, m0, 8192
  s_add_u32 s28, s28, 8192
  buffer_load_dwordx4 v1, s[8:11], s28 offen sc1 lds
  buffer_load_dwordx4 v1, s[8:11], s28 offen offset:1024 sc1 lds
  s_add_u32 m0, m0, 8192
  s_add_u32 s28, s28, 8192
  buffer_load_dwordx4 v1, s[8:11], s28 offen sc1 lds
  buffer_load_dwordx4 v1, s[8:11], s28 offen offset:1024 sc1 lds
  s_add_u32 m0, m0, 8192
  s_add_u32 s28, s28, 8192
  buffer_load_dwordx4 v1, s[8:11], s28 offen sc1 lds
  buffer_load_dwordx4 v1, s[8:11], s28 offen offset:1024 sc1 lds
  s_add_u32 m0, m0, 8192
  s_add_u32 s28, s28, 8192
  buffer_load_dwordx4 v1, s[8:11], s28 offen sc1 lds
  buffer_load_dwordx4 v1, s[8:11], s28 offen offset:1024 sc1 lds
  s_add_u32 m0, m0, 8192
  s_add_u32 s28, s28, 8192
  buffer_load_dwordx4 v1, s[8:11], s28 offen sc1 lds
  buffer_load_dwordx4 v1, s[8:11], s28 offen offset:1024 sc1 lds
  s_add_u32 m0, m0, 8192
  s_add_u32 s28, s28, 8192
  buffer_load_dwordx4 v1, s[8:11], s28 offen sc1 lds
  buffer_load_dwordx4 v1, s[8:11], s28 offen offset:1024 sc1 lds
  s_add_u32 m0, m0, 8192
  s_add_u32 s28, s28, 8192
  buffer_load_dwordx4 v1, s[8:11], s28 offen sc1 lds
  buffer_load_dwordx4 v1, s[8:11], s28 offen offset:1024 sc1 lds
  s_add_u32 m0, m0, 8192
  s_add_u32 s28, s28, 8192
  buffer_load_dwordx4 v1, s[8:11], s28 offen sc1 lds
  buffer_load_dwordx4 v1, s[8:11], s28 offen offset:1024 sc1 lds
  s_add_u32 m0, m0, 8192
  s_add_u32 s28, s28, 8192
  s_add_u32 s91, s32, 26480640
  buffer_load_dwordx4 v[160:163], v6, s[8:11], s91 offen offset:0 sc1
  buffer_load_dwordx4 v[164:167], v6, s[8:11], s91 offen offset:256 sc1
  s_sub_u32 s91, s91, s57
  buffer_load_dwordx4 v[168:171], v6, s[8:11], s91 offen offset:512 sc1
  buffer_load_dwordx4 v[172:175], v6, s[8:11], s91 offen offset:768 sc1
  s_add_u32 s91, s32, 26484736
  buffer_load_dwordx4 v[176:179], v6, s[8:11], s91 offen offset:0 sc1
  buffer_load_dwordx4 v[180:183], v6, s[8:11], s91 offen offset:256 sc1
  s_sub_u32 s91, s91, s57
  buffer_load_dwordx4 v[184:187], v6, s[8:11], s91 offen offset:512 sc1
  buffer_load_dwordx4 v[188:191], v6, s[8:11], s91 offen offset:768 sc1
  s_add_u32 s91, s32, 26488832
  buffer_load_dwordx4 v[192:195], v6, s[8:11], s91 offen offset:0 sc1
  buffer_load_dwordx4 v[196:199], v6, s[8:11], s91 offen offset:256 sc1
  s_lshl_b32 s6, s3, 9
  v_add_u32 v8, s6, v8
  v_add_u32 v9, s6, v9
  v_add_u32 v10, s6, v10
  v_add_u32 v11, s6, v11
  v_mov_b32 v88, -1
  v_mov_b32 v89, 0xffff
  v_cmp_gt_u32 vcc, 16, v0
  s_nop 1
  v_cndmask_b32 v88, v88, v89, vcc
  s_waitcnt vmcnt(10)
  s_barrier
  ds_read_b64_tr_b16 v[16:17], v8 offset:0
  ds_read_b64_tr_b16 v[18:19], v9 offset:0
  ds_read_b64_tr_b16 v[20:21], v8 offset:256
  ds_read_b64_tr_b16 v[22:23], v9 offset:256
  s_sub_u32 s91, s91, s57
  ds_read_b64_tr_b16 v[24:25], v8 offset:8192
  ds_read_b64_tr_b16 v[26:27], v9 offset:8192
  ds_read_b64_tr_b16 v[28:29], v8 offset:8448
  ds_read_b64_tr_b16 v[30:31], v9 offset:8448
  buffer_load_dwordx4 v[200:203], v6, s[8:11], s91 offen offset:512 sc1
  s_waitcnt lgkmcnt(4)
  ds_read_b64_tr_b16 v[32:33], v8 offset:16384
  ds_read_b64_tr_b16 v[34:35], v9 offset:16384
  ds_read_b64_tr_b16 v[36:37], v8 offset:16640
  ds_read_b64_tr_b16 v[38:39], v9 offset:16640
  buffer_load_dwordx4 v[204:207], v6, s[8:11], s91 offen offset:768 sc1
  ds_read_b64_tr_b16 v[40:41], v8 offset:24576
  ds_read_b64_tr_b16 v[42:43], v9 offset:24576
  ds_read_b64_tr_b16 v[44:45], v8 offset:24832
  ds_read_b64_tr_b16 v[46:47], v9 offset:24832
  s_add_u32 s91, s32, 26492928
  s_waitcnt lgkmcnt(4)
  ds_read_b64_tr_b16 v[48:49], v8 offset:32768
  ds_read_b64_tr_b16 v[50:51], v9 offset:32768
  ds_read_b64_tr_b16 v[52:53], v8 offset:33024
  ds_read_b64_tr_b16 v[54:55], v9 offset:33024
  buffer_load_dwordx4 v[208:211], v6, s[8:11], s91 offen offset:0 sc1
  ds_read_b64_tr_b16 v[56:57], v8 offset:40960
  ds_read_b64_tr_b16 v[58:59], v9 offset:40960
  ds_read_b64_tr_b16 v[60:61], v8 offset:41216
  ds_read_b64_tr_b16 v[62:63], v9 offset:41216
  buffer_load_dwordx4 v[212:215], v6, s[8:11], s91 offen offset:256 sc1
  s_waitcnt lgkmcnt(4)
  ds_read_b64_tr_b16 v[64:65], v8 offset:49152
  ds_read_b64_tr_b16 v[66:67], v9 offset:49152
  ds_read_b64_tr_b16 v[68:69], v8 offset:49408
  ds_read_b64_tr_b16 v[70:71], v9 offset:49408
  s_sub_u32 s91, s91, s57
  ds_read_b64_tr_b16 v[72:73], v8 offset:57344
  ds_read_b64_tr_b16 v[74:75], v9 offset:57344
  ds_read_b64_tr_b16 v[76:77], v8 offset:57600
  ds_read_b64_tr_b16 v[78:79], v9 offset:57600
  buffer_load_dwordx4 v[216:219], v6, s[8:11], s91 offen offset:512 sc1
  s_waitcnt lgkmcnt(4)
  s_waitcnt lgkmcnt(0)
  v_and_b32 v16, v16, v88
  v_and_b32 v20, v20, v88
  s_nop 0
  v_mfma_f32_16x16x32_bf16 v[80:83], v[16:19], v[16:19], 0
  v_mfma_f32_16x16x32_bf16 v[84:87], v[20:23], v[20:23], 0
  buffer_load_dwordx4 v[220:223], v6, s[8:11], s91 offen offset:768 sc1
  v_mfma_f32_16x16x32_bf16 v[80:83], v[24:27], v[24:27], v[80:83]
  v_mfma_f32_16x16x32_bf16 v[84:87], v[28:31], v[28:31], v[84:87]
  v_mfma_f32_16x16x32_bf16 v[80:83], v[32:35], v[32:35], v[80:83]
  v_mfma_f32_16x16x32_bf16 v[84:87], v[36:39], v[36:39], v[84:87]
  s_add_u32 s91, s32, 26497024
  v_mfma_f32_16x16x32_bf16 v[80:83], v[40:43], v[40:43], v[80:83]
  v_mfma_f32_16x16x32_bf16 v[84:87], v[44:47], v[44:47], v[84:87]
  v_mfma_f32_16x16x32_bf16 v[80:83], v[48:51], v[48:51], v[80:83]
  v_mfma_f32_16x16x32_bf16 v[84:87], v[52:55], v[52:55], v[84:87]
  buffer_load_dwordx4 v[224:227], v6, s[8:11], s91 offen offset:0 sc1
  v_mfma_f32_16x16x32_bf16 v[80:83], v[56:59], v[56:59], v[80:83]
  v_mfma_f32_16x16x32_bf16 v[84:87], v[60:63], v[60:63], v[84:87]
  v_mfma_f32_16x16x32_bf16 v[80:83], v[64:67], v[64:67], v[80:83]
  v_mfma_f32_16x16x32_bf16 v[84:87], v[68:71], v[68:71], v[84:87]
  buffer_load_dwordx4 v[228:231], v6, s[8:11], s91 offen offset:256 sc1
  v_mfma_f32_16x16x32_bf16 v[80:83], v[72:75], v[72:75], v[80:83]
  v_mfma_f32_16x16x32_bf16 v[84:87], v[76:79], v[76:79], v[84:87]
  ds_read_b64_tr_b16 v[16:17], v10 offset:0
  ds_read_b64_tr_b16 v[18:19], v11 offset:0
  s_sub_u32 s91, s91, s57
  ds_read_b64_tr_b16 v[20:21], v10 offset:256
  ds_read_b64_tr_b16 v[22:23], v11 offset:256
  ds_read_b64_tr_b16 v[24:25], v10 offset:8192
  ds_read_b64_tr_b16 v[26:27], v11 offset:8192
  buffer_load_dwordx4 v[232:235], v6, s[8:11], s91 offen offset:512 sc1
  ds_read_b64_tr_b16 v[28:29], v10 offset:8448
  ds_read_b64_tr_b16 v[30:31], v11 offset:8448
  s_waitcnt lgkmcnt(4)
  ds_read_b64_tr_b16 v[32:33], v10 offset:16384
  ds_read_b64_tr_b16 v[34:35], v11 offset:16384
  buffer_load_dwordx4 v[236:239], v6, s[8:11], s91 offen offset:768 sc1
  ds_read_b64_tr_b16 v[36:37], v10 offset:16640
  ds_read_b64_tr_b16 v[38:39], v11 offset:16640
  ds_read_b64_tr_b16 v[40:41], v10 offset:24576
  ds_read_b64_tr_b16 v[42:43], v11 offset:24576
  s_add_u32 s91, s32, 26501120
  ds_read_b64_tr_b16 v[44:45], v10 offset:24832
  ds_read_b64_tr_b16 v[46:47], v11 offset:24832
  s_waitcnt lgkmcnt(4)
  ds_read_b64_tr_b16 v[48:49], v10 offset:32768
  ds_read_b64_tr_b16 v[50:51], v11 offset:32768
  buffer_load_dwordx4 v[240:243], v6, s[8:11], s91 offen offset:0 sc1
  ds_read_b64_tr_b16 v[52:53], v10 offset:33024
  ds_read_b64_tr_b16 v[54:55], v11 offset:33024
  ds_read_b64_tr_b16 v[56:57], v10 offset:40960
  ds_read_b64_tr_b16 v[58:59], v11 offset:40960
  buffer_load_dwordx4 v[244:247], v6, s[8:11], s91 offen offset:256 sc1
  ds_read_b64_tr_b16 v[60:61], v10 offset:41216
  ds_read_b64_tr_b16 v[62:63], v11 offset:41216
  s_waitcnt lgkmcnt(4)
  ds_read_b64_tr_b16 v[64:65], v10 offset:49152
  ds_read_b64_tr_b16 v[66:67], v11 offset:49152
  s_sub_u32 s91, s91, s57
  ds_read_b64_tr_b16 v[68:69], v10 offset:49408
  ds_read_b64_tr_b16 v[70:71], v11 offset:49408
  ds_read_b64_tr_b16 v[72:73], v10 offset:57344
  ds_read_b64_tr_b16 v[74:75], v11 offset:57344
  buffer_load_dwordx4 v[248:251], v6, s[8:11], s91 offen offset:512 sc1
  ds_read_b64_tr_b16 v[76:77], v10 offset:57600
  ds_read_b64_tr_b16 v[78:79], v11 offset:57600
  s_waitcnt lgkmcnt(4)
  s_waitcnt lgkmcnt(0)
  v_mfma_f32_16x16x32_bf16 v[80:83], v[16:19], v[16:19], v[80:83]
  v_mfma_f32_16x16x32_bf16 v[84:87], v[20:23], v[20:23], v[84:87]
  buffer_load_dwordx4 v[252:255], v6, s[8:11], s91 offen offset:768 sc1
  v_mfma_f32_16x16x32_bf16 v[80:83], v[24:27], v[24:27], v[80:83]
  v_mfma_f32_16x16x32_bf16 v[84:87], v[28:31], v[28:31], v[84:87]
  v_mfma_f32_16x16x32_bf16 v[80:83], v[32:35], v[32:35], v[80:83]
  v_mfma_f32_16x16x32_bf16 v[84:87], v[36:39], v[36:39], v[84:87]
  buffer_load_dwordx4 a[0:3], v1, s[8:11], s88 offen offset:0 sc1
  v_mfma_f32_16x16x32_bf16 v[80:83], v[40:43], v[40:43], v[80:83]
  v_mfma_f32_16x16x32_bf16 v[84:87], v[44:47], v[44:47], v[84:87]
  v_mfma_f32_16x16x32_bf16 v[80:83], v[48:51], v[48:51], v[80:83]
  v_mfma_f32_16x16x32_bf16 v[84:87], v[52:55], v[52:55], v[84:87]
  buffer_load_dwordx4 a[4:7], v1, s[8:11], s89 offen offset:0 sc1
  v_mfma_f32_16x16x32_bf16 v[80:83], v[56:59], v[56:59], v[80:83]
  v_mfma_f32_16x16x32_bf16 v[84:87], v[60:63], v[60:63], v[84:87]
  v_mfma_f32_16x16x32_bf16 v[80:83], v[64:67], v[64:67], v[80:83]
  v_mfma_f32_16x16x32_bf16 v[84:87], v[68:71], v[68:71], v[84:87]
  v_mfma_f32_16x16x32_bf16 v[80:83], v[72:75], v[72:75], v[80:83]
  v_mfma_f32_16x16x32_bf16 v[84:87], v[76:79], v[76:79], v[84:87]
  v_and_b32 v89, 3, v2
  v_mov_b32 v90, 0x3727c5ac
  v_cmp_eq_u32 vcc, 1, v89
  s_nop 3
  v_cndmask_b32 v80, v80, v81, vcc
  v_cndmask_b32 v84, v84, v85, vcc
  v_cmp_eq_u32 vcc, 2, v89
  s_nop 1
  v_cndmask_b32 v80, v80, v82, vcc
  v_cndmask_b32 v84, v84, v86, vcc
  v_cmp_eq_u32 vcc, 3, v89
  s_nop 1
  v_cndmask_b32 v80, v80, v83, vcc
  v_cndmask_b32 v84, v84, v87, vcc
  v_fma_f32 v80, v80, s16, v90
  v_fma_f32 v84, v84, s16, v90
  v_rcp_f32 v81, v80
  v_rcp_f32 v85, v84
  v_lshlrev_b32 v88, 2, v2
  s_lshl_b32 s6, s53, 9
  s_add_u32 s6, s6, 33579008
  s_lshl_b32 s7, s3, 7
  s_add_u32 s6, s6, s7
  v_lshrrev_b32 v89, 2, v2
  v_cmp_eq_u32 vcc, v89, v3
  s_nop 0
  s_mov_b64 exec, vcc
  buffer_store_dword v81, v88, s[8:11], s6 offen offset:0 sc1
  buffer_store_dword v85, v88, s[8:11], s6 offen offset:64 sc1
  s_mov_b64 exec, -1
  buffer_load_dwordx4 a[8:11], v1, s[8:11], s90 offen offset:0 sc1
  buffer_load_dwordx4 a[12:15], v1, s[8:11], s94 offen offset:0 sc1
  buffer_load_dwordx4 a[16:19], v1, s[8:11], s88 offen offset:1024 sc1
  buffer_load_dwordx4 a[20:23], v1, s[8:11], s89 offen offset:1024 sc1
  buffer_load_dwordx4 a[24:27], v1, s[8:11], s90 offen offset:1024 sc1
  buffer_load_dwordx4 a[28:31], v1, s[8:11], s94 offen offset:1024 sc1
  buffer_load_dwordx4 a[32:35], v1, s[8:11], s88 offen offset:2048 sc1
  s_waitcnt vmcnt(7)
  s_barrier
  s_mov_b64 exec, 1
  buffer_atomic_add v7, v15, s[8:11], s25 offen sc1
  s_mov_b64 exec, -1
  buffer_load_dwordx4 a[36:39], v1, s[8:11], s89 offen offset:2048 sc1
  buffer_load_dwordx4 a[40:43], v1, s[8:11], s90 offen offset:2048 sc1
  buffer_load_dwordx4 a[44:47], v1, s[8:11], s94 offen offset:2048 sc1
  buffer_load_dwordx4 a[48:51], v1, s[8:11], s88 offen offset:3072 sc1
  buffer_load_dwordx4 a[52:55], v1, s[8:11], s89 offen offset:3072 sc1
  buffer_load_dwordx4 a[56:59], v1, s[8:11], s90 offen offset:3072 sc1
  buffer_load_dwordx4 a[60:63], v1, s[8:11], s94 offen offset:3072 sc1
  buffer_load_dword v4, v15, s[8:11], s24 offen sc1
  s_waitcnt vmcnt(0)
  s_branch G1_END1
Lcode_end:
.section .rodata,"a"
.p2align 6
.amdhsa_kernel interleave_layers__spectral_gfnet__glu_gated_reglu__prompt_kernel
  .amdhsa_next_free_vgpr 512
  .amdhsa_next_free_sgpr 102
  .amdhsa_accum_offset 256
  .amdhsa_group_segment_fixed_size 0
  .amdhsa_kernarg_size 80
  .amdhsa_user_sgpr_count 2
  .amdhsa_user_sgpr_kernarg_segment_ptr 1
  .amdhsa_system_sgpr_workgroup_id_x 1
  .amdhsa_float_denorm_mode_32 3
.end_amdhsa_kernel

.p2align 8
.type tbl,@object
tbl:
.long 0x3e503e50,0x3e503e50,0x3e503e50,0x3e503e50,0x3e4c3e50,0x3e2d3e40,0xbe4cbe50,0xbe2dbe40,0x3e403e50,0x3d9f3e13,0x3e403e50,0x3d9f3e13,0x3e2d3e50,0xbd223d9f,0xbe2dbe50,0x3d22bd9f
.long 0x3e133e50,0xbe132365,0x3e133e50,0xbe132501,0x3de73e50,0xbe4cbd9f,0xbde7be50,0x3e4c3d9f,0x3d9f3e50,0xbe40be13,0x3d9f3e50,0xbe40be13,0x3d223e50,0xbde7be40,0xbd22be50,0x3de73e40
.long 0x23653e50,0xa42cbe50,0xa52c3e50,0xa62cbe50,0xbd223e50,0x3de7be40,0x3d22be50,0xbde73e40,0xbd9f3e50,0x3e40be13,0xbd9f3e50,0x3e40be13,0xbde73e50,0x3e4cbd9f,0x3de7be50,0xbe4c3d9f
.long 0xbe133e50,0x3e13a42c,0xbe133e50,0x3e13a649,0xbe2d3e50,0x3d223d9f,0x3e2dbe50,0xbd22bd9f,0xbe403e50,0xbd9f3e13,0xbe403e50,0xbd9f3e13,0xbe4c3e50,0xbe2d3e40,0x3e4cbe50,0x3e2dbe40
.long 0x3e503e50,0x3e503e50,0x3e503e50,0x3e503e50,0x3de73e13,0x3d223d9f,0xbde7be13,0xbd22bd9f,0xbd9f2365,0xbe40be13,0xbd9f248f,0xbe40be13,0xbe4cbe13,0xbde7be40,0x3e4c3e13,0x3de73e40
.long 0xbe13be50,0x3e13a42c,0xbe13be50,0x3e13a60f,0x3d22be13,0x3e2d3e40,0xbd223e13,0xbe2dbe40,0x3e40a42c,0xbd9f3e13,0x3e40a61e,0xbd9f3e13,0x3e2d3e13,0xbe4cbd9f,0xbe2dbe13,0x3e4c3d9f
.long 0x248f3e50,0xa4c9be50,0xa4e63e50,0xa63abe50,0xbe2d3e13,0x3e4cbd9f,0x3e2dbe13,0xbe4c3d9f,0xbe40248f,0x3d9f3e13,0xbe40a466,0x3d9f3e13,0xbd22be13,0xbe2d3e40,0x3d223e13,0x3e2dbe40
.long 0x3e13be50,0xbe132501,0x3e13be50,0xbe1326d7,0x3e4cbe13,0x3de7be40,0xbe4c3e13,0xbde73e40,0x3d9fa4c9,0x3e40be13,0x3d9fa665,0x3e40be13,0xbde73e13,0xbd223d9f,0x3de7be13,0x3d22bd9f
.long 0x3e503e50,0x3e503e50,0x3e503e50,0x3e503e50,0xbd222365,0xbde7bd9f,0x3d22a42c,0x3de73d9f,0xbe40be50,0xbd9fbe13,0xbe40be50,0xbd9fbe13,0x3de7a42c,0x3e4c3e40,0xbde72501,0xbe4cbe40
.long 0x3e133e50,0xbe13248f,0x3e133e50,0xbe13a566,0xbe2d248f,0xbd22be40,0x3e2da61e,0x3d223e40,0xbd9fbe50,0x3e403e13,0xbd9fbe50,0x3e403e13,0x3e4ca4c9,0xbe2d3d9f,0xbe4ca4e6,0x3e2dbd9f
.long 0x25013e50,0xa60fbe50,0xa4663e50,0xa649be50,0xbe4c2501,0x3e2d3d9f,0x3e4ca649,0xbe2dbd9f,0x3d9fbe50,0xbe403e13,0x3d9fbe50,0xbe403e13,0x3e2da60f,0x3d22be40,0xbe2d2465,0xbd223e40
.long 0xbe133e50,0x3e13a61e,0xbe133e50,0x3e13262c,0xbde7a566,0xbe4c3e40,0x3de7a674,0x3e4cbe40,0x3e40be50,0x3d9fbe13,0x3e40be50,0x3d9fbe13,0x3d22a61e,0x3de7bd9f,0xbd222565,0xbde73d9f
.long 0x3e503e50,0x3e503e50,0x3e503e50,0x3e503e50,0xbe2dbe13,0xbe4cbe40,0x3e2d3e13,0x3e4c3e40,0x3d9fa42c,0x3e403e13,0x3d9fa4c9,0x3e403e13,0x3d223e13,0xbe2dbd9f,0xbd22be13,0x3e2d3d9f
.long 0xbe13be50,0x3e13a4c9,0xbe13be50,0x3e13a61e,0x3e4c3e13,0xbde73d9f,0xbe4cbe13,0x3de7bd9f,0xbe402501,0x3d9fbe13,0xbe40a4e6,0x3d9fbe13,0x3de7be13,0xbd223e40,0xbde73e13,0x3d22be40
.long 0xa5663e50,0xa61ebe50,0xa0143e50,0xa657be50,0xbde7be13,0x3d223e40,0x3de73e13,0xbd22be40,0x3e40a61e,0xbd9fbe13,0x3e40a665,0xbd9fbe13,0xbe4c3e13,0x3de73d9f,0x3e4cbe13,0xbde7bd9f
.long 0x3e13be50,0xbe13a4e6,0x3e13be50,0xbe13275e,0xbd223e13,0x3e2dbd9f,0x3d22be13,0xbe2d3d9f,0xbd9fa4e6,0xbe403e13,0xbd9f26f4,0xbe403e13,0x3e2dbe13,0x3e4cbe40,0xbe2d3e13,0xbe4c3e40
.long 0xbe503e50,0xbe503e50,0xbe503e50,0xbe503e50,0xbd228000,0xbde7bd9f,0x3d22a3e5,0x3de73d9f,0xbd9f8000,0xbe40be13,0xbd9f2465,0xbe40be13,0xbde78000,0xbe4cbe40,0x3de7a4ac,0x3e4c3e40
.long 0xbe138000,0xbe13be50,0xbe1324e5,0xbe13be50,0xbe2d8000,0xbd22be40,0x3e2da50f,0x3d223e40,0xbe408000,0x3d9fbe13,0xbe40252c,0x3d9fbe13,0xbe4c8000,0x3e2dbd9f,0x3e4ca549,0xbe2d3d9f
.long 0xbe508000,0x3e50a3e5,0xbe502565,0x3e50a581,0xbe4c8000,0x3e2d3d9f,0x3e4ca581,0xbe2dbd9f,0xbe408000,0x3d9f3e13,0xbe40258f,0x3d9f3e13,0xbe2d8000,0xbd223e40,0x3e2da68f,0x3d22be40
.long 0xbe138000,0xbe133e50,0xbe1325ac,0xbe133e50,0xbde78000,0xbe4c3e40,0x3de725e6,0x3e4cbe40,0xbd9f8000,0xbe403e13,0xbd9f25c9,0xbe403e13,0xbd228000,0xbde73d9f,0x3d22a69e,0x3de7bd9f
.long 0xbe503e50,0xbe503e50,0xbe503e50,0xbe503e50,0xbe2dbe13,0xbe4cbe40,0x3e2d3e13,0x3e4c3e40,0xbe40be50,0xbd9fbe13,0xbe40be50,0xbd9fbe13,0xbd22be13,0x3e2d3d9f,0x3d223e13,0xbe2dbd9f
.long 0x3e13a3e5,0x3e133e50,0x3e13a50f,0x3e133e50,0x3e4c3e13,0xbde73d9f,0xbe4cbe13,0x3de7bd9f,0x3d9f3e50,0xbe40be13,0x3d9f3e50,0xbe40be13,0xbde73e13,0x3d22be40,0x3de7be13,0xbd223e40
.long 0xbe502465,0x3e50a4ac,0xbe50258f,0x3e50a68f,0xbde7be13,0x3d223e40,0x3de73e13,0xbd22be40,0x3d9fbe50,0xbe403e13,0x3d9fbe50,0xbe403e13,0x3e4cbe13,0xbde7bd9f,0xbe4c3e13,0x3de73d9f
.long 0x3e13a4ac,0x3e13be50,0x3e13a69e,0x3e13be50,0xbd223e13,0x3e2dbd9f,0x3d22be13,0xbe2d3d9f,0xbe403e50,0xbd9f3e13,0xbe403e50,0xbd9f3e13,0xbe2d3e13,0xbe4c3e40,0x3e2dbe13,0x3e4cbe40
.long 0xbe503e50,0xbe503e50,0xbe503e50,0xbe503e50,0xbe4cbe50,0xbe2dbe40,0x3e4c3e50,0x3e2d3e40,0x3d9fa3e5,0x3e403e13,0x3d9fa4ac,0x3e403e13,0x3e2d3e50,0xbd223d9f,0xbe2dbe50,0x3d22bd9f
.long 0xbe132465,0xbe13be50,0xbe13252c,0xbe13be50,0xbde7be50,0x3e4c3d9f,0x3de73e50,0xbe4cbd9f,0x3e40a4ac,0xbd9f3e13,0x3e40a581,0xbd9f3e13,0x3d223e50,0xbde7be40,0xbd22be50,0x3de73e40
.long 0xbe5024e5,0x3e50a50f,0xbe5025ac,0x3e5025e6,0x3d22be50,0xbde73e40,0xbd223e50,0x3de7be40,0x3e40a50f,0xbd9fbe13,0x3e40a69e,0xbd9fbe13,0xbde73e50,0x3e4cbd9f,0x3de7be50,0xbe4c3d9f
.long 0xbe13252c,0xbe133e50,0xbe132601,0xbe133e50,0x3e2dbe50,0xbd22bd9f,0xbe2d3e50,0x3d223d9f,0x3d9fa549,0x3e40be13,0x3d9f2566,0x3e40be13,0xbe4c3e50,0xbe2d3e40,0x3e4cbe50,0x3e2dbe40
.long 0xbe503e50,0xbe503e50,0xbe503e50,0xbe503e50,0xbde7be13,0xbd22bd9f,0x3de73e13,0x3d223d9f,0x3e403e50,0x3d9f3e13,0x3e403e50,0x3d9f3e13,0xbe4cbe13,0xbde7be40,0x3e4c3e13,0x3de73e40
.long 0x3e13a4ac,0x3e133e50,0x3e13a549,0x3e133e50,0xbd223e13,0xbe2dbe40,0x3d22be13,0x3e2d3e40,0xbd9fbe50,0x3e403e13,0xbd9fbe50,0x3e403e13,0x3e2d3e13,0xbe4cbd9f,0xbe2dbe13,0x3e4c3d9f
.long 0xbe50252c,0x3e50a549,0xbe5025c9,0x3e50a69e,0x3e2dbe13,0xbe4c3d9f,0xbe2d3e13,0x3e4cbd9f,0xbd9f3e50,0x3e40be13,0xbd9f3e50,0x3e40be13,0xbd22be13,0xbe2d3e40,0x3d223e13,0x3e2dbe40
.long 0x3e13a581,0x3e13be50,0x3e132566,0x3e13be50,0xbe4c3e13,0xbde73e40,0x3e4cbe13,0x3de7be40,0x3e40be50,0x3d9fbe13,0x3e40be50,0x3d9fbe13,0xbde73e13,0xbd223d9f,0x3de7be13,0x3d22bd9f
.long 0x3f8b1a3f,0x3f8b1a3f,0x3f8b1a3f,0x3f8b1a3f,0x3f8b1a3f,0x3f8b1790,0x3f8b0f85,0x3f8b021e,0x3f8b1a3f,0x3f8b0f85,0x3f8aef5a,0x3f8ab9c2,0x3f8b1a3f,0x3f8b021e,0x3f8ab9c2,0x3f8a4145
.long 0x3f8b1a3f,0x3f8aef5a,0x3f8a6ec6,0x3f8998d2,0x3f8b1a3f,0x3f8ad73b,0x3f8a0e71,0x3f88c0a1,0x3f8b1a3f,0x3f8ab9c2,0x3f8998d2,0x3f87b8fe,0x3f8b1a3f,0x3f8a96f0,0x3f890dfb,0x3f868245
.long 0x3f8b1a3f,0x3f8a6ec6,0x3f886e01,0x3f851ce1,0x3f8b1a3f,0x3f8a4145,0x3f87b8fe,0x3f83894f,0x3f8b1a3f,0x3f8a0e71,0x3f86ef0d,0x3f81c81a,0x3f8b1a3f,0x3f89d649,0x3f86104d,0x3f7fb3bd
.long 0x3f8b1a3f,0x3f8998d2,0x3f851ce1,0x3f7b7e90,0x3f8b1a3f,0x3f89560c,0x3f8414ef,0x3f76f221,0x3f8b1a3f,0x3f890dfb,0x3f82f89e,0x3f721006,0x3f8b1a3f,0x3f88c0a1,0x3f81c81a,0x3f6cd9ef
.long 0x3f8b1a3f,0x3f8b1a3f,0x3f8b1a3f,0x3f8b1a3f,0x3f8aef5a,0x3f8ad73b,0x3f8ab9c2,0x3f8a96f0,0x3f8a6ec6,0x3f8a0e71,0x3f8998d2,0x3f890dfb,0x3f8998d2,0x3f88c0a1,0x3f87b8fe,0x3f868245
.long 0x3f886e01,0x3f86ef0d,0x3f851ce1,0x3f82f89e,0x3f86ef0d,0x3f849b76,0x3f81c81a,0x3f7cef64,0x3f851ce1,0x3f81c81a,0x3f7b7e90,0x3f721006,0x3f82f89e,0x3f7cef64,0x3f721006,0x3f6567a8
.long 0x3f808394,0x3f755ade,0x3f6751ad,0x3f570e2f,0x3f7b7e90,0x3f6cd9ef,0x3f5b526b,0x3f471eb3,0x3f755ade,0x3f6374cb,0x3f4e22e7,0x3f35b74a,0x3f6e9fda,0x3f59347d,0x3f3fd56b,0x3f22f8d0
.long 0x3f6751ad,0x3f4e22e7,0x3f307dcd,0x3f0f06a6,0x3f5f74d6,0x3f424ab3,0x3f203158,0x3ef40cee,0x3f570e2f,0x3f35b74a,0x3f0f06a6,0x3ec83fcd,0x3f4e22e7,0x3f2874cb,0x3efa2b14,0x3e9af89e
.long 0x3f8b1a3f,0x3f8b1a3f,0x3f8b1a3f,0x3f8b1a3f,0x3f8a6ec6,0x3f8a4145,0x3f8a0e71,0x3f89d649,0x3f886e01,0x3f87b8fe,0x3f86ef0d,0x3f86104d,0x3f851ce1,0x3f83894f,0x3f81c81a,0x3f7fb3bd
.long 0x3f808394,0x3f7b7e90,0x3f755ade,0x3f6e9fda,0x3f755ade,0x3f6cd9ef,0x3f6374cb,0x3f59347d,0x3f6751ad,0x3f5b526b,0x3f4e22e7,0x3f3fd56b,0x3f570e2f,0x3f471eb3,0x3f35b74a,0x3f22f8d0
.long 0x3f44b87e,0x3f307dcd,0x3f1a8ffc,0x3f03251b,0x3f307dcd,0x3f17b650,0x3efa2b14,0x3ec1dd19,0x3f1a8ffc,0x3efa2b14,0x3ebb72ec,0x3e73d1fe,0x3f03251b,0x3ec1dd19,0x3e73d1fe,0x3dbef437
.long 0x3ed4edce,0x3e873256,0x3dda26a2,0xbd5a69fb,0x3ea1846f,0x3e15c39e,0xbcda7ad4,0xbe4bb0c3,0x3e5919b7,0x3cda7ad4,0xbe2348de,0xbeae8923,0x3dda26a2,0xbdbef437,0xbe9466d4,0xbef40cee
.long 0x3f8b1a3f,0x3f8b1a3f,0x3f8b1a3f,0x3f8b1a3f,0x3f8998d2,0x3f89560c,0x3f890dfb,0x3f88c0a1,0x3f851ce1,0x3f8414ef,0x3f82f89e,0x3f81c81a,0x3f7b7e90,0x3f76f221,0x3f721006,0x3f6cd9ef
.long 0x3f6751ad,0x3f5f74d6,0x3f570e2f,0x3f4e22e7,0x3f4e22e7,0x3f424ab3,0x3f35b74a,0x3f2874cb,0x3f307dcd,0x3f203158,0x3f0f06a6,0x3efa2b14,0x3f0f06a6,0x3ef40cee,0x3ec83fcd,0x3e9af89e
.long 0x3ed4edce,0x3ea1846f,0x3e5919b7,0x3dda26a2,0x3e873256,0x3e15c39e,0x3cda7ad4,0xbdbef437,0x3dda26a2,0xbcda7ad4,0xbe2348de,0xbe9466d4,0xbd5a69fb,0xbe4bb0c3,0xbeae8923,0xbef40cee
.long 0xbe5919b7,0xbebb72ec,0xbf03251b,0xbf25b9ff,0xbebb72ec,0xbf06255d,0xbf2b2919,0xbf4bd3ff,0xbf03251b,0xbf2b2919,0xbf4e22e7,0xbf6b0ae3,0xbf25b9ff,0xbf4bd3ff,0xbf6b0ae3,0xbf812854
.long 0x80000000,0x80000000,0x80000000,0x80000000,0x80000000,0xbc5a7f0a,0xbcda7ad4,0xbd23d6db,0x80000000,0xbcda7ad4,0xbd5a69fb,0xbda3ba6f,0x80000000,0xbd23d6db,0xbda3ba6f,0xbdf550a3
.long 0x80000000,0xbd5a69fb,0xbdda26a2,0xbe2348de,0x80000000,0xbd887a58,0xbe083898,0xbe4bb0c3,0x80000000,0xbda3ba6f,0xbe2348de,0xbe73d1fe,0x80000000,0xbdbef437,0xbe3e3ff5,0xbe8dcf51
.long 0x80000000,0xbdda26a2,0xbe5919b7,0xbea1846f,0x80000000,0xbdf550a3,0xbe73d1fe,0xbeb50184,0x80000000,0xbe083898,0xbe873256,0xbec83fcd,0x80000000,0xbe15c39e,0xbe9466d4,0xbedb389d
.long 0x80000000,0xbe2348de,0xbea1846f,0xbeede55e,0x80000000,0xbe30c7d2,0xbeae8923,0xbf001fcb,0x80000000,0xbe3e3ff5,0xbebb72ec,0xbf092074,0x80000000,0xbe4bb0c3,0xbec83fcd,0xbf11f189
.long 0x80000000,0x80000000,0x80000000,0x80000000,0xbd5a69fb,0xbd887a58,0xbda3ba6f,0xbdbef437,0xbdda26a2,0xbe083898,0xbe2348de,0xbe3e3ff5,0xbe2348de,0xbe4bb0c3,0xbe73d1fe,0xbe8dcf51
.long 0xbe5919b7,0xbe873256,0xbea1846f,0xbebb72ec,0xbe873256,0xbea80a06,0xbec83fcd,0xbee7b4a3,0xbea1846f,0xbec83fcd,0xbeede55e,0xbf092074,0xbebb72ec,0xbee7b4a3,0xbf092074,0xbf1d63b3
.long 0xbed4edce,0xbf03251b,0xbf1a8ffc,0xbf307dcd,0xbeede55e,0xbf11f189,0xbf2b2919,0xbf424ab3,0xbf03251b,0xbf203158,0xbf3ad4c2,0xbf52a8c9,0xbf0f06a6,0xbf2dd6cd,0xbf497d3c,0xbf617929
.long 0xbf1a8ffc,0xbf3ad4c2,0xbf570e2f,0xbf6e9fda,0xbf25b9ff,0xbf471eb3,0xbf6374cb,0xbf7a0409,0xbf307dcd,0xbf52a8c9,0xbf6e9fda,0xbf81c81a,0xbf3ad4c2,0xbf5d67e5,0xbf787fe0,0xbf85992b
.long 0x80000000,0x80000000,0x80000000,0x80000000,0xbdda26a2,0xbdf550a3,0xbe083898,0xbe15c39e,0xbe5919b7,0xbe73d1fe,0xbe873256,0xbe9466d4,0xbea1846f,0xbeb50184,0xbec83fcd,0xbedb389d
.long 0xbed4edce,0xbeede55e,0xbf03251b,0xbf0f06a6,0xbf03251b,0xbf11f189,0xbf203158,0xbf2dd6cd,0xbf1a8ffc,0xbf2b2919,0xbf3ad4c2,0xbf497d3c,0xbf307dcd,0xbf424ab3,0xbf52a8c9,0xbf617929
.long 0xbf44b87e,0xbf570e2f,0xbf6751ad,0xbf755ade,0xbf570e2f,0xbf6932c6,0xbf787fe0,0xbf8262df,0xbf6751ad,0xbf787fe0,0xbf82f89e,0xbf87b8fe,0xbf755ade,0xbf8262df,0xbf87b8fe,0xbf8a96f0
.long 0xbf808394,0xbf86ef0d,0xbf8a6ec6,0xbf8aef5a,0xbf851ce1,0xbf89d649,0xbf8b0f85,0xbf88c0a1,0xbf886e01,0xbf8b0f85,0xbf8998d2,0xbf8414ef,0xbf8a6ec6,0xbf8a96f0,0xbf86104d,0xbf7a0409
.long 0x80000000,0x80000000,0x80000000,0x80000000,0xbe2348de,0xbe30c7d2,0xbe3e3ff5,0xbe4bb0c3,0xbea1846f,0xbeae8923,0xbebb72ec,0xbec83fcd,0xbeede55e,0xbf001fcb,0xbf092074,0xbf11f189
.long 0xbf1a8ffc,0xbf25b9ff,0xbf307dcd,0xbf3ad4c2,0xbf3ad4c2,0xbf471eb3,0xbf52a8c9,0xbf5d67e5,0xbf570e2f,0xbf6374cb,0xbf6e9fda,0xbf787fe0,0xbf6e9fda,0xbf7a0409,0xbf81c81a,0xbf85992b
.long 0xbf808394,0xbf851ce1,0xbf886e01,0xbf8a6ec6,0xbf86ef0d,0xbf89d649,0xbf8b0f85,0xbf8a96f0,0xbf8a6ec6,0xbf8b0f85,0xbf8998d2,0xbf86104d,0xbf8aef5a,0xbf88c0a1,0xbf8414ef,0xbf7a0409
.long 0xbf886e01,0xbf82f89e,0xbf755ade,0xbf5f74d6,0xbf82f89e,0xbf73ba24,0xbf5b526b,0xbf3d58bd,0xbf755ade,0xbf5b526b,0xbf3ad4c2,0xbf14d6cb,0xbf5f74d6,0xbf3d58bd,0xbf14d6cb,0xbece9ac9
.long 0x3e913e91,0x3e913e91,0x0,0x0,0x3e863e91,0x3dde3e4d,0x3dde0000,0x3e863e4d,0x3e4d3e91,0xbe4d23a0,0x3e4d0000,0x3e4d3e91,0x3dde3e91,0xbe86be4d,0x3e860000,0xbdde3e4d
.long 0x23a03e91,0xa470be91,0x3e910000,0xbe912420,0xbdde3e91,0x3e86be4d,0x3e860000,0xbddebe4d,0xbe4d3e91,0x3e4da470,0x3e4d0000,0x3e4dbe91,0xbe863e91,0xbdde3e4d,0x3dde0000,0x3e86be4d
.long 0xbe913e91,0xbe913e91,0x24200000,0x24f0a4a0,0xbe863e91,0xbdde3e4d,0xbdde0000,0xbe863e4d,0xbe4d3e91,0x3e4d24c8,0xbe4d0000,0xbe4d3e91,0xbdde3e91,0x3e86be4d,0xbe860000,0x3dde3e4d
.long 0xa4703e91,0x2534be91,0xbe910000,0x3e9124f0,0x3dde3e91,0xbe86be4d,0xbe860000,0x3ddebe4d,0x3e4d3e91,0xbe4da50c,0xbe4d0000,0xbe4dbe91,0x3e863e91,0x3dde3e4d,0xbdde0000,0xbe86be4d
.long 0x3e913e91,0x3e913e91,0x0,0x0,0xbdde23a0,0xbe86be4d,0x3e863e91,0x3dde3e4d,0xbe4dbe91,0x3e4da470,0xbe4d2420,0xbe4dbe91,0x3e86a470,0xbdde3e4d,0xbddebe91,0x3e863e4d
.long 0x24c83e91,0xa50cbe91,0x3e91a4a0,0xbe9124f0,0xbe8624c8,0x3dde3e4d,0xbdde3e91,0x3e86be4d,0x3e4dbe91,0xbe4d2534,0xbe4d24f0,0xbe4d3e91,0x3ddea50c,0x3e86be4d,0x3e86be91,0x3ddebe4d
.long 0xbe913e91,0xbe913e91,0x2548a520,0x258ca570,0x3dde2534,0x3e86be4d,0xbe863e91,0xbdde3e4d,0x3e4dbe91,0xbe4da65c,0x3e4d2548,0x3e4dbe91,0xbe86a648,0x3dde3e4d,0x3ddebe91,0xbe863e4d
.long 0xa65c3e91,0xa520be91,0xbe91a570,0x3e9125b4,0x3e86a5a0,0xbdde3e4d,0x3dde3e91,0xbe86be4d,0xbe4dbe91,0x3e4da520,0x3e4d258c,0x3e4d3e91,0xbddea65c,0xbe86be4d,0xbe86be91,0xbddebe4d
.long 0x3e913e91,0x3e913e91,0x0,0x0,0xbe86be91,0xbddebe4d,0xbdde2420,0xbe86be4d,0x3e4d3e91,0xbe4d24c8,0x3e4da4a0,0x3e4d3e91,0xbddebe91,0x3e863e4d,0xbe8624f0,0x3ddebe4d
.long 0x25343e91,0xa648be91,0x3e91a520,0xbe912548,0x3ddebe91,0xbe863e4d,0xbe862548,0x3dde3e4d,0xbe4d3e91,0x3e4da65c,0x3e4da570,0x3e4dbe91,0x3e86be91,0x3ddebe4d,0xbdde258c,0xbe863e4d
.long 0xbe913e91,0xbe913e91,0x25b4a5a0,0x26c8a5c8,0x3e86be91,0x3ddebe4d,0x3dde25b4,0x3e86be4d,0xbe4d3e91,0x3e4da4a0,0xbe4da5c8,0xbe4d3e91,0x3ddebe91,0xbe863e4d,0x3e8626c8,0xbddebe4d
.long 0xa68c3e91,0x2716be91,0xbe91a5f0,0x3e9126dc,0xbddebe91,0x3e863e4d,0x3e86a620,0xbdde3e4d,0x3e4d3e91,0xbe4da6a0,0xbe4da60c,0xbe4dbe91,0xbe86be91,0xbddebe4d,0x3dde26dc,0x3e863e4d
.long 0x3e913e91,0x3e913e91,0x0,0x0,0x3ddea470,0x3e863e4d,0xbe86be91,0xbddebe4d,0xbe4dbe91,0x3e4da50c,0xbe4d24f0,0xbe4dbe91,0xbe862534,0x3ddebe4d,0x3dde3e91,0xbe86be4d
.long 0xa5a03e91,0xa65cbe91,0x3e91a570,0xbe91258c,0x3e86a65c,0xbddebe4d,0x3ddebe91,0xbe863e4d,0x3e4dbe91,0xbe4da520,0xbe4d25b4,0xbe4d3e91,0xbddea520,0xbe863e4d,0xbe863e91,0xbdde3e4d
.long 0xbe913e91,0xbe913e91,0xa620a5f0,0x26dca60c,0xbddea68c,0xbe863e4d,0x3e86be91,0x3ddebe4d,0x3e4dbe91,0xbe4da6a0,0x3e4d26dc,0x3e4dbe91,0x3e8624a0,0xbddebe4d,0xbdde3e91,0x3e86be4d
.long 0x26703e91,0x279bbe91,0xbe91a634,0x3e91a5a0,0xbe86a6aa,0x3ddebe4d,0xbddebe91,0x3e863e4d,0xbe4dbe91,0x3e4d272a,0x3e4da5a0,0x3e4d3e91,0x3dde25a0,0x3e863e4d,0x3e863e91,0x3dde3e4d
.long 0x80008000,0x80008000,0x3e913e91,0x3e913e91,0xbdde8000,0xbe86be4d,0x3e863e91,0x3dde3e4d,0xbe4d8000,0xbe4dbe91,0x3e4d3e91,0xbe4d23a0,0xbe868000,0x3ddebe4d,0x3dde3e91,0xbe86be4d
.long 0xbe918000,0x3e91a420,0x23a03e91,0xa470be91,0xbe868000,0x3dde3e4d,0xbdde3e91,0x3e86be4d,0xbe4d8000,0xbe4d3e91,0xbe4d3e91,0x3e4da470,0xbdde8000,0xbe863e4d,0xbe863e91,0xbdde3e4d
.long 0x24200000,0x24f0a4a0,0x3e91be91,0x3e91be91,0xbdde0000,0xbe863e4d,0x3e86be91,0x3ddebe4d,0xbe4d0000,0xbe4d3e91,0x3e4dbe91,0xbe4da4c8,0xbe860000,0x3dde3e4d,0x3ddebe91,0xbe863e4d
.long 0xbe910000,0x3e9124f0,0x2470be91,0xa5343e91,0xbe860000,0x3ddebe4d,0xbddebe91,0x3e863e4d,0xbe4d0000,0xbe4dbe91,0xbe4dbe91,0x3e4d250c,0xbdde0000,0xbe86be4d,0xbe86be91,0xbddebe4d
.long 0x80008000,0x80008000,0x3e913e91,0x3e913e91,0xbe86be91,0xbddebe4d,0xbdde23a0,0xbe86be4d,0x3e4da420,0x3e4d3e91,0xbe4dbe91,0x3e4da470,0x3dde3e91,0xbe86be4d,0x3e86a470,0xbdde3e4d
.long 0xbe9124a0,0x3e91a4f0,0x24c83e91,0xa50cbe91,0x3ddebe91,0xbe863e4d,0xbe8624c8,0x3dde3e4d,0x3e4da4f0,0x3e4dbe91,0x3e4dbe91,0xbe4d2534,0xbe863e91,0xbdde3e4d,0x3ddea50c,0x3e86be4d
.long 0x2548a520,0x258ca570,0x3e91be91,0x3e91be91,0xbe863e91,0xbdde3e4d,0xbddea534,0xbe863e4d,0x3e4d2548,0x3e4dbe91,0xbe4d3e91,0x3e4d265c,0x3ddebe91,0xbe863e4d,0x3e862648,0xbddebe4d
.long 0xbe91a570,0x3e9125b4,0x265cbe91,0x25203e91,0x3dde3e91,0xbe86be4d,0xbe8625a0,0x3ddebe4d,0x3e4d258c,0x3e4d3e91,0x3e4d3e91,0xbe4d2520,0xbe86be91,0xbddebe4d,0x3dde265c,0x3e863e4d
.long 0x80008000,0x80008000,0x3e913e91,0x3e913e91,0x3ddea420,0x3e863e4d,0xbe86be91,0xbddebe4d,0xbe4d24a0,0xbe4dbe91,0x3e4d3e91,0xbe4d24c8,0x3e86a4f0,0xbdde3e4d,0xbddebe91,0x3e863e4d
.long 0xbe912520,0x3e91a548,0x25343e91,0xa648be91,0x3e86a548,0xbddebe4d,0x3ddebe91,0xbe863e4d,0xbe4d2570,0xbe4d3e91,0xbe4d3e91,0x3e4da65c,0x3ddea58c,0x3e86be4d,0x3e86be91,0x3ddebe4d
.long 0x25b4a5a0,0x26c8a5c8,0x3e91be91,0x3e91be91,0x3dde25b4,0x3e86be4d,0xbe863e91,0xbdde3e4d,0xbe4da5c8,0xbe4d3e91,0x3e4dbe91,0xbe4d24a0,0x3e8626c8,0xbddebe4d,0xbdde3e91,0x3e86be4d
.long 0xbe91a5f0,0x3e9126dc,0x268cbe91,0xa7163e91,0x3e86a620,0xbdde3e4d,0x3dde3e91,0xbe86be4d,0xbe4da60c,0xbe4dbe91,0xbe4dbe91,0x3e4d26a0,0x3dde26dc,0x3e863e4d,0x3e863e91,0x3dde3e4d
.long 0x80008000,0x80008000,0x3e913e91,0x3e913e91,0x3e863e91,0x3dde3e4d,0x3ddea470,0x3e863e4d,0x3e4da4f0,0x3e4d3e91,0xbe4dbe91,0x3e4da50c,0xbddebe91,0x3e863e4d,0xbe862534,0x3ddebe4d
.long 0xbe912570,0x3e91a58c,0xa5a03e91,0xa65cbe91,0xbdde3e91,0x3e86be4d,0x3e86a65c,0xbddebe4d,0x3e4da5b4,0x3e4dbe91,0x3e4dbe91,0xbe4da520,0x3e86be91,0x3ddebe4d,0xbddea520,0xbe863e4d
.long 0xa620a5f0,0x26dca60c,0x3e91be91,0x3e91be91,0x3e86be91,0x3ddebe4d,0x3dde268c,0x3e86be4d,0x3e4d26dc,0x3e4dbe91,0xbe4d3e91,0x3e4d26a0,0xbdde3e91,0x3e86be4d,0xbe86a4a0,0x3dde3e4d
.long 0xbe91a634,0x3e91a5a0,0xa670be91,0xa79b3e91,0xbddebe91,0x3e863e4d,0x3e8626aa,0xbdde3e4d,0x3e4da5a0,0x3e4d3e91,0x3e4d3e91,0xbe4da72a,0x3e863e91,0x3dde3e4d,0xbddea5a0,0xbe86be4d
.long 0xbef8bdaa,0xbef8bdaa,0x0,0x0,0x0,0x0,0xbdde0000,0xbe86be4d,0x0,0x0,0xbe4d0000,0xbe4dbe91,0x0,0x0,0xbe860000,0x3ddebe4d
.long 0x0,0x0,0xbe910000,0x3e91a420,0x0,0x0,0xbe860000,0x3dde3e4d,0x0,0x0,0xbe4d0000,0xbe4d3e91,0x0,0x0,0xbdde0000,0xbe863e4d
.long 0x3e91be91,0x3e91be91,0x3e8e3e91,0x3e713e86,0x3e86be91,0x3ddebe4d,0x3eb03e91,0x3e53bdbc,0x3e4dbe91,0xbe4da4c8,0x3eb73e91,0xbd9fbec8,0x3ddebe91,0xbe863e4d,0x3ea23e91,0xbe88beec
.long 0x2470be91,0xa5343e91,0x3e693e91,0xbe01be86,0xbddebe91,0x3e863e4d,0x3dd63e91,0x3e2d3dbc,0xbe4dbe91,0x3e4d250c,0xbd113e91,0x3e833ec8,0xbe86be91,0xbddebe4d,0xbe2d3e91,0x3cd73eec
.long 0xbef8bdaa,0xbef8bdaa,0x0,0x0,0x0,0x0,0xbe86be91,0xbddebe4d,0x0,0x0,0x3e4da420,0x3e4d3e91,0x0,0x0,0x3dde3e91,0xbe86be4d
.long 0x0,0x0,0xbe9124a0,0x3e91a4f0,0x0,0x0,0x3ddebe91,0xbe863e4d,0x0,0x0,0x3e4da4f0,0x3e4dbe91,0x0,0x0,0xbe863e91,0xbdde3e4d
.long 0x3e91be91,0x3e91be91,0x3e213e4d,0x3d623dde,0xbddea534,0xbe863e4d,0xbc84bef8,0xbd48beec,0xbe4d3e91,0x3e4d265c,0xbe14be4d,0x3d113f0b,0x3e862648,0xbddebe4d,0x3e023ef8,0xbc84be9e
.long 0x265cbe91,0x25203e91,0x3d433e4d,0xbbb2bdde,0xbe8625a0,0x3ddebe4d,0xbe28bef8,0x3cd73eec,0x3e4d3e91,0xbe4d2520,0x3d9fbe4d,0xbd30bf0b,0x3dde265c,0x3e863e4d,0x3dd63ef8,0x3d5a3e9e
.long 0xbef8bdaa,0xbef8bdaa,0x0,0x0,0x0,0x0,0x3ddea420,0x3e863e4d,0x0,0x0,0xbe4d24a0,0xbe4dbe91,0x0,0x0,0x3e86a4f0,0xbdde3e4d
.long 0x0,0x0,0xbe912520,0x3e91a548,0x0,0x0,0x3e86a548,0xbddebe4d,0x0,0x0,0xbe4d2570,0xbe4d3e91,0x0,0x0,0x3ddea58c,0x3e86be4d
.long 0x3e91be91,0x3e91be91,0xbd6225aa,0xbe21bdde,0xbe863e91,0xbdde3e4d,0x3d48a5d2,0x3c843eec,0x3e4dbe91,0xbe4d24a0,0xbd1125fa,0x3e14bf0b,0xbdde3e91,0x3e86be4d,0x3c84a6d9,0xbe023e9e
.long 0x268cbe91,0xa7163e91,0x3bb22625,0xbd433dde,0x3dde3e91,0xbe86be4d,0xbcd7a520,0x3e28beec,0xbe4dbe91,0x3e4d26a0,0x3d302570,0xbd9f3f0b,0x3e863e91,0x3dde3e4d,0xbd5aa725,0xbdd6be9e
.long 0xbef8bdaa,0xbef8bdaa,0x0,0x0,0x0,0x0,0x3e863e91,0x3dde3e4d,0x0,0x0,0x3e4da4f0,0x3e4d3e91,0x0,0x0,0xbddebe91,0x3e863e4d
.long 0x0,0x0,0xbe912570,0x3e91a58c,0x0,0x0,0xbdde3e91,0x3e86be4d,0x0,0x0,0x3e4da5b4,0x3e4dbe91,0x0,0x0,0x3e86be91,0x3ddebe4d
.long 0x3e91be91,0x3e91be91,0xbe71be4d,0xbe8ebe86,0x3dde268c,0x3e86be4d,0xbe533ef8,0xbeb03dbc,0xbe4d3e91,0x3e4d26a0,0x3d9f3e4d,0xbeb73ec8,0xbe86a4a0,0x3dde3e4d,0x3e88bef8,0xbea23eec
.long 0xa670be91,0xa79b3e91,0x3e01be4d,0xbe693e86,0x3e8626aa,0xbdde3e4d,0xbe2d3ef8,0xbdd6bdbc,0x3e4d3e91,0xbe4da72a,0xbe833e4d,0x3d11bec8,0xbddea5a0,0xbe86be4d,0xbcd7bef8,0x3e2dbeec
.long 0x3e4d3e4d,0x3e4d3e4d,0xbe91be91,0xbe91be91,0x0,0x0,0xbe86be91,0xbddebe4d,0x0,0x0,0xbe4dbe91,0x3e4da3a0,0x0,0x0,0xbddebe91,0x3e863e4d
.long 0x0,0x0,0xa3a0be91,0x24703e91,0x0,0x0,0x3ddebe91,0xbe863e4d,0x0,0x0,0x3e4dbe91,0xbe4d2470,0x0,0x0,0x3e86be91,0x3ddebe4d
.long 0xa4200000,0xa4f024a0,0xbead3e91,0xbee23e33,0x3dde0000,0x3e86be4d,0xbed73e91,0xbec6bd7c,0x3e4d0000,0x3e4dbe91,0xbedf3e91,0x3e14be86,0x3e860000,0xbddebe4d,0xbec63e91,0x3effbe9e
.long 0x3e910000,0xbe91a4f0,0xbe8e3e91,0x3e71be33,0x3e860000,0xbdde3e4d,0xbe023e91,0xbea23d7c,0x3e4d0000,0x3e4d3e91,0x3d303e91,0xbef53e86,0x3dde0000,0x3e863e4d,0x3e533e91,0xbd483e9e
.long 0x3e4d3e4d,0x3e4d3e4d,0xbe91be91,0xbe91be91,0x0,0x0,0x3ddea3a0,0x3e863e4d,0x0,0x0,0x3e4d3e91,0xbe4d2470,0x0,0x0,0xbe862470,0x3ddebe4d
.long 0x0,0x0,0xa4c8be91,0x250c3e91,0x0,0x0,0x3e86a4c8,0xbddebe4d,0x0,0x0,0xbe4d3e91,0x3e4da534,0x0,0x0,0xbdde250c,0xbe863e4d
.long 0xa5482520,0xa58c2570,0xbf053daa,0xbf103cb0,0x3e86be91,0x3ddebe4d,0x3d5abe4d,0x3effbdbc,0xbe4da548,0xbe4d3e91,0x3ef5bdaa,0xbeb73dde,0xbdde3e91,0x3e86be4d,0xbed73e4d,0x3e28bd7c
.long 0x3e912570,0xbe91a5b4,0xbe213daa,0x3d62bcb0,0xbddebe91,0x3e863e4d,0x3f0abe4d,0xbe883dbc,0xbe4da58c,0xbe4dbe91,0xbe83bdaa,0x3edfbdde,0x3e863e91,0x3dde3e4d,0xbeb03e4d,0xbf0a3d7c
.long 0x3e4d3e4d,0x3e4d3e4d,0xbe91be91,0xbe91be91,0x0,0x0,0x3e863e91,0x3dde3e4d,0x0,0x0,0xbe4dbe91,0x3e4da4c8,0x0,0x0,0x3dde3e91,0xbe86be4d
.long 0x0,0x0,0xa534be91,0x26483e91,0x0,0x0,0xbdde3e91,0x3e86be4d,0x0,0x0,0x3e4dbe91,0xbe4d265c,0x0,0x0,0xbe863e91,0xbdde3e4d
.long 0xa5b425a0,0xa6c825c8,0xbf10b78e,0xbf053cb0,0xbddea5b4,0xbe863e4d,0x3eff378e,0x3d5abdbc,0x3e4d25c8,0x3e4dbe91,0xbeb7b78e,0x3ef53dde,0xbe86a6c8,0x3dde3e4d,0x3e28378e,0xbed7bd7c
.long 0x3e9125f0,0xbe91a6dc,0x3d62b78e,0xbe21bcb0,0xbe862620,0x3ddebe4d,0xbe88378e,0x3f0a3dbc,0x3e4d260c,0x3e4d3e91,0x3edfb78e,0xbe83bdde,0xbddea6dc,0xbe86be4d,0xbf0a378e,0xbeb03d7c
.long 0x3e4d3e4d,0x3e4d3e4d,0xbe91be91,0xbe91be91,0x0,0x0,0xbdde2470,0xbe86be4d,0x0,0x0,0x3e4d3e91,0xbe4d250c,0x0,0x0,0x3e86a534,0xbdde3e4d
.long 0x0,0x0,0x25a0be91,0x265c3e91,0x0,0x0,0xbe86265c,0x3dde3e4d,0x0,0x0,0xbe4d3e91,0x3e4d2520,0x0,0x0,0x3dde2520,0x3e86be4d
.long 0x262025f0,0xa6dc260c,0xbee23daa,0xbead3e33,0xbe863e91,0xbdde3e4d,0xbec6be4d,0xbed7bd7c,0xbe4da6dc,0xbe4d3e91,0x3e14bdaa,0xbedfbe86,0x3ddebe91,0xbe863e4d,0x3eff3e4d,0xbec6be9e
.long 0x3e912634,0xbe9125a0,0x3e713daa,0xbe8ebe33,0x3dde3e91,0xbe86be4d,0xbea2be4d,0xbe023d7c,0xbe4d25a0,0xbe4dbe91,0xbef5bdaa,0x3d303e86,0xbe86be91,0xbddebe4d,0xbd483e4d,0x3e533e9e
.long 0x3def3def,0x3def3def,0x3def3def,0x3def3def,0x3dee3def,0x3de53deb,0x3dd33ddd,0x3db93dc7,0x3deb3def,0x3dc73ddd,0x3d853da9,0x3cbb3d37,0x3de53def,0x3d983dc7,0x3c3c3d37,0xbd62bcbb
.long 0x3ddd3def,0x3d373da9,0xbd372304,0xbdddbda9,0x3dd33def,0x3c3c3d85,0xbdb9bd37,0xbde5bdeb,0x3dc73def,0xbcbb3d37,0xbdebbda9,0xbd85bddd,0x3db93def,0xbd623cbb,0xbde5bddd,0x3c3cbd85
.long 0x3da93def,0xbda92304,0xbda9bdef,0x3da9a3c6,0x3d983def,0xbdd3bcbb,0xbd0bbddd,0x3dee3d85,0x3d853def,0xbdebbd37,0x3cbbbda9,0x3dc73ddd,0x3d623def,0xbdeebd85,0x3d98bd37,0x3d0b3deb
.long 0x3d373def,0xbdddbda9,0x3ddda3c6,0xbd373da9,0x3d0b3def,0xbdb9bdc7,0x3dee3d37,0xbdd33cbb,0x3cbb3def,0xbd85bddd,0x3dc73da9,0xbdebbd37,0x3c3c3def,0xbd0bbdeb,0x3d623ddd,0xbd98bdc7
.long 0x3def3def,0x3def3def,0x3def3def,0x3def3def,0x3d983da9,0x3d623d85,0x3d0b3d37,0x3c3c3cbb,0xbcbb2304,0xbd85bd37,0xbdc7bda9,0xbdebbddd,0xbdd3bda9,0xbdeebdeb,0xbdb9bddd,0xbd0bbd85
.long 0xbdddbdef,0xbd37bda9,0x3d37a3c6,0x3ddd3da9,0xbd0bbda9,0x3d983cbb,0x3dee3ddd,0x3d623dc7,0x3d85a3c6,0x3deb3ddd,0x3cbb3da9,0xbdc7bd37,0x3dee3da9,0x3d0b3dc7,0xbdd3bd37,0xbd98bdeb
.long 0x3da93def,0xbda92304,0xbda9bdef,0x3da9a3c6,0xbc3c3da9,0xbde5bdc7,0x3d62bd37,0x3db93deb,0xbdc72304,0xbcbbbddd,0x3deb3da9,0xbd853d37,0xbde5bda9,0x3db9bcbb,0x3c3c3ddd,0xbdd3bdc7
.long 0xbd37bdef,0x3ddd3da9,0xbddd2304,0x3d37bda9,0x3d62bda9,0x3c3c3deb,0xbd98bddd,0x3de53d85,0x3deba3c6,0xbdc73d37,0x3d85bda9,0xbcbb3ddd,0x3db93da9,0xbdd3bd85,0x3de53d37,0xbdeebcbb
.long 0x3def3def,0x3def3def,0x3def3def,0x3def3def,0xbc3c2304,0xbd0bbcbb,0xbd62bd37,0xbd98bd85,0xbdebbdef,0xbdc7bddd,0xbd85bda9,0xbcbbbd37,0x3d0ba3c6,0x3db93d85,0x3dee3ddd,0x3dd33deb
.long 0x3ddd3def,0x3d373da9,0xbd372304,0xbdddbda9,0xbd622304,0xbdeebdc7,0xbd98bddd,0x3d0bbcbb,0xbdc7bdef,0x3cbbbd37,0x3deb3da9,0x3d853ddd,0x3d98a3c6,0x3dd33deb,0xbd0b3d37,0xbdeebdc7
.long 0x3da93def,0xbda92304,0xbda9bdef,0x3da9a3c6,0xbdb92304,0xbd62bdeb,0x3de53d37,0x3c3c3dc7,0xbd85bdef,0x3deb3d37,0xbcbb3da9,0xbdc7bddd,0x3dd3a3c6,0xbc3c3dc7,0xbdb9bddd,0x3de53cbb
.long 0x3d373def,0xbdddbda9,0x3ddda3c6,0xbd373da9,0xbde52304,0x3d98bd85,0xbc3c3ddd,0xbd62bdeb,0xbcbbbdef,0x3d853ddd,0xbdc7bda9,0x3deb3d37,0x3deea3c6,0xbde53cbb,0x3dd3bd37,0xbdb93d85
.long 0x3def3def,0x3def3def,0x3def3def,0x3def3def,0xbdb9bda9,0xbdd3bdc7,0xbde5bddd,0xbdeebdeb,0x3cbba3c6,0x3d853d37,0x3dc73da9,0x3deb3ddd,0x3d623da9,0xbc3c3cbb,0xbd98bd37,0xbde5bdc7
.long 0xbdddbdef,0xbd37bda9,0x3d37a3c6,0x3ddd3da9,0x3de53da9,0x3db93deb,0xbc3c3d37,0xbdd3bd85,0xbd852304,0xbdebbddd,0xbcbbbda9,0x3dc73d37,0xbc3cbda9,0x3de53d85,0x3d623ddd,0xbdb9bcbb
.long 0x3da93def,0xbda92304,0xbda9bdef,0x3da9a3c6,0xbdeebda9,0x3d0bbd85,0x3dd33ddd,0xbd983cbb,0x3dc7a3c6,0x3cbb3ddd,0xbdebbda9,0x3d85bd37,0xbd0b3da9,0xbd98bdeb,0x3dee3d37,0xbd623d85
.long 0xbd37bdef,0x3ddd3da9,0xbddd2304,0x3d37bda9,0x3dd33da9,0xbdeebcbb,0x3db9bd37,0xbd0b3dc7,0xbdeb2304,0x3dc7bd37,0xbd853da9,0x3cbbbddd,0x3d98bda9,0xbd623dc7,0x3d0bbddd,0xbc3c3deb
.long 0x0,0x0,0x0,0x0,0xbc3c0000,0xbd0bbcbb,0xbd62bd37,0xbd98bd85,0xbcbb0000,0xbd85bd37,0xbdc7bda9,0xbdebbddd,0xbd0b0000,0xbdb9bd85,0xbdeebddd,0xbdd3bdeb
.long 0xbd370000,0xbdddbda9,0xbdddbdef,0xbd37bda9,0xbd620000,0xbdeebdc7,0xbd98bddd,0x3d0bbcbb,0xbd850000,0xbdebbddd,0xbcbbbda9,0x3dc73d37,0xbd980000,0xbdd3bdeb,0x3d0bbd37,0x3dee3dc7
.long 0xbda90000,0xbda9bdef,0x3da9a384,0x3da93def,0xbdb90000,0xbd62bdeb,0x3de53d37,0x3c3c3dc7,0xbdc70000,0xbcbbbddd,0x3deb3da9,0xbd853d37,0xbdd30000,0x3c3cbdc7,0x3db93ddd,0xbde5bcbb
.long 0xbddd0000,0x3d37bda9,0x3d373def,0xbdddbda9,0xbde50000,0x3d98bd85,0xbc3c3ddd,0xbd62bdeb,0xbdeb0000,0x3dc7bd37,0xbd853da9,0x3cbbbddd,0xbdee0000,0x3de5bcbb,0xbdd33d37,0x3db9bd85
.long 0x0,0x0,0x0,0x0,0xbdb9bda9,0xbdd3bdc7,0xbde5bddd,0xbdeebdeb,0xbdebbdef,0xbdc7bddd,0xbd85bda9,0xbcbbbd37,0xbd62bda9,0x3c3cbcbb,0x3d983d37,0x3de53dc7
.long 0x3d37a384,0x3ddd3da9,0x3ddd3def,0x3d373da9,0x3de53da9,0x3db93deb,0xbc3c3d37,0xbdd3bd85,0x3dc73def,0xbcbb3d37,0xbdebbda9,0xbd85bddd,0x3c3c3da9,0xbde5bd85,0xbd62bddd,0x3db93cbb
.long 0xbda90000,0xbda9bdef,0x3da9a384,0x3da93def,0xbdeebda9,0x3d0bbd85,0x3dd33ddd,0xbd983cbb,0xbd85bdef,0x3deb3d37,0xbcbb3da9,0xbdc7bddd,0x3d0bbda9,0x3d983deb,0xbdeebd37,0x3d62bd85
.long 0x3ddda384,0xbd373da9,0xbd37bdef,0x3ddd3da9,0x3dd33da9,0xbdeebcbb,0x3db9bd37,0xbd0b3dc7,0x3cbb3def,0xbd85bddd,0x3dc73da9,0xbdebbd37,0xbd983da9,0x3d62bdc7,0xbd0b3ddd,0x3c3cbdeb
.long 0x0,0x0,0x0,0x0,0xbdeebdef,0xbde5bdeb,0xbdd3bddd,0xbdb9bdc7,0x3cbba384,0x3d853d37,0x3dc73da9,0x3deb3ddd,0x3de53def,0x3d983dc7,0x3c3c3d37,0xbd62bcbb
.long 0xbd370000,0xbdddbda9,0xbdddbdef,0xbd37bda9,0xbdd3bdef,0xbc3cbd85,0x3db93d37,0x3de53deb,0x3d85a384,0x3deb3ddd,0x3cbb3da9,0xbdc7bd37,0x3db93def,0xbd623cbb,0xbde5bddd,0x3c3cbd85
.long 0xbda90000,0xbda9bdef,0x3da9a384,0x3da93def,0xbd98bdef,0x3dd33cbb,0x3d0b3ddd,0xbdeebd85,0x3dc7a384,0x3cbb3ddd,0xbdebbda9,0x3d85bd37,0x3d623def,0xbdeebd85,0x3d98bd37,0x3d0b3deb
.long 0xbddd0000,0x3d37bda9,0x3d373def,0xbdddbda9,0xbd0bbdef,0x3db93dc7,0xbdeebd37,0x3dd3bcbb,0x3deba384,0xbdc73d37,0x3d85bda9,0xbcbb3ddd,0x3c3c3def,0xbd0bbdeb,0x3d623ddd,0xbd98bdc7
.long 0x0,0x0,0x0,0x0,0xbd98bda9,0xbd62bd85,0xbd0bbd37,0xbc3cbcbb,0x3deb3def,0x3dc73ddd,0x3d853da9,0x3cbb3d37,0xbdd3bda9,0xbdeebdeb,0xbdb9bddd,0xbd0bbd85
.long 0x3d37a384,0x3ddd3da9,0x3ddd3def,0x3d373da9,0x3d0b3da9,0xbd98bcbb,0xbdeebddd,0xbd62bdc7,0xbdc7bdef,0x3cbbbd37,0x3deb3da9,0x3d853ddd,0x3dee3da9,0x3d0b3dc7,0xbdd3bd37,0xbd98bdeb
.long 0xbda90000,0xbda9bdef,0x3da9a384,0x3da93def,0x3c3cbda9,0x3de53dc7,0xbd623d37,0xbdb9bdeb,0x3d853def,0xbdebbd37,0x3cbbbda9,0x3dc73ddd,0xbde5bda9,0x3db9bcbb,0x3c3c3ddd,0xbdd3bdc7
.long 0x3ddda384,0xbd373da9,0xbd37bdef,0x3ddd3da9,0xbd623da9,0xbc3cbdeb,0x3d983ddd,0xbde5bd85,0xbcbbbdef,0x3d853ddd,0xbdc7bda9,0x3deb3d37,0x3db93da9,0xbdd3bd85,0x3de53d37,0xbdeebcbb
.long 0x3e503e50,0x3e503e50,0x3e503e50,0x3e503e50,0x3e4c3e50,0x3e2d3e40,0xbe4cbe50,0xbe2dbe40,0x3e403e50,0x3d9f3e13,0x3e403e50,0x3d9f3e13,0x3e2d3e50,0xbd223d9f,0xbe2dbe50,0x3d22bd9f
.long 0x3e133e50,0xbe132365,0x3e133e50,0xbe132365,0x3de73e50,0xbe4cbd9f,0xbde7be50,0x3e4c3d9f,0x3d9f3e50,0xbe40be13,0x3d9f3e50,0xbe40be13,0x3d223e50,0xbde7be40,0xbd22be50,0x3de73e40
.long 0x23653e50,0xa42cbe50,0x23653e50,0xa42cbe50,0xbd223e50,0x3de7be40,0x3d22be50,0xbde73e40,0xbd9f3e50,0x3e40be13,0xbd9f3e50,0x3e40be13,0xbde73e50,0x3e4cbd9f,0x3de7be50,0xbe4c3d9f
.long 0xbe133e50,0x3e13a42c,0xbe133e50,0x3e13a42c,0xbe2d3e50,0x3d223d9f,0x3e2dbe50,0xbd22bd9f,0xbe403e50,0xbd9f3e13,0xbe403e50,0xbd9f3e13,0xbe4c3e50,0xbe2d3e40,0x3e4cbe50,0x3e2dbe40
.long 0x3e503e50,0x3e503e50,0x3e503e50,0x3e503e50,0x3de73e13,0x3d223d9f,0xbde7be13,0xbd22bd9f,0xbd9f2365,0xbe40be13,0xbd9f2365,0xbe40be13,0xbe4cbe13,0xbde7be40,0x3e4c3e13,0x3de73e40
.long 0xbe13be50,0x3e13a42c,0xbe13be50,0x3e13a42c,0x3d22be13,0x3e2d3e40,0xbd223e13,0xbe2dbe40,0x3e40a42c,0xbd9f3e13,0x3e40a42c,0xbd9f3e13,0x3e2d3e13,0xbe4cbd9f,0xbe2dbe13,0x3e4c3d9f
.long 0x23653e50,0xa42cbe50,0x23653e50,0xa42cbe50,0xbe2d3e13,0x3e4cbd9f,0x3e2dbe13,0xbe4c3d9f,0xbe402365,0x3d9f3e13,0xbe402365,0x3d9f3e13,0xbd22be13,0xbe2d3e40,0x3d223e13,0x3e2dbe40
.long 0x3e13be50,0xbe132365,0x3e13be50,0xbe132365,0x3e4cbe13,0x3de7be40,0xbe4c3e13,0xbde73e40,0x3d9fa42c,0x3e40be13,0x3d9fa42c,0x3e40be13,0xbde73e13,0xbd223d9f,0x3de7be13,0x3d22bd9f
.long 0x3e503e50,0x3e503e50,0x3e503e50,0x3e503e50,0xbd222365,0xbde7bd9f,0x3d22a42c,0x3de73d9f,0xbe40be50,0xbd9fbe13,0xbe40be50,0xbd9fbe13,0x3de7a42c,0x3e4c3e40,0xbde72365,0xbe4cbe40
.long 0x3e133e50,0xbe132365,0x3e133e50,0xbe132365,0xbe2d2365,0xbd22be40,0x3e2da42c,0x3d223e40,0xbd9fbe50,0x3e403e13,0xbd9fbe50,0x3e403e13,0x3e4ca42c,0xbe2d3d9f,0xbe4c2365,0x3e2dbd9f
.long 0x23653e50,0xa42cbe50,0x23653e50,0xa42cbe50,0xbe4c2365,0x3e2d3d9f,0x3e4ca42c,0xbe2dbd9f,0x3d9fbe50,0xbe403e13,0x3d9fbe50,0xbe403e13,0x3e2da42c,0x3d22be40,0xbe2d2365,0xbd223e40
.long 0xbe133e50,0x3e13a42c,0xbe133e50,0x3e13a42c,0xbde72365,0xbe4c3e40,0x3de7a42c,0x3e4cbe40,0x3e40be50,0x3d9fbe13,0x3e40be50,0x3d9fbe13,0x3d22a42c,0x3de7bd9f,0xbd222365,0xbde73d9f
.long 0x3e503e50,0x3e503e50,0x3e503e50,0x3e503e50,0xbe2dbe13,0xbe4cbe40,0x3e2d3e13,0x3e4c3e40,0x3d9fa42c,0x3e403e13,0x3d9fa42c,0x3e403e13,0x3d223e13,0xbe2dbd9f,0xbd22be13,0x3e2d3d9f
.long 0xbe13be50,0x3e13a42c,0xbe13be50,0x3e13a42c,0x3e4c3e13,0xbde73d9f,0xbe4cbe13,0x3de7bd9f,0xbe402365,0x3d9fbe13,0xbe402365,0x3d9fbe13,0x3de7be13,0xbd223e40,0xbde73e13,0x3d22be40
.long 0x23653e50,0xa42cbe50,0x23653e50,0xa42cbe50,0xbde7be13,0x3d223e40,0x3de73e13,0xbd22be40,0x3e40a42c,0xbd9fbe13,0x3e40a42c,0xbd9fbe13,0xbe4c3e13,0x3de73d9f,0x3e4cbe13,0xbde7bd9f
.long 0x3e13be50,0xbe132365,0x3e13be50,0xbe132365,0xbd223e13,0x3e2dbd9f,0x3d22be13,0xbe2d3d9f,0xbd9f2365,0xbe403e13,0xbd9f2365,0xbe403e13,0x3e2dbe13,0x3e4cbe40,0xbe2d3e13,0xbe4c3e40
.long 0x0,0x0,0x0,0x0,0xbd220000,0xbde7bd9f,0x3d22a3e5,0x3de73d9f,0xbd9f0000,0xbe40be13,0xbd9f0000,0xbe40be13,0xbde70000,0xbe4cbe40,0x3de7a3e5,0x3e4c3e40
.long 0xbe130000,0xbe13be50,0xbe130000,0xbe13be50,0xbe2d0000,0xbd22be40,0x3e2da3e5,0x3d223e40,0xbe400000,0x3d9fbe13,0xbe400000,0x3d9fbe13,0xbe4c0000,0x3e2dbd9f,0x3e4ca3e5,0xbe2d3d9f
.long 0xbe500000,0x3e50a3e5,0xbe500000,0x3e50a3e5,0xbe4c0000,0x3e2d3d9f,0x3e4ca3e5,0xbe2dbd9f,0xbe400000,0x3d9f3e13,0xbe400000,0x3d9f3e13,0xbe2d0000,0xbd223e40,0x3e2da3e5,0x3d22be40
.long 0xbe130000,0xbe133e50,0xbe130000,0xbe133e50,0xbde70000,0xbe4c3e40,0x3de7a3e5,0x3e4cbe40,0xbd9f0000,0xbe403e13,0xbd9f0000,0xbe403e13,0xbd220000,0xbde73d9f,0x3d22a3e5,0x3de7bd9f
.long 0x0,0x0,0x0,0x0,0xbe2dbe13,0xbe4cbe40,0x3e2d3e13,0x3e4c3e40,0xbe40be50,0xbd9fbe13,0xbe40be50,0xbd9fbe13,0xbd22be13,0x3e2d3d9f,0x3d223e13,0xbe2dbd9f
.long 0x3e13a3e5,0x3e133e50,0x3e13a3e5,0x3e133e50,0x3e4c3e13,0xbde73d9f,0xbe4cbe13,0x3de7bd9f,0x3d9f3e50,0xbe40be13,0x3d9f3e50,0xbe40be13,0xbde73e13,0x3d22be40,0x3de7be13,0xbd223e40
.long 0xbe500000,0x3e50a3e5,0xbe500000,0x3e50a3e5,0xbde7be13,0x3d223e40,0x3de73e13,0xbd22be40,0x3d9fbe50,0xbe403e13,0x3d9fbe50,0xbe403e13,0x3e4cbe13,0xbde7bd9f,0xbe4c3e13,0x3de73d9f
.long 0x3e13a3e5,0x3e13be50,0x3e13a3e5,0x3e13be50,0xbd223e13,0x3e2dbd9f,0x3d22be13,0xbe2d3d9f,0xbe403e50,0xbd9f3e13,0xbe403e50,0xbd9f3e13,0xbe2d3e13,0xbe4c3e40,0x3e2dbe13,0x3e4cbe40
.long 0x0,0x0,0x0,0x0,0xbe4cbe50,0xbe2dbe40,0x3e4c3e50,0x3e2d3e40,0x3d9fa3e5,0x3e403e13,0x3d9fa3e5,0x3e403e13,0x3e2d3e50,0xbd223d9f,0xbe2dbe50,0x3d22bd9f
.long 0xbe130000,0xbe13be50,0xbe130000,0xbe13be50,0xbde7be50,0x3e4c3d9f,0x3de73e50,0xbe4cbd9f,0x3e40a3e5,0xbd9f3e13,0x3e40a3e5,0xbd9f3e13,0x3d223e50,0xbde7be40,0xbd22be50,0x3de73e40
.long 0xbe500000,0x3e50a3e5,0xbe500000,0x3e50a3e5,0x3d22be50,0xbde73e40,0xbd223e50,0x3de7be40,0x3e40a3e5,0xbd9fbe13,0x3e40a3e5,0xbd9fbe13,0xbde73e50,0x3e4cbd9f,0x3de7be50,0xbe4c3d9f
.long 0xbe130000,0xbe133e50,0xbe130000,0xbe133e50,0x3e2dbe50,0xbd22bd9f,0xbe2d3e50,0x3d223d9f,0x3d9fa3e5,0x3e40be13,0x3d9fa3e5,0x3e40be13,0xbe4c3e50,0xbe2d3e40,0x3e4cbe50,0x3e2dbe40
.long 0x0,0x0,0x0,0x0,0xbde7be13,0xbd22bd9f,0x3de73e13,0x3d223d9f,0x3e403e50,0x3d9f3e13,0x3e403e50,0x3d9f3e13,0xbe4cbe13,0xbde7be40,0x3e4c3e13,0x3de73e40
.long 0x3e13a3e5,0x3e133e50,0x3e13a3e5,0x3e133e50,0xbd223e13,0xbe2dbe40,0x3d22be13,0x3e2d3e40,0xbd9fbe50,0x3e403e13,0xbd9fbe50,0x3e403e13,0x3e2d3e13,0xbe4cbd9f,0xbe2dbe13,0x3e4c3d9f
.long 0xbe500000,0x3e50a3e5,0xbe500000,0x3e50a3e5,0x3e2dbe13,0xbe4c3d9f,0xbe2d3e13,0x3e4cbd9f,0xbd9f3e50,0x3e40be13,0xbd9f3e50,0x3e40be13,0xbd22be13,0xbe2d3e40,0x3d223e13,0x3e2dbe40
.long 0x3e13a3e5,0x3e13be50,0x3e13a3e5,0x3e13be50,0xbe4c3e13,0xbde73e40,0x3e4cbe13,0x3de7be40,0x3e40be50,0x3d9fbe13,0x3e40be50,0x3d9fbe13,0xbde73e13,0xbd223d9f,0x3de7be13,0x3d22bd9f
.long 0x3b73,0x3b73,0x3b73,0x3b73,0x3b73,0x99da3b73,0x9dda3b73,0xa0633b73,0x3b73,0x9dda3b73,0xa1da3b73,0xa4633b73,0x3b73,0xa0633b73,0xa4633b73,0xa6953b73
.long 0x3b73,0xa1da3b73,0xa5da3b73,0xa8633b72,0x3b73,0xa3503b73,0xa7503b72,0xa97c3b71,0x3b73,0xa4633b73,0xa8633b72,0xaa943b70,0x3b73,0xa51f3b73,0xa91e3b72,0xabad3b6f
.long 0x3b73,0xa5da3b73,0xa9d93b71,0xac623b6e,0x3b73,0xa6953b73,0xaa943b70,0xacee3b6d,0x3b73,0xa7503b72,0xab4f3b70,0xad7a3b6b,0x3b73,0xa8063b72,0xac053b6f,0xae063b6a
.long 0x3b73,0xa8633b72,0xac623b6e,0xae923b68,0x3b73,0xa8c13b72,0xacc03b6d,0xaf1d3b66,0x3b73,0xa91e3b72,0xad1d3b6c,0xafa93b63,0x3b73,0xa97c3b71,0xad7a3b6b,0xb01a3b61
.long 0x3b73,0x3b73,0x3b73,0x3b73,0xa1da3b73,0xa3503b73,0xa4633b73,0xa51f3b73,0xa5da3b73,0xa7503b72,0xa8633b72,0xa91e3b72,0xa8633b72,0xa97c3b71,0xaa943b70,0xabad3b6f
.long 0xa9d93b71,0xab4f3b70,0xac623b6e,0xad1d3b6c,0xab4f3b70,0xac913b6e,0xad7a3b6b,0xae633b68,0xac623b6e,0xad7a3b6b,0xae923b68,0xafa93b63,0xad1d3b6c,0xae633b68,0xafa93b63,0xb0773b5e
.long 0xadd83b6a,0xaf4c3b65,0xb05f3b5f,0xb1183b57,0xae923b68,0xb01a3b61,0xb0ea3b59,0xb1b93b50,0xaf4c3b65,0xb08e3b5d,0xb1743b53,0xb25a3b47,0xb0033b62,0xb1013b58,0xb1fe3b4c,0xb2fa3b3e
.long 0xb05f3b5f,0xb1743b53,0xb2883b45,0xb3983b34,0xb0bc3b5b,0xb1e73b4d,0xb3103b3d,0xb41b3b29,0xb1183b57,0xb25a3b47,0xb3983b34,0xb46a3b1e,0xb1743b53,0xb2cc3b41,0xb4103b2b,0xb4b83b11
.long 0x3b73,0x3b73,0x3b73,0x3b73,0xa5da3b73,0xa6953b73,0xa7503b72,0xa8063b72,0xa9d93b71,0xaa943b70,0xab4f3b70,0xac053b6f,0xac623b6e,0xacee3b6d,0xad7a3b6b,0xae063b6a
.long 0xadd83b6a,0xae923b68,0xaf4c3b65,0xb0033b62,0xaf4c3b65,0xb01a3b61,0xb08e3b5d,0xb1013b58,0xb05f3b5f,0xb0ea3b59,0xb1743b53,0xb1fe3b4c,0xb1183b57,0xb1b93b50,0xb25a3b47,0xb2fa3b3e
.long 0xb1d03b4f,0xb2883b45,0xb33e3b3a,0xb3f33b2e,0xb2883b45,0xb3543b39,0xb4103b2b,0xb4753b1c,0xb33e3b3a,0xb4103b2b,0xb4803b1a,0xb4ef3b08,0xb3f33b2e,0xb4753b1c,0xb4ef3b08,0xb5683af1
.long 0xb4533b21,0xb4d93b0c,0xb55d3af3,0xb5df3ad9,0xb4ad3b13,0xb53c3afa,0xb5c93ade,0xb6543abf,0xb5053b04,0xb59e3ae7,0xb6353ac6,0xb6c83aa2,0xb55d3af3,0xb5ff3ad2,0xb69e3aad,0xb73a3a84
.long 0x3b73,0x3b73,0x3b73,0x3b73,0xa8633b72,0xa8c13b72,0xa91e3b72,0xa97c3b71,0xac623b6e,0xacc03b6d,0xad1d3b6c,0xad7a3b6b,0xae923b68,0xaf1d3b66,0xafa93b63,0xb01a3b61
.long 0xb05f3b5f,0xb0bc3b5b,0xb1183b57,0xb1743b53,0xb1743b53,0xb1e73b4d,0xb25a3b47,0xb2cc3b41,0xb2883b45,0xb3103b3d,0xb3983b34,0xb4103b2b,0xb3983b34,0xb41b3b29,0xb46a3b1e,0xb4b83b11
.long 0xb4533b21,0xb4ad3b13,0xb5053b04,0xb55d3af3,0xb4d93b0c,0xb53c3afa,0xb59e3ae7,0xb5ff3ad2,0xb55d3af3,0xb5c93ade,0xb6353ac6,0xb69e3aad,0xb5df3ad9,0xb6543abf,0xb6c83aa2,0xb73a3a84
.long 0xb65f3abc,0xb6dd3a9d,0xb7583a7c,0xb7d13a58,0xb6dd3a9d,0xb7623a79,0xb7e53a52,0xb8323a28,0xb7583a7c,0xb7e53a52,0xb8373a25,0xb87a39f5,0xb7d13a58,0xb8323a28,0xb87a39f5,0xb8be39bf
.long 0x3b73,0x3b73,0x3b73,0x3b73,0xa9d93b71,0xaa373b71,0xaa943b70,0xaaf23b70,0xadd83b6a,0xae353b69,0xae923b68,0xaeef3b66,0xb05f3b5f,0xb0a53b5c,0xb0ea3b59,0xb12f3b56
.long 0xb1d03b4f,0xb22c3b4a,0xb2883b45,0xb2e33b40,0xb33e3b3a,0xb3af3b33,0xb4103b2b,0xb4483b23,0xb4533b21,0xb4963b17,0xb4d93b0c,0xb51b3b00,0xb5053b04,0xb5523af6,0xb59e3ae7,0xb5ea3ad7
.long 0xb5b43ae2,0xb60a3ad0,0xb65f3abc,0xb6b33aa8,0xb65f3abc,0xb6be3aa5,0xb71b3a8d,0xb7773a73,0xb7063a92,0xb76d3a76,0xb7d13a58,0xb81a3a38,0xb7a93a64,0xb80b3a42,0xb8413a1e,0xb87539f8
.long 0xb8243a32,0xb85d3a0a,0xb89539e0,0xb8cc39b3,0xb87039fc,0xb8ac39cd,0xb8e7399d,0xb91f3969,0xb8ba39c2,0xb8f8398d,0xb9343955,0xb96d391b,0xb9013985,0xb9413949,0xb97d390a,0xb9b738c7
.long 0x3b73,0x3b73,0x3b73,0x3b73,0xab4f3b70,0xabad3b6f,0xac053b6f,0xac343b6f,0xaf4c3b65,0xafa93b63,0xb0033b62,0xb0313b60,0xb1743b53,0xb1b93b50,0xb1fe3b4c,0xb2433b49
.long 0xb33e3b3a,0xb3983b34,0xb3f33b2e,0xb4263b28,0xb4803b1a,0xb4b83b11,0xb4ef3b08,0xb5263afe,0xb55d3af3,0xb59e3ae7,0xb5df3ad9,0xb61f3acb,0xb6353ac6,0xb67f3ab5,0xb6c83aa2,0xb7103a8f
.long 0xb7063a92,0xb7583a7c,0xb7a93a64,0xb7f93a4b,0xb7d13a58,0xb8153a3c,0xb8413a1e,0xb86b39ff,0xb84a3a17,0xb87a39f5,0xb8a839d1,0xb8d539ac,0xb8a839d1,0xb8d939a8,0xb90a397d,0xb9383951
.long 0xb9013985,0xb9343955,0xb9653923,0xb99538ef,0xb9553934,0xb98938fd,0xb9bb38c3,0xb9ea3888,0xb9a438de,0xb9d8389f,0xba0a385d,0xba38381a,0xb9ee3883,0xba21383c,0xba5237e5,0xba7e374e
.long 0x3b73,0x3b73,0x3b73,0x3b73,0xac623b6e,0xac913b6e,0xacc03b6d,0xacee3b6d,0xb05f3b5f,0xb08e3b5d,0xb0bc3b5b,0xb0ea3b59,0xb2883b45,0xb2cc3b41,0xb3103b3d,0xb3543b39
.long 0xb4533b21,0xb4803b1a,0xb4ad3b13,0xb4d93b0c,0xb55d3af3,0xb5933ae9,0xb5c93ade,0xb5ff3ad2,0xb65f3abc,0xb69e3aad,0xb6dd3a9d,0xb71b3a8d,0xb7583a7c,0xb79f3a67,0xb7e53a52,0xb8153a3c
.long 0xb8243a32,0xb84a3a17,0xb87039fc,0xb89539e0,0xb89539e0,0xb8be39bf,0xb8e7399d,0xb90e3979,0xb9013985,0xb92c395d,0xb9553934,0xb97d390a,0xb9653923,0xb99138f4,0xb9bb38c3,0xb9e33891
.long 0xb9c238ba,0xb9ee3883,0xba17384a,0xba3f3810,0xba17384a,0xba42380b,0xba6a3795,0xba8f3710,0xba6437a9,0xba8d371b,0xbab23689,0xbad435f4,0xbaa836b3,0xbacd3615,0xbaef3573,0xbb0d34ce
.long 0x3b73,0x3b73,0x3b73,0x3b73,0xad1d3b6c,0xad4c3b6c,0xad7a3b6b,0xada93b6b,0xb1183b57,0xb1463b55,0xb1743b53,0xb1a23b51,0xb3983b34,0xb3dc3b30,0xb4103b2b,0xb4323b26
.long 0xb5053b04,0xb5313afc,0xb55d3af3,0xb5883aeb,0xb6353ac6,0xb66a3aba,0xb69e3aad,0xb6d23aa0,0xb7583a7c,0xb7953a6a,0xb7d13a58,0xb8063a45,0xb8373a25,0xb8593a0d,0xb87a39f5,0xb89a39dc
.long 0xb8ba39c2,0xb8de39a4,0xb9013985,0xb9233965,0xb9343955,0xb9593930,0xb97d390a,0xb9a038e2,0xb9a438de,0xb9ca38b1,0xb9ee3883,0xba113854,0xba0a385d,0xba2f3828,0xba5237e5,0xba733777
.long 0xba6437a9,0xba87372f,0xbaa836b3,0xbac63635,0xbab23689,0xbad235ff,0xbaef3573,0xbb0a34e4,0xbaf3355d,0xbb0f34c3,0xbb283426,0xbb3d3310,0xbb283426,0xbb3e32fa,0xbb5131a2,0xbb603048
.long 0x3b73,0x3b73,0x3b73,0x3b73,0x3b73,0x19da3b73,0x1dda3b73,0x20633b73,0x3b73,0x1dda3b73,0x21da3b73,0x24633b73,0x3b73,0x20633b73,0x24633b73,0x26953b73
.long 0x3b73,0x21da3b73,0x25da3b73,0x28633b72,0x3b73,0x23503b73,0x27503b72,0x297c3b71,0x3b73,0x24633b73,0x28633b72,0x2a943b70,0x3b73,0x251f3b73,0x291e3b72,0x2bad3b6f
.long 0x3b73,0x25da3b73,0x29d93b71,0x2c623b6e,0x3b73,0x26953b73,0x2a943b70,0x2cee3b6d,0x3b73,0x27503b72,0x2b4f3b70,0x2d7a3b6b,0x3b73,0x28063b72,0x2c053b6f,0x2e063b6a
.long 0x3b73,0x28633b72,0x2c623b6e,0x2e923b68,0x3b73,0x28c13b72,0x2cc03b6d,0x2f1d3b66,0x3b73,0x291e3b72,0x2d1d3b6c,0x2fa93b63,0x3b73,0x297c3b71,0x2d7a3b6b,0x301a3b61
.long 0x3b73,0x3b73,0x3b73,0x3b73,0x21da3b73,0x23503b73,0x24633b73,0x251f3b73,0x25da3b73,0x27503b72,0x28633b72,0x291e3b72,0x28633b72,0x297c3b71,0x2a943b70,0x2bad3b6f
.long 0x29d93b71,0x2b4f3b70,0x2c623b6e,0x2d1d3b6c,0x2b4f3b70,0x2c913b6e,0x2d7a3b6b,0x2e633b68,0x2c623b6e,0x2d7a3b6b,0x2e923b68,0x2fa93b63,0x2d1d3b6c,0x2e633b68,0x2fa93b63,0x30773b5e
.long 0x2dd83b6a,0x2f4c3b65,0x305f3b5f,0x31183b57,0x2e923b68,0x301a3b61,0x30ea3b59,0x31b93b50,0x2f4c3b65,0x308e3b5d,0x31743b53,0x325a3b47,0x30033b62,0x31013b58,0x31fe3b4c,0x32fa3b3e
.long 0x305f3b5f,0x31743b53,0x32883b45,0x33983b34,0x30bc3b5b,0x31e73b4d,0x33103b3d,0x341b3b29,0x31183b57,0x325a3b47,0x33983b34,0x346a3b1e,0x31743b53,0x32cc3b41,0x34103b2b,0x34b83b11
.long 0x3b73,0x3b73,0x3b73,0x3b73,0x25da3b73,0x26953b73,0x27503b72,0x28063b72,0x29d93b71,0x2a943b70,0x2b4f3b70,0x2c053b6f,0x2c623b6e,0x2cee3b6d,0x2d7a3b6b,0x2e063b6a
.long 0x2dd83b6a,0x2e923b68,0x2f4c3b65,0x30033b62,0x2f4c3b65,0x301a3b61,0x308e3b5d,0x31013b58,0x305f3b5f,0x30ea3b59,0x31743b53,0x31fe3b4c,0x31183b57,0x31b93b50,0x325a3b47,0x32fa3b3e
.long 0x31d03b4f,0x32883b45,0x333e3b3a,0x33f33b2e,0x32883b45,0x33543b39,0x34103b2b,0x34753b1c,0x333e3b3a,0x34103b2b,0x34803b1a,0x34ef3b08,0x33f33b2e,0x34753b1c,0x34ef3b08,0x35683af1
.long 0x34533b21,0x34d93b0c,0x355d3af3,0x35df3ad9,0x34ad3b13,0x353c3afa,0x35c93ade,0x36543abf,0x35053b04,0x359e3ae7,0x36353ac6,0x36c83aa2,0x355d3af3,0x35ff3ad2,0x369e3aad,0x373a3a84
.long 0x3b73,0x3b73,0x3b73,0x3b73,0x28633b72,0x28c13b72,0x291e3b72,0x297c3b71,0x2c623b6e,0x2cc03b6d,0x2d1d3b6c,0x2d7a3b6b,0x2e923b68,0x2f1d3b66,0x2fa93b63,0x301a3b61
.long 0x305f3b5f,0x30bc3b5b,0x31183b57,0x31743b53,0x31743b53,0x31e73b4d,0x325a3b47,0x32cc3b41,0x32883b45,0x33103b3d,0x33983b34,0x34103b2b,0x33983b34,0x341b3b29,0x346a3b1e,0x34b83b11
.long 0x34533b21,0x34ad3b13,0x35053b04,0x355d3af3,0x34d93b0c,0x353c3afa,0x359e3ae7,0x35ff3ad2,0x355d3af3,0x35c93ade,0x36353ac6,0x369e3aad,0x35df3ad9,0x36543abf,0x36c83aa2,0x373a3a84
.long 0x365f3abc,0x36dd3a9d,0x37583a7c,0x37d13a58,0x36dd3a9d,0x37623a79,0x37e53a52,0x38323a28,0x37583a7c,0x37e53a52,0x38373a25,0x387a39f5,0x37d13a58,0x38323a28,0x387a39f5,0x38be39bf
.long 0x3b73,0x29d93b71,0x2dd83b6a,0x305f3b5f,0x3b73,0x2a373b71,0x2e353b69,0x30a53b5c,0x3b73,0x2a943b70,0x2e923b68,0x30ea3b59,0x3b73,0x2af23b70,0x2eef3b66,0x312f3b56
.long 0x3b73,0x2b4f3b70,0x2f4c3b65,0x31743b53,0x3b73,0x2bad3b6f,0x2fa93b63,0x31b93b50,0x3b73,0x2c053b6f,0x30033b62,0x31fe3b4c,0x3b73,0x2c343b6f,0x30313b60,0x32433b49
.long 0x3b73,0x2c623b6e,0x305f3b5f,0x32883b45,0x3b73,0x2c913b6e,0x308e3b5d,0x32cc3b41,0x3b73,0x2cc03b6d,0x30bc3b5b,0x33103b3d,0x3b73,0x2cee3b6d,0x30ea3b59,0x33543b39
.long 0x3b73,0x2d1d3b6c,0x31183b57,0x33983b34,0x3b73,0x2d4c3b6c,0x31463b55,0x33dc3b30,0x3b73,0x2d7a3b6b,0x31743b53,0x34103b2b,0x3b73,0x2da93b6b,0x31a23b51,0x34323b26
.long 0x31d03b4f,0x333e3b3a,0x34533b21,0x35053b04,0x322c3b4a,0x33af3b33,0x34963b17,0x35523af6,0x32883b45,0x34103b2b,0x34d93b0c,0x359e3ae7,0x32e33b40,0x34483b23,0x351b3b00,0x35ea3ad7
.long 0x333e3b3a,0x34803b1a,0x355d3af3,0x36353ac6,0x33983b34,0x34b83b11,0x359e3ae7,0x367f3ab5,0x33f33b2e,0x34ef3b08,0x35df3ad9,0x36c83aa2,0x34263b28,0x35263afe,0x361f3acb,0x37103a8f
.long 0x34533b21,0x355d3af3,0x365f3abc,0x37583a7c,0x34803b1a,0x35933ae9,0x369e3aad,0x379f3a67,0x34ad3b13,0x35c93ade,0x36dd3a9d,0x37e53a52,0x34d93b0c,0x35ff3ad2,0x371b3a8d,0x38153a3c
.long 0x35053b04,0x36353ac6,0x37583a7c,0x38373a25,0x35313afc,0x366a3aba,0x37953a6a,0x38593a0d,0x355d3af3,0x369e3aad,0x37d13a58,0x387a39f5,0x35883aeb,0x36d23aa0,0x38063a45,0x389a39dc
.long 0x35b43ae2,0x365f3abc,0x37063a92,0x37a93a64,0x360a3ad0,0x36be3aa5,0x376d3a76,0x380b3a42,0x365f3abc,0x371b3a8d,0x37d13a58,0x38413a1e,0x36b33aa8,0x37773a73,0x381a3a38,0x387539f8
.long 0x37063a92,0x37d13a58,0x384a3a17,0x38a839d1,0x37583a7c,0x38153a3c,0x387a39f5,0x38d939a8,0x37a93a64,0x38413a1e,0x38a839d1,0x390a397d,0x37f93a4b,0x386b39ff,0x38d539ac,0x39383951
.long 0x38243a32,0x389539e0,0x39013985,0x39653923,0x384a3a17,0x38be39bf,0x392c395d,0x399138f4,0x387039fc,0x38e7399d,0x39553934,0x39bb38c3,0x389539e0,0x390e3979,0x397d390a,0x39e33891
.long 0x38ba39c2,0x39343955,0x39a438de,0x3a0a385d,0x38de39a4,0x39593930,0x39ca38b1,0x3a2f3828,0x39013985,0x397d390a,0x39ee3883,0x3a5237e5,0x39233965,0x39a038e2,0x3a113854,0x3a733777
.long 0x38243a32,0x387039fc,0x38ba39c2,0x39013985,0x385d3a0a,0x38ac39cd,0x38f8398d,0x39413949,0x389539e0,0x38e7399d,0x39343955,0x397d390a,0x38cc39b3,0x391f3969,0x396d391b,0x39b738c7
.long 0x39013985,0x39553934,0x39a438de,0x39ee3883,0x39343955,0x398938fd,0x39d8389f,0x3a21383c,0x39653923,0x39bb38c3,0x3a0a385d,0x3a5237e5,0x399538ef,0x39ea3888,0x3a38381a,0x3a7e374e
.long 0x39c238ba,0x3a17384a,0x3a6437a9,0x3aa836b3,0x39ee3883,0x3a42380b,0x3a8d371b,0x3acd3615,0x3a17384a,0x3a6a3795,0x3ab23689,0x3aef3573,0x3a3f3810,0x3a8f3710,0x3ad435f4,0x3b0d34ce
.long 0x3a6437a9,0x3ab23689,0x3af3355d,0x3b283426,0x3a87372f,0x3ad235ff,0x3b0f34c3,0x3b3e32fa,0x3aa836b3,0x3aef3573,0x3b283426,0x3b5131a2,0x3ac63635,0x3b0a34e4,0x3b3d3310,0x3b603048
.long 0x23043def,0xa3c6bdef,0x23043def,0xa3c6bdef,0xbc3c3def,0x3d0bbdeb,0xbd623ddd,0x3d98bdc7,0xbcbb3def,0x3d85bddd,0xbdc73da9,0x3debbd37,0xbd0b3def,0x3db9bdc7,0xbdee3d37,0x3dd33cbb
.long 0xbd373def,0x3dddbda9,0xbddd2304,0x3d373da9,0xbd623def,0x3deebd85,0xbd98bd37,0xbd0b3deb,0xbd853def,0x3debbd37,0xbcbbbda9,0xbdc73ddd,0xbd983def,0x3dd3bcbb,0x3d0bbddd,0xbdee3d85
.long 0xbda93def,0x3da9a3c6,0x3da9bdef,0xbda92304,0xbdb93def,0x3d623cbb,0x3de5bddd,0xbc3cbd85,0xbdc73def,0x3cbb3d37,0x3debbda9,0x3d85bddd,0xbdd33def,0xbc3c3d85,0x3db9bd37,0x3de5bdeb
.long 0xbddd3def,0xbd373da9,0x3d37a3c6,0x3dddbda9,0xbde53def,0xbd983dc7,0xbc3c3d37,0x3d62bcbb,0xbdeb3def,0xbdc73ddd,0xbd853da9,0xbcbb3d37,0xbdee3def,0xbde53deb,0xbdd33ddd,0xbdb93dc7
.long 0x23043def,0xa3c6bdef,0x23043def,0xa3c6bdef,0xbdb93da9,0x3dd3bd85,0xbde53d37,0x3deebcbb,0xbdeb2304,0x3dc73d37,0xbd85bda9,0x3cbb3ddd,0xbd62bda9,0xbc3c3deb,0x3d98bddd,0xbde53d85
.long 0x3d37bdef,0xbddd3da9,0x3ddda3c6,0xbd37bda9,0x3de5bda9,0xbdb9bcbb,0xbc3c3ddd,0x3dd3bdc7,0x3dc7a3c6,0x3cbbbddd,0xbdeb3da9,0x3d853d37,0x3c3c3da9,0x3de5bdc7,0xbd62bd37,0xbdb93deb
.long 0xbda93def,0x3da9a3c6,0x3da9bdef,0xbda92304,0xbdee3da9,0xbd0b3dc7,0x3dd3bd37,0x3d98bdeb,0xbd852304,0xbdeb3ddd,0xbcbb3da9,0x3dc7bd37,0x3d0bbda9,0xbd983cbb,0xbdee3ddd,0xbd623dc7
.long 0x3dddbdef,0x3d37bda9,0xbd372304,0xbddd3da9,0x3dd3bda9,0x3deebdeb,0x3db9bddd,0x3d0bbd85,0x3cbba3c6,0x3d85bd37,0x3dc7bda9,0x3debbddd,0xbd983da9,0xbd623d85,0xbd0b3d37,0xbc3c3cbb
.long 0x23043def,0xa3c6bdef,0x23043def,0xa3c6bdef,0xbdee2304,0x3de53cbb,0xbdd3bd37,0x3db93d85,0x3cbbbdef,0xbd853ddd,0x3dc7bda9,0xbdeb3d37,0x3de5a3c6,0xbd98bd85,0x3c3c3ddd,0x3d62bdeb
.long 0xbd373def,0x3dddbda9,0xbddd2304,0x3d373da9,0xbdd32304,0x3c3c3dc7,0x3db9bddd,0xbde53cbb,0x3d85bdef,0xbdeb3d37,0x3cbb3da9,0x3dc7bddd,0x3db9a3c6,0x3d62bdeb,0xbde53d37,0xbc3c3dc7
.long 0xbda93def,0x3da9a3c6,0x3da9bdef,0xbda92304,0xbd982304,0xbdd33deb,0x3d0b3d37,0x3deebdc7,0x3dc7bdef,0xbcbbbd37,0xbdeb3da9,0xbd853ddd,0x3d62a3c6,0x3deebdc7,0x3d98bddd,0xbd0bbcbb
.long 0xbddd3def,0xbd373da9,0x3d37a3c6,0x3dddbda9,0xbd0b2304,0xbdb93d85,0xbdee3ddd,0xbdd33deb,0x3debbdef,0x3dc7bddd,0x3d85bda9,0x3cbbbd37,0x3c3ca3c6,0x3d0bbcbb,0x3d62bd37,0x3d98bd85
.long 0x23043def,0xa3c6bdef,0x23043def,0xa3c6bdef,0xbd98bda9,0x3d623dc7,0xbd0bbddd,0x3c3c3deb,0x3deba3c6,0xbdc7bd37,0x3d853da9,0xbcbbbddd,0xbdd33da9,0x3deebcbb,0xbdb9bd37,0x3d0b3dc7
.long 0x3d37bdef,0xbddd3da9,0x3ddda3c6,0xbd37bda9,0x3d0b3da9,0x3d98bdeb,0xbdee3d37,0x3d623d85,0xbdc72304,0xbcbb3ddd,0x3debbda9,0xbd85bd37,0x3deebda9,0xbd0bbd85,0xbdd33ddd,0x3d983cbb
.long 0xbda93def,0x3da9a3c6,0x3da9bdef,0xbda92304,0x3c3cbda9,0xbde53d85,0xbd623ddd,0x3db9bcbb,0x3d85a3c6,0x3debbddd,0x3cbbbda9,0xbdc73d37,0xbde53da9,0xbdb93deb,0x3c3c3d37,0x3dd3bd85
.long 0x3dddbdef,0x3d37bda9,0xbd372304,0xbddd3da9,0xbd623da9,0x3c3c3cbb,0x3d98bd37,0x3de5bdc7,0xbcbb2304,0xbd853d37,0xbdc73da9,0xbdeb3ddd,0x3db9bda9,0x3dd3bdc7,0x3de5bddd,0x3deebdeb
.long 0xbdef0000,0x3defa384,0xbdef0000,0x3defa384,0xbdee0000,0x3de53cbb,0xbdd3bd37,0x3db93d85,0xbdeb0000,0x3dc73d37,0xbd85bda9,0x3cbb3ddd,0xbde50000,0x3d983d85,0xbc3cbddd,0xbd623deb
.long 0xbddd0000,0x3d373da9,0x3d37bdef,0xbddd3da9,0xbdd30000,0x3c3c3dc7,0x3db9bddd,0xbde53cbb,0xbdc70000,0xbcbb3ddd,0x3debbda9,0xbd85bd37,0xbdb90000,0xbd623deb,0x3de5bd37,0x3c3cbdc7
.long 0xbda90000,0xbda93def,0x3da9a384,0x3da9bdef,0xbd980000,0xbdd33deb,0x3d0b3d37,0x3deebdc7,0xbd850000,0xbdeb3ddd,0xbcbb3da9,0x3dc7bd37,0xbd620000,0xbdee3dc7,0xbd983ddd,0x3d0b3cbb
.long 0xbd370000,0xbddd3da9,0xbddd3def,0xbd373da9,0xbd0b0000,0xbdb93d85,0xbdee3ddd,0xbdd33deb,0xbcbb0000,0xbd853d37,0xbdc73da9,0xbdeb3ddd,0xbc3c0000,0xbd0b3cbb,0xbd623d37,0xbd983d85
.long 0xbdef0000,0x3defa384,0xbdef0000,0x3defa384,0xbd98bda9,0x3d623dc7,0xbd0bbddd,0x3c3c3deb,0x3cbbbdef,0xbd853ddd,0x3dc7bda9,0xbdeb3d37,0x3dd3bda9,0xbdee3cbb,0x3db93d37,0xbd0bbdc7
.long 0x3ddda384,0xbd37bda9,0xbd373def,0x3dddbda9,0x3d0b3da9,0x3d98bdeb,0xbdee3d37,0x3d623d85,0xbd853def,0x3debbd37,0xbcbbbda9,0xbdc73ddd,0xbdee3da9,0x3d0b3d85,0x3dd3bddd,0xbd98bcbb
.long 0xbda90000,0xbda93def,0x3da9a384,0x3da9bdef,0x3c3cbda9,0xbde53d85,0xbd623ddd,0x3db9bcbb,0x3dc7bdef,0xbcbbbd37,0xbdeb3da9,0xbd853ddd,0x3de5bda9,0x3db9bdeb,0xbc3cbd37,0xbdd33d85
.long 0x3d37a384,0x3dddbda9,0x3dddbdef,0x3d37bda9,0xbd623da9,0x3c3c3cbb,0x3d98bd37,0x3de5bdc7,0xbdeb3def,0xbdc73ddd,0xbd853da9,0xbcbb3d37,0xbdb93da9,0xbdd33dc7,0xbde53ddd,0xbdee3deb
.long 0xbdef0000,0x3defa384,0xbdef0000,0x3defa384,0x3c3cbdef,0xbd0b3deb,0x3d62bddd,0xbd983dc7,0x3deba384,0xbdc7bd37,0x3d853da9,0xbcbbbddd,0xbd0b3def,0x3db9bdc7,0xbdee3d37,0x3dd33cbb
.long 0xbddd0000,0x3d373da9,0x3d37bdef,0xbddd3da9,0x3d62bdef,0xbdee3d85,0x3d983d37,0x3d0bbdeb,0x3dc7a384,0x3cbbbddd,0xbdeb3da9,0x3d853d37,0xbd983def,0x3dd3bcbb,0x3d0bbddd,0xbdee3d85
.long 0xbda90000,0xbda93def,0x3da9a384,0x3da9bdef,0x3db9bdef,0xbd62bcbb,0xbde53ddd,0x3c3c3d85,0x3d85a384,0x3debbddd,0x3cbbbda9,0xbdc73d37,0xbdd33def,0xbc3c3d85,0x3db9bd37,0x3de5bdeb
.long 0xbd370000,0xbddd3da9,0xbddd3def,0xbd373da9,0x3de5bdef,0x3d98bdc7,0x3c3cbd37,0xbd623cbb,0x3cbba384,0x3d85bd37,0x3dc7bda9,0x3debbddd,0xbdee3def,0xbde53deb,0xbdd33ddd,0xbdb93dc7
.long 0xbdef0000,0x3defa384,0xbdef0000,0x3defa384,0x3db9bda9,0xbdd33d85,0x3de5bd37,0xbdee3cbb,0xbcbb3def,0x3d85bddd,0xbdc73da9,0x3debbd37,0xbd62bda9,0xbc3c3deb,0x3d98bddd,0xbde53d85
.long 0x3ddda384,0xbd37bda9,0xbd373def,0x3dddbda9,0xbde53da9,0x3db93cbb,0x3c3cbddd,0xbdd33dc7,0x3d85bdef,0xbdeb3d37,0x3cbb3da9,0x3dc7bddd,0x3c3c3da9,0x3de5bdc7,0xbd62bd37,0xbdb93deb
.long 0xbda90000,0xbda93def,0x3da9a384,0x3da9bdef,0x3deebda9,0x3d0bbdc7,0xbdd33d37,0xbd983deb,0xbdc73def,0x3cbb3d37,0x3debbda9,0x3d85bddd,0x3d0bbda9,0xbd983cbb,0xbdee3ddd,0xbd623dc7
.long 0x3d37a384,0x3dddbda9,0x3dddbdef,0x3d37bda9,0xbdd33da9,0xbdee3deb,0xbdb93ddd,0xbd0b3d85,0x3debbdef,0x3dc7bddd,0x3d85bda9,0x3cbbbd37,0xbd983da9,0xbd623d85,0xbd0b3d37,0xbc3c3cbb
.long 0x3e503e50,0x3e503e50,0x3e503e50,0x3e503e50,0x3e4c3e50,0x3e2d3e40,0xbe4cbe50,0xbe2dbe40,0x3e403e50,0x3d9f3e13,0x3e403e50,0x3d9f3e13,0x3e2d3e50,0xbd223d9f,0xbe2dbe50,0x3d22bd9f
.long 0x3e133e50,0xbe132365,0x3e133e50,0xbe132365,0x3de73e50,0xbe4cbd9f,0xbde7be50,0x3e4c3d9f,0x3d9f3e50,0xbe40be13,0x3d9f3e50,0xbe40be13,0x3d223e50,0xbde7be40,0xbd22be50,0x3de73e40
.long 0x23653e50,0xa42cbe50,0x23653e50,0xa42cbe50,0xbd223e50,0x3de7be40,0x3d22be50,0xbde73e40,0xbd9f3e50,0x3e40be13,0xbd9f3e50,0x3e40be13,0xbde73e50,0x3e4cbd9f,0x3de7be50,0xbe4c3d9f
.long 0xbe133e50,0x3e13a42c,0xbe133e50,0x3e13a42c,0xbe2d3e50,0x3d223d9f,0x3e2dbe50,0xbd22bd9f,0xbe403e50,0xbd9f3e13,0xbe403e50,0xbd9f3e13,0xbe4c3e50,0xbe2d3e40,0x3e4cbe50,0x3e2dbe40
.long 0x3e503e50,0x3e503e50,0x3e503e50,0x3e503e50,0x3de73e13,0x3d223d9f,0xbde7be13,0xbd22bd9f,0xbd9f2365,0xbe40be13,0xbd9f2365,0xbe40be13,0xbe4cbe13,0xbde7be40,0x3e4c3e13,0x3de73e40
.long 0xbe13be50,0x3e13a42c,0xbe13be50,0x3e13a42c,0x3d22be13,0x3e2d3e40,0xbd223e13,0xbe2dbe40,0x3e40a42c,0xbd9f3e13,0x3e40a42c,0xbd9f3e13,0x3e2d3e13,0xbe4cbd9f,0xbe2dbe13,0x3e4c3d9f
.long 0x23653e50,0xa42cbe50,0x23653e50,0xa42cbe50,0xbe2d3e13,0x3e4cbd9f,0x3e2dbe13,0xbe4c3d9f,0xbe402365,0x3d9f3e13,0xbe402365,0x3d9f3e13,0xbd22be13,0xbe2d3e40,0x3d223e13,0x3e2dbe40
.long 0x3e13be50,0xbe132365,0x3e13be50,0xbe132365,0x3e4cbe13,0x3de7be40,0xbe4c3e13,0xbde73e40,0x3d9fa42c,0x3e40be13,0x3d9fa42c,0x3e40be13,0xbde73e13,0xbd223d9f,0x3de7be13,0x3d22bd9f
.long 0x3e503e50,0x3e503e50,0x3e503e50,0x3e503e50,0xbd222365,0xbde7bd9f,0x3d22a42c,0x3de73d9f,0xbe40be50,0xbd9fbe13,0xbe40be50,0xbd9fbe13,0x3de7a42c,0x3e4c3e40,0xbde72365,0xbe4cbe40
.long 0x3e133e50,0xbe132365,0x3e133e50,0xbe132365,0xbe2d2365,0xbd22be40,0x3e2da42c,0x3d223e40,0xbd9fbe50,0x3e403e13,0xbd9fbe50,0x3e403e13,0x3e4ca42c,0xbe2d3d9f,0xbe4c2365,0x3e2dbd9f
.long 0x23653e50,0xa42cbe50,0x23653e50,0xa42cbe50,0xbe4c2365,0x3e2d3d9f,0x3e4ca42c,0xbe2dbd9f,0x3d9fbe50,0xbe403e13,0x3d9fbe50,0xbe403e13,0x3e2da42c,0x3d22be40,0xbe2d2365,0xbd223e40
.long 0xbe133e50,0x3e13a42c,0xbe133e50,0x3e13a42c,0xbde72365,0xbe4c3e40,0x3de7a42c,0x3e4cbe40,0x3e40be50,0x3d9fbe13,0x3e40be50,0x3d9fbe13,0x3d22a42c,0x3de7bd9f,0xbd222365,0xbde73d9f
.long 0x3e503e50,0x3e503e50,0x3e503e50,0x3e503e50,0xbe2dbe13,0xbe4cbe40,0x3e2d3e13,0x3e4c3e40,0x3d9fa42c,0x3e403e13,0x3d9fa42c,0x3e403e13,0x3d223e13,0xbe2dbd9f,0xbd22be13,0x3e2d3d9f
.long 0xbe13be50,0x3e13a42c,0xbe13be50,0x3e13a42c,0x3e4c3e13,0xbde73d9f,0xbe4cbe13,0x3de7bd9f,0xbe402365,0x3d9fbe13,0xbe402365,0x3d9fbe13,0x3de7be13,0xbd223e40,0xbde73e13,0x3d22be40
.long 0x23653e50,0xa42cbe50,0x23653e50,0xa42cbe50,0xbde7be13,0x3d223e40,0x3de73e13,0xbd22be40,0x3e40a42c,0xbd9fbe13,0x3e40a42c,0xbd9fbe13,0xbe4c3e13,0x3de73d9f,0x3e4cbe13,0xbde7bd9f
.long 0x3e13be50,0xbe132365,0x3e13be50,0xbe132365,0xbd223e13,0x3e2dbd9f,0x3d22be13,0xbe2d3d9f,0xbd9f2365,0xbe403e13,0xbd9f2365,0xbe403e13,0x3e2dbe13,0x3e4cbe40,0xbe2d3e13,0xbe4c3e40
.long 0x0,0x0,0x0,0x0,0xbd220000,0xbde7bd9f,0x3d22a3e5,0x3de73d9f,0xbd9f0000,0xbe40be13,0xbd9f0000,0xbe40be13,0xbde70000,0xbe4cbe40,0x3de7a3e5,0x3e4c3e40
.long 0xbe130000,0xbe13be50,0xbe130000,0xbe13be50,0xbe2d0000,0xbd22be40,0x3e2da3e5,0x3d223e40,0xbe400000,0x3d9fbe13,0xbe400000,0x3d9fbe13,0xbe4c0000,0x3e2dbd9f,0x3e4ca3e5,0xbe2d3d9f
.long 0xbe500000,0x3e50a3e5,0xbe500000,0x3e50a3e5,0xbe4c0000,0x3e2d3d9f,0x3e4ca3e5,0xbe2dbd9f,0xbe400000,0x3d9f3e13,0xbe400000,0x3d9f3e13,0xbe2d0000,0xbd223e40,0x3e2da3e5,0x3d22be40
.long 0xbe130000,0xbe133e50,0xbe130000,0xbe133e50,0xbde70000,0xbe4c3e40,0x3de7a3e5,0x3e4cbe40,0xbd9f0000,0xbe403e13,0xbd9f0000,0xbe403e13,0xbd220000,0xbde73d9f,0x3d22a3e5,0x3de7bd9f
.long 0x0,0x0,0x0,0x0,0xbe2dbe13,0xbe4cbe40,0x3e2d3e13,0x3e4c3e40,0xbe40be50,0xbd9fbe13,0xbe40be50,0xbd9fbe13,0xbd22be13,0x3e2d3d9f,0x3d223e13,0xbe2dbd9f
.long 0x3e13a3e5,0x3e133e50,0x3e13a3e5,0x3e133e50,0x3e4c3e13,0xbde73d9f,0xbe4cbe13,0x3de7bd9f,0x3d9f3e50,0xbe40be13,0x3d9f3e50,0xbe40be13,0xbde73e13,0x3d22be40,0x3de7be13,0xbd223e40
.long 0xbe500000,0x3e50a3e5,0xbe500000,0x3e50a3e5,0xbde7be13,0x3d223e40,0x3de73e13,0xbd22be40,0x3d9fbe50,0xbe403e13,0x3d9fbe50,0xbe403e13,0x3e4cbe13,0xbde7bd9f,0xbe4c3e13,0x3de73d9f
.long 0x3e13a3e5,0x3e13be50,0x3e13a3e5,0x3e13be50,0xbd223e13,0x3e2dbd9f,0x3d22be13,0xbe2d3d9f,0xbe403e50,0xbd9f3e13,0xbe403e50,0xbd9f3e13,0xbe2d3e13,0xbe4c3e40,0x3e2dbe13,0x3e4cbe40
.long 0x0,0x0,0x0,0x0,0xbe4cbe50,0xbe2dbe40,0x3e4c3e50,0x3e2d3e40,0x3d9fa3e5,0x3e403e13,0x3d9fa3e5,0x3e403e13,0x3e2d3e50,0xbd223d9f,0xbe2dbe50,0x3d22bd9f
.long 0xbe130000,0xbe13be50,0xbe130000,0xbe13be50,0xbde7be50,0x3e4c3d9f,0x3de73e50,0xbe4cbd9f,0x3e40a3e5,0xbd9f3e13,0x3e40a3e5,0xbd9f3e13,0x3d223e50,0xbde7be40,0xbd22be50,0x3de73e40
.long 0xbe500000,0x3e50a3e5,0xbe500000,0x3e50a3e5,0x3d22be50,0xbde73e40,0xbd223e50,0x3de7be40,0x3e40a3e5,0xbd9fbe13,0x3e40a3e5,0xbd9fbe13,0xbde73e50,0x3e4cbd9f,0x3de7be50,0xbe4c3d9f
.long 0xbe130000,0xbe133e50,0xbe130000,0xbe133e50,0x3e2dbe50,0xbd22bd9f,0xbe2d3e50,0x3d223d9f,0x3d9fa3e5,0x3e40be13,0x3d9fa3e5,0x3e40be13,0xbe4c3e50,0xbe2d3e40,0x3e4cbe50,0x3e2dbe40
.long 0x0,0x0,0x0,0x0,0xbde7be13,0xbd22bd9f,0x3de73e13,0x3d223d9f,0x3e403e50,0x3d9f3e13,0x3e403e50,0x3d9f3e13,0xbe4cbe13,0xbde7be40,0x3e4c3e13,0x3de73e40
.long 0x3e13a3e5,0x3e133e50,0x3e13a3e5,0x3e133e50,0xbd223e13,0xbe2dbe40,0x3d22be13,0x3e2d3e40,0xbd9fbe50,0x3e403e13,0xbd9fbe50,0x3e403e13,0x3e2d3e13,0xbe4cbd9f,0xbe2dbe13,0x3e4c3d9f
.long 0xbe500000,0x3e50a3e5,0xbe500000,0x3e50a3e5,0x3e2dbe13,0xbe4c3d9f,0xbe2d3e13,0x3e4cbd9f,0xbd9f3e50,0x3e40be13,0xbd9f3e50,0x3e40be13,0xbd22be13,0xbe2d3e40,0x3d223e13,0x3e2dbe40
.long 0x3e13a3e5,0x3e13be50,0x3e13a3e5,0x3e13be50,0xbe4c3e13,0xbde73e40,0x3e4cbe13,0x3de7be40,0x3e40be50,0x3d9fbe13,0x3e40be50,0x3d9fbe13,0xbde73e13,0xbd223d9f,0x3de7be13,0x3d22bd9f
.long 0x3b73,0xa9d93b71,0xadd83b6a,0xb05f3b5f,0x3b73,0xaa373b71,0xae353b69,0xb0a53b5c,0x3b73,0xaa943b70,0xae923b68,0xb0ea3b59,0x3b73,0xaaf23b70,0xaeef3b66,0xb12f3b56
.long 0x3b73,0xab4f3b70,0xaf4c3b65,0xb1743b53,0x3b73,0xabad3b6f,0xafa93b63,0xb1b93b50,0x3b73,0xac053b6f,0xb0033b62,0xb1fe3b4c,0x3b73,0xac343b6f,0xb0313b60,0xb2433b49
.long 0x3b73,0xac623b6e,0xb05f3b5f,0xb2883b45,0x3b73,0xac913b6e,0xb08e3b5d,0xb2cc3b41,0x3b73,0xacc03b6d,0xb0bc3b5b,0xb3103b3d,0x3b73,0xacee3b6d,0xb0ea3b59,0xb3543b39
.long 0x3b73,0xad1d3b6c,0xb1183b57,0xb3983b34,0x3b73,0xad4c3b6c,0xb1463b55,0xb3dc3b30,0x3b73,0xad7a3b6b,0xb1743b53,0xb4103b2b,0x3b73,0xada93b6b,0xb1a23b51,0xb4323b26
.long 0xb1d03b4f,0xb33e3b3a,0xb4533b21,0xb5053b04,0xb22c3b4a,0xb3af3b33,0xb4963b17,0xb5523af6,0xb2883b45,0xb4103b2b,0xb4d93b0c,0xb59e3ae7,0xb2e33b40,0xb4483b23,0xb51b3b00,0xb5ea3ad7
.long 0xb33e3b3a,0xb4803b1a,0xb55d3af3,0xb6353ac6,0xb3983b34,0xb4b83b11,0xb59e3ae7,0xb67f3ab5,0xb3f33b2e,0xb4ef3b08,0xb5df3ad9,0xb6c83aa2,0xb4263b28,0xb5263afe,0xb61f3acb,0xb7103a8f
.long 0xb4533b21,0xb55d3af3,0xb65f3abc,0xb7583a7c,0xb4803b1a,0xb5933ae9,0xb69e3aad,0xb79f3a67,0xb4ad3b13,0xb5c93ade,0xb6dd3a9d,0xb7e53a52,0xb4d93b0c,0xb5ff3ad2,0xb71b3a8d,0xb8153a3c
.long 0xb5053b04,0xb6353ac6,0xb7583a7c,0xb8373a25,0xb5313afc,0xb66a3aba,0xb7953a6a,0xb8593a0d,0xb55d3af3,0xb69e3aad,0xb7d13a58,0xb87a39f5,0xb5883aeb,0xb6d23aa0,0xb8063a45,0xb89a39dc
.long 0xb5b43ae2,0xb65f3abc,0xb7063a92,0xb7a93a64,0xb60a3ad0,0xb6be3aa5,0xb76d3a76,0xb80b3a42,0xb65f3abc,0xb71b3a8d,0xb7d13a58,0xb8413a1e,0xb6b33aa8,0xb7773a73,0xb81a3a38,0xb87539f8
.long 0xb7063a92,0xb7d13a58,0xb84a3a17,0xb8a839d1,0xb7583a7c,0xb8153a3c,0xb87a39f5,0xb8d939a8,0xb7a93a64,0xb8413a1e,0xb8a839d1,0xb90a397d,0xb7f93a4b,0xb86b39ff,0xb8d539ac,0xb9383951
.long 0xb8243a32,0xb89539e0,0xb9013985,0xb9653923,0xb84a3a17,0xb8be39bf,0xb92c395d,0xb99138f4,0xb87039fc,0xb8e7399d,0xb9553934,0xb9bb38c3,0xb89539e0,0xb90e3979,0xb97d390a,0xb9e33891
.long 0xb8ba39c2,0xb9343955,0xb9a438de,0xba0a385d,0xb8de39a4,0xb9593930,0xb9ca38b1,0xba2f3828,0xb9013985,0xb97d390a,0xb9ee3883,0xba5237e5,0xb9233965,0xb9a038e2,0xba113854,0xba733777
.long 0xb8243a32,0xb87039fc,0xb8ba39c2,0xb9013985,0xb85d3a0a,0xb8ac39cd,0xb8f8398d,0xb9413949,0xb89539e0,0xb8e7399d,0xb9343955,0xb97d390a,0xb8cc39b3,0xb91f3969,0xb96d391b,0xb9b738c7
.long 0xb9013985,0xb9553934,0xb9a438de,0xb9ee3883,0xb9343955,0xb98938fd,0xb9d8389f,0xba21383c,0xb9653923,0xb9bb38c3,0xba0a385d,0xba5237e5,0xb99538ef,0xb9ea3888,0xba38381a,0xba7e374e
.long 0xb9c238ba,0xba17384a,0xba6437a9,0xbaa836b3,0xb9ee3883,0xba42380b,0xba8d371b,0xbacd3615,0xba17384a,0xba6a3795,0xbab23689,0xbaef3573,0xba3f3810,0xba8f3710,0xbad435f4,0xbb0d34ce
.long 0xba6437a9,0xbab23689,0xbaf3355d,0xbb283426,0xba87372f,0xbad235ff,0xbb0f34c3,0xbb3e32fa,0xbaa836b3,0xbaef3573,0xbb283426,0xbb5131a2,0xbac63635,0xbb0a34e4,0xbb3d3310,0xbb603048
.long 0xb9453945,0xb9853901,0xb9c238ba,0xb9fc3870,0xb9853901,0xb9c638b5,0xba033867,0xba3c3815,0xb9c238ba,0xba033867,0xba3f3810,0xba76376d,0xb9fc3870,0xba3c3815,0xba76376d,0xbaaa36a9
.long 0xba323824,0xba703781,0xbaa836b3,0xbad935df,0xba6437a9,0xbaa036d2,0xbad435f4,0xbb023510,0xba923706,0xbacb361f,0xbafc3531,0xbb25343d,0xbabc365f,0xbaf13568,0xbb1e346a,0xbb4132cc
.long 0xbae235b4,0xbb1334ad,0xbb3a333e,0xbb573118,0xbb043505,0xbb3033dc,0xbb5131a2,0xbb672ec0,0xbb213453,0xbb47325a,0xbb623003,0xbb702a94,0xbb3a333e,0xbb5a30d3,0xbb6d2cc0,0xbb7399da
.long 0xbb4f31d0,0xbb682e92,0xbb7325da,0xbb70ab4f,0xbb5f305f,0xbb702af2,0xbb72a750,0xbb66af1d,0xbb6a2dd8,0xbb731dda,0xbb6cad1d,0xbb55b146,0xbb7129d9,0xbb71a97c,0xbb60b031,0xbb3eb2fa
.long 0xba323824,0xba6437a9,0xba923706,0xbabc365f,0xba703781,0xbaa036d2,0xbacb361f,0xbaf13568,0xbaa836b3,0xbad435f4,0xbafc3531,0xbb1e346a,0xbad935df,0xbb023510,0xbb25343d,0xbb4132cc
.long 0xbb043505,0xbb283426,0xbb453288,0xbb5b30bc,0xbb283426,0xbb463271,0xbb5d308e,0xbb6c2d4c,0xbb453288,0xbb5d308e,0xbb6c2d1d,0xbb732463,0xbb5b30bc,0xbb6c2d4c,0xbb732463,0xbb71aa37
.long 0xbb6a2dd8,0xbb7325da,0xbb71a9d9,0xbb65af4c,0xbb722863,0xbb72a8c1,0xbb66aeef,0xbb50b1b9,0xbb73a5da,0xbb69ae35,0xbb53b174,0xbb31b3c6,0xbb6cad1d,0xbb58b101,0xbb37b36b,0xbb0ab4e4
.long 0xbb5fb05f,0xbb40b2e3,0xbb13b4ad,0xbad9b5df,0xbb4ab22c,0xbb1fb45f,0xbae7b59e,0xbaa0b6d2,0xbb2eb3f3,0xbaf8b547,0xbab2b689,0xba5eb7bd,0xbb0cb4d9,0xbac8b62a,0xba76b76d,0xba14b84f
.long 0xbae235b4,0xbb043505,0xbb213453,0xbb3a333e,0xbb1334ad,0xbb3033dc,0xbb47325a,0xbb5a30d3,0xbb3a333e,0xbb5131a2,0xbb623003,0xbb6d2cc0,0xbb573118,0xbb672ec0,0xbb702a94,0xbb7399da
.long 0xbb6a2dd8,0xbb722863,0xbb73a5da,0xbb6cad1d,0xbb7325da,0xbb72a8c1,0xbb69ae35,0xbb58b101,0xbb71a9d9,0xbb66aeef,0xbb53b174,0xbb37b36b,0xbb65af4c,0xbb50b1b9,0xbb31b3c6,0xbb0ab4e4
.long 0xbb4fb1d0,0xbb2eb3f3,0xbb04b505,0xbad0b60a,0xbb2eb3f3,0xbb02b510,0xbacbb61f,0xba8ab725,0xbb04b505,0xbacbb61f,0xba87b72f,0xba38b81a,0xbad0b60a,0xba8ab725,0xba38b81a,0xb9dcb89a
.long 0xba92b706,0xba3fb810,0xb9e0b895,0xb975b912,0xba4bb7f9,0xb9eab888,0xb97db90a,0xb905b981,0xb9fcb870,0xb98db8f8,0xb912b975,0xb88cb9e7,0xb9a4b8de,0xb927b961,0xb89fb9d8,0xb80bba42
.long 0xbb4f31d0,0xbb5f305f,0xbb6a2dd8,0xbb7129d9,0xbb682e92,0xbb702af2,0xbb731dda,0xbb71a97c,0xbb7325da,0xbb72a750,0xbb6cad1d,0xbb60b031,0xbb70ab4f,0xbb66af1d,0xbb55b146,0xbb3eb2fa
.long 0xbb5fb05f,0xbb4ab22c,0xbb2eb3f3,0xbb0cb4d9,0xbb40b2e3,0xbb1fb45f,0xbaf8b547,0xbac8b62a,0xbb13b4ad,0xbae7b59e,0xbab2b689,0xba76b76d,0xbad9b5df,0xbaa0b6d2,0xba5eb7bd,0xba14b84f
.long 0xba92b706,0xba4bb7f9,0xb9fcb870,0xb9a4b8de,0xba3fb810,0xb9eab888,0xb98db8f8,0xb927b961,0xb9e0b895,0xb97db90a,0xb912b975,0xb89fb9d8,0xb975b912,0xb905b981,0xb88cb9e7,0xb80bba42
.long 0xb901b985,0xb883b9ee,0xb7f9ba4b,0xb6ddba9d,0xb883b9ee,0xb7efba4f,0xb6c8baa2,0xb593bae9,0xb7f9ba4b,0xb6c8baa2,0xb588baeb,0xb43dbb25,0xb6ddba9d,0xb593bae9,0xb43dbb25,0xb1b9bb50
.long 0x3b73,0x3b73,0x3b73,0x3b73,0x29d93b71,0x2a373b71,0x2a943b70,0x2af23b70,0x2dd83b6a,0x2e353b69,0x2e923b68,0x2eef3b66,0x305f3b5f,0x30a53b5c,0x30ea3b59,0x312f3b56
.long 0x31d03b4f,0x322c3b4a,0x32883b45,0x32e33b40,0x333e3b3a,0x33af3b33,0x34103b2b,0x34483b23,0x34533b21,0x34963b17,0x34d93b0c,0x351b3b00,0x35053b04,0x35523af6,0x359e3ae7,0x35ea3ad7
.long 0x35b43ae2,0x360a3ad0,0x365f3abc,0x36b33aa8,0x365f3abc,0x36be3aa5,0x371b3a8d,0x37773a73,0x37063a92,0x376d3a76,0x37d13a58,0x381a3a38,0x37a93a64,0x380b3a42,0x38413a1e,0x387539f8
.long 0x38243a32,0x385d3a0a,0x389539e0,0x38cc39b3,0x387039fc,0x38ac39cd,0x38e7399d,0x391f3969,0x38ba39c2,0x38f8398d,0x39343955,0x396d391b,0x39013985,0x39413949,0x397d390a,0x39b738c7
.long 0x3b73,0x3b73,0x3b73,0x3b73,0x2b4f3b70,0x2bad3b6f,0x2c053b6f,0x2c343b6f,0x2f4c3b65,0x2fa93b63,0x30033b62,0x30313b60,0x31743b53,0x31b93b50,0x31fe3b4c,0x32433b49
.long 0x333e3b3a,0x33983b34,0x33f33b2e,0x34263b28,0x34803b1a,0x34b83b11,0x34ef3b08,0x35263afe,0x355d3af3,0x359e3ae7,0x35df3ad9,0x361f3acb,0x36353ac6,0x367f3ab5,0x36c83aa2,0x37103a8f
.long 0x37063a92,0x37583a7c,0x37a93a64,0x37f93a4b,0x37d13a58,0x38153a3c,0x38413a1e,0x386b39ff,0x384a3a17,0x387a39f5,0x38a839d1,0x38d539ac,0x38a839d1,0x38d939a8,0x390a397d,0x39383951
.long 0x39013985,0x39343955,0x39653923,0x399538ef,0x39553934,0x398938fd,0x39bb38c3,0x39ea3888,0x39a438de,0x39d8389f,0x3a0a385d,0x3a38381a,0x39ee3883,0x3a21383c,0x3a5237e5,0x3a7e374e
.long 0x3b73,0x3b73,0x3b73,0x3b73,0x2c623b6e,0x2c913b6e,0x2cc03b6d,0x2cee3b6d,0x305f3b5f,0x308e3b5d,0x30bc3b5b,0x30ea3b59,0x32883b45,0x32cc3b41,0x33103b3d,0x33543b39
.long 0x34533b21,0x34803b1a,0x34ad3b13,0x34d93b0c,0x355d3af3,0x35933ae9,0x35c93ade,0x35ff3ad2,0x365f3abc,0x369e3aad,0x36dd3a9d,0x371b3a8d,0x37583a7c,0x379f3a67,0x37e53a52,0x38153a3c
.long 0x38243a32,0x384a3a17,0x387039fc,0x389539e0,0x389539e0,0x38be39bf,0x38e7399d,0x390e3979,0x39013985,0x392c395d,0x39553934,0x397d390a,0x39653923,0x399138f4,0x39bb38c3,0x39e33891
.long 0x39c238ba,0x39ee3883,0x3a17384a,0x3a3f3810,0x3a17384a,0x3a42380b,0x3a6a3795,0x3a8f3710,0x3a6437a9,0x3a8d371b,0x3ab23689,0x3ad435f4,0x3aa836b3,0x3acd3615,0x3aef3573,0x3b0d34ce
.long 0x3b73,0x3b73,0x3b73,0x3b73,0x2d1d3b6c,0x2d4c3b6c,0x2d7a3b6b,0x2da93b6b,0x31183b57,0x31463b55,0x31743b53,0x31a23b51,0x33983b34,0x33dc3b30,0x34103b2b,0x34323b26
.long 0x35053b04,0x35313afc,0x355d3af3,0x35883aeb,0x36353ac6,0x366a3aba,0x369e3aad,0x36d23aa0,0x37583a7c,0x37953a6a,0x37d13a58,0x38063a45,0x38373a25,0x38593a0d,0x387a39f5,0x389a39dc
.long 0x38ba39c2,0x38de39a4,0x39013985,0x39233965,0x39343955,0x39593930,0x397d390a,0x39a038e2,0x39a438de,0x39ca38b1,0x39ee3883,0x3a113854,0x3a0a385d,0x3a2f3828,0x3a5237e5,0x3a733777
.long 0x3a6437a9,0x3a87372f,0x3aa836b3,0x3ac63635,0x3ab23689,0x3ad235ff,0x3aef3573,0x3b0a34e4,0x3af3355d,0x3b0f34c3,0x3b283426,0x3b3d3310,0x3b283426,0x3b3e32fa,0x3b5131a2,0x3b603048
.long 0x39453945,0x39853901,0x39c238ba,0x39fc3870,0x39853901,0x39c638b5,0x3a033867,0x3a3c3815,0x39c238ba,0x3a033867,0x3a3f3810,0x3a76376d,0x39fc3870,0x3a3c3815,0x3a76376d,0x3aaa36a9
.long 0x3a323824,0x3a703781,0x3aa836b3,0x3ad935df,0x3a6437a9,0x3aa036d2,0x3ad435f4,0x3b023510,0x3a923706,0x3acb361f,0x3afc3531,0x3b25343d,0x3abc365f,0x3af13568,0x3b1e346a,0x3b4132cc
.long 0x3ae235b4,0x3b1334ad,0x3b3a333e,0x3b573118,0x3b043505,0x3b3033dc,0x3b5131a2,0x3b672ec0,0x3b213453,0x3b47325a,0x3b623003,0x3b702a94,0x3b3a333e,0x3b5a30d3,0x3b6d2cc0,0x3b7399da
.long 0x3b4f31d0,0x3b682e92,0x3b7325da,0x3b70ab4f,0x3b5f305f,0x3b702af2,0x3b72a750,0x3b66af1d,0x3b6a2dd8,0x3b731dda,0x3b6cad1d,0x3b55b146,0x3b7129d9,0x3b71a97c,0x3b60b031,0x3b3eb2fa
.long 0x3a323824,0x3a6437a9,0x3a923706,0x3abc365f,0x3a703781,0x3aa036d2,0x3acb361f,0x3af13568,0x3aa836b3,0x3ad435f4,0x3afc3531,0x3b1e346a,0x3ad935df,0x3b023510,0x3b25343d,0x3b4132cc
.long 0x3b043505,0x3b283426,0x3b453288,0x3b5b30bc,0x3b283426,0x3b463271,0x3b5d308e,0x3b6c2d4c,0x3b453288,0x3b5d308e,0x3b6c2d1d,0x3b732463,0x3b5b30bc,0x3b6c2d4c,0x3b732463,0x3b71aa37
.long 0x3b6a2dd8,0x3b7325da,0x3b71a9d9,0x3b65af4c,0x3b722863,0x3b72a8c1,0x3b66aeef,0x3b50b1b9,0x3b73a5da,0x3b69ae35,0x3b53b174,0x3b31b3c6,0x3b6cad1d,0x3b58b101,0x3b37b36b,0x3b0ab4e4
.long 0x3b5fb05f,0x3b40b2e3,0x3b13b4ad,0x3ad9b5df,0x3b4ab22c,0x3b1fb45f,0x3ae7b59e,0x3aa0b6d2,0x3b2eb3f3,0x3af8b547,0x3ab2b689,0x3a5eb7bd,0x3b0cb4d9,0x3ac8b62a,0x3a76b76d,0x3a14b84f
.long 0x3ae235b4,0x3b043505,0x3b213453,0x3b3a333e,0x3b1334ad,0x3b3033dc,0x3b47325a,0x3b5a30d3,0x3b3a333e,0x3b5131a2,0x3b623003,0x3b6d2cc0,0x3b573118,0x3b672ec0,0x3b702a94,0x3b7399da
.long 0x3b6a2dd8,0x3b722863,0x3b73a5da,0x3b6cad1d,0x3b7325da,0x3b72a8c1,0x3b69ae35,0x3b58b101,0x3b71a9d9,0x3b66aeef,0x3b53b174,0x3b37b36b,0x3b65af4c,0x3b50b1b9,0x3b31b3c6,0x3b0ab4e4
.long 0x3b4fb1d0,0x3b2eb3f3,0x3b04b505,0x3ad0b60a,0x3b2eb3f3,0x3b02b510,0x3acbb61f,0x3a8ab725,0x3b04b505,0x3acbb61f,0x3a87b72f,0x3a38b81a,0x3ad0b60a,0x3a8ab725,0x3a38b81a,0x39dcb89a
.long 0x3a92b706,0x3a3fb810,0x39e0b895,0x3975b912,0x3a4bb7f9,0x39eab888,0x397db90a,0x3905b981,0x39fcb870,0x398db8f8,0x3912b975,0x388cb9e7,0x39a4b8de,0x3927b961,0x389fb9d8,0x380bba42
.long 0x3b4f31d0,0x3b5f305f,0x3b6a2dd8,0x3b7129d9,0x3b682e92,0x3b702af2,0x3b731dda,0x3b71a97c,0x3b7325da,0x3b72a750,0x3b6cad1d,0x3b60b031,0x3b70ab4f,0x3b66af1d,0x3b55b146,0x3b3eb2fa
.long 0x3b5fb05f,0x3b4ab22c,0x3b2eb3f3,0x3b0cb4d9,0x3b40b2e3,0x3b1fb45f,0x3af8b547,0x3ac8b62a,0x3b13b4ad,0x3ae7b59e,0x3ab2b689,0x3a76b76d,0x3ad9b5df,0x3aa0b6d2,0x3a5eb7bd,0x3a14b84f
.long 0x3a92b706,0x3a4bb7f9,0x39fcb870,0x39a4b8de,0x3a3fb810,0x39eab888,0x398db8f8,0x3927b961,0x39e0b895,0x397db90a,0x3912b975,0x389fb9d8,0x3975b912,0x3905b981,0x388cb9e7,0x380bba42
.long 0x3901b985,0x3883b9ee,0x37f9ba4b,0x36ddba9d,0x3883b9ee,0x37efba4f,0x36c8baa2,0x3593bae9,0x37f9ba4b,0x36c8baa2,0x3588baeb,0x343dbb25,0x36ddba9d,0x3593bae9,0x343dbb25,0x31b9bb50
.long 0xbdef3def,0xbdef3def,0xbdef3def,0xbdef3def,0xbdee3def,0xbde53deb,0xbdd33ddd,0xbdb93dc7,0xbdeb3def,0xbdc73ddd,0xbd853da9,0xbcbb3d37,0xbde53def,0xbd983dc7,0xbc3c3d37,0x3d62bcbb
.long 0xbddd3def,0xbd373da9,0x3d372304,0x3dddbda9,0xbdd33def,0xbc3c3d85,0x3db9bd37,0x3de5bdeb,0xbdc73def,0x3cbb3d37,0x3debbda9,0x3d85bddd,0xbdb93def,0x3d623cbb,0x3de5bddd,0xbc3cbd85
.long 0xbda93def,0x3da92304,0x3da9bdef,0xbda9a3c6,0xbd983def,0x3dd3bcbb,0x3d0bbddd,0xbdee3d85,0xbd853def,0x3debbd37,0xbcbbbda9,0xbdc73ddd,0xbd623def,0x3deebd85,0xbd98bd37,0xbd0b3deb
.long 0xbd373def,0x3dddbda9,0xbddda3c6,0x3d373da9,0xbd0b3def,0x3db9bdc7,0xbdee3d37,0x3dd33cbb,0xbcbb3def,0x3d85bddd,0xbdc73da9,0x3debbd37,0xbc3c3def,0x3d0bbdeb,0xbd623ddd,0x3d98bdc7
.long 0xbdef3def,0xbdef3def,0xbdef3def,0xbdef3def,0xbd983da9,0xbd623d85,0xbd0b3d37,0xbc3c3cbb,0x3cbb2304,0x3d85bd37,0x3dc7bda9,0x3debbddd,0x3dd3bda9,0x3deebdeb,0x3db9bddd,0x3d0bbd85
.long 0x3dddbdef,0x3d37bda9,0xbd37a3c6,0xbddd3da9,0x3d0bbda9,0xbd983cbb,0xbdee3ddd,0xbd623dc7,0xbd85a3c6,0xbdeb3ddd,0xbcbb3da9,0x3dc7bd37,0xbdee3da9,0xbd0b3dc7,0x3dd3bd37,0x3d98bdeb
.long 0xbda93def,0x3da92304,0x3da9bdef,0xbda9a3c6,0x3c3c3da9,0x3de5bdc7,0xbd62bd37,0xbdb93deb,0x3dc72304,0x3cbbbddd,0xbdeb3da9,0x3d853d37,0x3de5bda9,0xbdb9bcbb,0xbc3c3ddd,0x3dd3bdc7
.long 0x3d37bdef,0xbddd3da9,0x3ddd2304,0xbd37bda9,0xbd62bda9,0xbc3c3deb,0x3d98bddd,0xbde53d85,0xbdeba3c6,0x3dc73d37,0xbd85bda9,0x3cbb3ddd,0xbdb93da9,0x3dd3bd85,0xbde53d37,0x3deebcbb
.long 0xbdef3def,0xbdef3def,0xbdef3def,0xbdef3def,0x3c3c2304,0x3d0bbcbb,0x3d62bd37,0x3d98bd85,0x3debbdef,0x3dc7bddd,0x3d85bda9,0x3cbbbd37,0xbd0ba3c6,0xbdb93d85,0xbdee3ddd,0xbdd33deb
.long 0xbddd3def,0xbd373da9,0x3d372304,0x3dddbda9,0x3d622304,0x3deebdc7,0x3d98bddd,0xbd0bbcbb,0x3dc7bdef,0xbcbbbd37,0xbdeb3da9,0xbd853ddd,0xbd98a3c6,0xbdd33deb,0x3d0b3d37,0x3deebdc7
.long 0xbda93def,0x3da92304,0x3da9bdef,0xbda9a3c6,0x3db92304,0x3d62bdeb,0xbde53d37,0xbc3c3dc7,0x3d85bdef,0xbdeb3d37,0x3cbb3da9,0x3dc7bddd,0xbdd3a3c6,0x3c3c3dc7,0x3db9bddd,0xbde53cbb
.long 0xbd373def,0x3dddbda9,0xbddda3c6,0x3d373da9,0x3de52304,0xbd98bd85,0x3c3c3ddd,0x3d62bdeb,0x3cbbbdef,0xbd853ddd,0x3dc7bda9,0xbdeb3d37,0xbdeea3c6,0x3de53cbb,0xbdd3bd37,0x3db93d85
.long 0xbdef3def,0xbdef3def,0xbdef3def,0xbdef3def,0x3db9bda9,0x3dd3bdc7,0x3de5bddd,0x3deebdeb,0xbcbba3c6,0xbd853d37,0xbdc73da9,0xbdeb3ddd,0xbd623da9,0x3c3c3cbb,0x3d98bd37,0x3de5bdc7
.long 0x3dddbdef,0x3d37bda9,0xbd37a3c6,0xbddd3da9,0xbde53da9,0xbdb93deb,0x3c3c3d37,0x3dd3bd85,0x3d852304,0x3debbddd,0x3cbbbda9,0xbdc73d37,0x3c3cbda9,0xbde53d85,0xbd623ddd,0x3db9bcbb
.long 0xbda93def,0x3da92304,0x3da9bdef,0xbda9a3c6,0x3deebda9,0xbd0bbd85,0xbdd33ddd,0x3d983cbb,0xbdc7a3c6,0xbcbb3ddd,0x3debbda9,0xbd85bd37,0x3d0b3da9,0x3d98bdeb,0xbdee3d37,0x3d623d85
.long 0x3d37bdef,0xbddd3da9,0x3ddd2304,0xbd37bda9,0xbdd33da9,0x3deebcbb,0xbdb9bd37,0x3d0b3dc7,0x3deb2304,0xbdc7bd37,0x3d853da9,0xbcbbbddd,0xbd98bda9,0x3d623dc7,0xbd0bbddd,0x3c3c3deb
.long 0xa3840000,0xa3840000,0xa3840000,0xa3840000,0x3c3c0000,0x3d0bbcbb,0x3d62bd37,0x3d98bd85,0x3cbb0000,0x3d85bd37,0x3dc7bda9,0x3debbddd,0x3d0b0000,0x3db9bd85,0x3deebddd,0x3dd3bdeb
.long 0x3d370000,0x3dddbda9,0x3dddbdef,0x3d37bda9,0x3d620000,0x3deebdc7,0x3d98bddd,0xbd0bbcbb,0x3d850000,0x3debbddd,0x3cbbbda9,0xbdc73d37,0x3d980000,0x3dd3bdeb,0xbd0bbd37,0xbdee3dc7
.long 0x3da90000,0x3da9bdef,0xbda9a384,0xbda93def,0x3db90000,0x3d62bdeb,0xbde53d37,0xbc3c3dc7,0x3dc70000,0x3cbbbddd,0xbdeb3da9,0x3d853d37,0x3dd30000,0xbc3cbdc7,0xbdb93ddd,0x3de5bcbb
.long 0x3ddd0000,0xbd37bda9,0xbd373def,0x3dddbda9,0x3de50000,0xbd98bd85,0x3c3c3ddd,0x3d62bdeb,0x3deb0000,0xbdc7bd37,0x3d853da9,0xbcbbbddd,0x3dee0000,0xbde5bcbb,0x3dd33d37,0xbdb9bd85
.long 0xa3840000,0xa3840000,0xa3840000,0xa3840000,0x3db9bda9,0x3dd3bdc7,0x3de5bddd,0x3deebdeb,0x3debbdef,0x3dc7bddd,0x3d85bda9,0x3cbbbd37,0x3d62bda9,0xbc3cbcbb,0xbd983d37,0xbde53dc7
.long 0xbd37a384,0xbddd3da9,0xbddd3def,0xbd373da9,0xbde53da9,0xbdb93deb,0x3c3c3d37,0x3dd3bd85,0xbdc73def,0x3cbb3d37,0x3debbda9,0x3d85bddd,0xbc3c3da9,0x3de5bd85,0x3d62bddd,0xbdb93cbb
.long 0x3da90000,0x3da9bdef,0xbda9a384,0xbda93def,0x3deebda9,0xbd0bbd85,0xbdd33ddd,0x3d983cbb,0x3d85bdef,0xbdeb3d37,0x3cbb3da9,0x3dc7bddd,0xbd0bbda9,0xbd983deb,0x3deebd37,0xbd62bd85
.long 0xbddda384,0x3d373da9,0x3d37bdef,0xbddd3da9,0xbdd33da9,0x3deebcbb,0xbdb9bd37,0x3d0b3dc7,0xbcbb3def,0x3d85bddd,0xbdc73da9,0x3debbd37,0x3d983da9,0xbd62bdc7,0x3d0b3ddd,0xbc3cbdeb
.long 0xa3840000,0xa3840000,0xa3840000,0xa3840000,0x3deebdef,0x3de5bdeb,0x3dd3bddd,0x3db9bdc7,0xbcbba384,0xbd853d37,0xbdc73da9,0xbdeb3ddd,0xbde53def,0xbd983dc7,0xbc3c3d37,0x3d62bcbb
.long 0x3d370000,0x3dddbda9,0x3dddbdef,0x3d37bda9,0x3dd3bdef,0x3c3cbd85,0xbdb93d37,0xbde53deb,0xbd85a384,0xbdeb3ddd,0xbcbb3da9,0x3dc7bd37,0xbdb93def,0x3d623cbb,0x3de5bddd,0xbc3cbd85
.long 0x3da90000,0x3da9bdef,0xbda9a384,0xbda93def,0x3d98bdef,0xbdd33cbb,0xbd0b3ddd,0x3deebd85,0xbdc7a384,0xbcbb3ddd,0x3debbda9,0xbd85bd37,0xbd623def,0x3deebd85,0xbd98bd37,0xbd0b3deb
.long 0x3ddd0000,0xbd37bda9,0xbd373def,0x3dddbda9,0x3d0bbdef,0xbdb93dc7,0x3deebd37,0xbdd3bcbb,0xbdeba384,0x3dc73d37,0xbd85bda9,0x3cbb3ddd,0xbc3c3def,0x3d0bbdeb,0xbd623ddd,0x3d98bdc7
.long 0xa3840000,0xa3840000,0xa3840000,0xa3840000,0x3d98bda9,0x3d62bd85,0x3d0bbd37,0x3c3cbcbb,0xbdeb3def,0xbdc73ddd,0xbd853da9,0xbcbb3d37,0x3dd3bda9,0x3deebdeb,0x3db9bddd,0x3d0bbd85
.long 0xbd37a384,0xbddd3da9,0xbddd3def,0xbd373da9,0xbd0b3da9,0x3d98bcbb,0x3deebddd,0x3d62bdc7,0x3dc7bdef,0xbcbbbd37,0xbdeb3da9,0xbd853ddd,0xbdee3da9,0xbd0b3dc7,0x3dd3bd37,0x3d98bdeb
.long 0x3da90000,0x3da9bdef,0xbda9a384,0xbda93def,0xbc3cbda9,0xbde53dc7,0x3d623d37,0x3db9bdeb,0xbd853def,0x3debbd37,0xbcbbbda9,0xbdc73ddd,0x3de5bda9,0xbdb9bcbb,0xbc3c3ddd,0x3dd3bdc7
.long 0xbddda384,0x3d373da9,0x3d37bdef,0xbddd3da9,0x3d623da9,0x3c3cbdeb,0xbd983ddd,0x3de5bd85,0x3cbbbdef,0xbd853ddd,0x3dc7bda9,0xbdeb3d37,0xbdb93da9,0x3dd3bd85,0xbde53d37,0x3deebcbb
.long 0x3e503e50,0x3e503e50,0x3e503e50,0x3e503e50,0x3e4c3e50,0x3e2d3e40,0xbe4cbe50,0xbe2dbe40,0x3e403e50,0x3d9f3e13,0x3e403e50,0x3d9f3e13,0x3e2d3e50,0xbd223d9f,0xbe2dbe50,0x3d22bd9f
.long 0x3e133e50,0xbe132365,0x3e133e50,0xbe132365,0x3de73e50,0xbe4cbd9f,0xbde7be50,0x3e4c3d9f,0x3d9f3e50,0xbe40be13,0x3d9f3e50,0xbe40be13,0x3d223e50,0xbde7be40,0xbd22be50,0x3de73e40
.long 0x23653e50,0xa42cbe50,0x23653e50,0xa42cbe50,0xbd223e50,0x3de7be40,0x3d22be50,0xbde73e40,0xbd9f3e50,0x3e40be13,0xbd9f3e50,0x3e40be13,0xbde73e50,0x3e4cbd9f,0x3de7be50,0xbe4c3d9f
.long 0xbe133e50,0x3e13a42c,0xbe133e50,0x3e13a42c,0xbe2d3e50,0x3d223d9f,0x3e2dbe50,0xbd22bd9f,0xbe403e50,0xbd9f3e13,0xbe403e50,0xbd9f3e13,0xbe4c3e50,0xbe2d3e40,0x3e4cbe50,0x3e2dbe40
.long 0x3e503e50,0x3e503e50,0x3e503e50,0x3e503e50,0x3de73e13,0x3d223d9f,0xbde7be13,0xbd22bd9f,0xbd9f2365,0xbe40be13,0xbd9f2365,0xbe40be13,0xbe4cbe13,0xbde7be40,0x3e4c3e13,0x3de73e40
.long 0xbe13be50,0x3e13a42c,0xbe13be50,0x3e13a42c,0x3d22be13,0x3e2d3e40,0xbd223e13,0xbe2dbe40,0x3e40a42c,0xbd9f3e13,0x3e40a42c,0xbd9f3e13,0x3e2d3e13,0xbe4cbd9f,0xbe2dbe13,0x3e4c3d9f
.long 0x23653e50,0xa42cbe50,0x23653e50,0xa42cbe50,0xbe2d3e13,0x3e4cbd9f,0x3e2dbe13,0xbe4c3d9f,0xbe402365,0x3d9f3e13,0xbe402365,0x3d9f3e13,0xbd22be13,0xbe2d3e40,0x3d223e13,0x3e2dbe40
.long 0x3e13be50,0xbe132365,0x3e13be50,0xbe132365,0x3e4cbe13,0x3de7be40,0xbe4c3e13,0xbde73e40,0x3d9fa42c,0x3e40be13,0x3d9fa42c,0x3e40be13,0xbde73e13,0xbd223d9f,0x3de7be13,0x3d22bd9f
.long 0x3e503e50,0x3e503e50,0x3e503e50,0x3e503e50,0xbd222365,0xbde7bd9f,0x3d22a42c,0x3de73d9f,0xbe40be50,0xbd9fbe13,0xbe40be50,0xbd9fbe13,0x3de7a42c,0x3e4c3e40,0xbde72365,0xbe4cbe40
.long 0x3e133e50,0xbe132365,0x3e133e50,0xbe132365,0xbe2d2365,0xbd22be40,0x3e2da42c,0x3d223e40,0xbd9fbe50,0x3e403e13,0xbd9fbe50,0x3e403e13,0x3e4ca42c,0xbe2d3d9f,0xbe4c2365,0x3e2dbd9f
.long 0x23653e50,0xa42cbe50,0x23653e50,0xa42cbe50,0xbe4c2365,0x3e2d3d9f,0x3e4ca42c,0xbe2dbd9f,0x3d9fbe50,0xbe403e13,0x3d9fbe50,0xbe403e13,0x3e2da42c,0x3d22be40,0xbe2d2365,0xbd223e40
.long 0xbe133e50,0x3e13a42c,0xbe133e50,0x3e13a42c,0xbde72365,0xbe4c3e40,0x3de7a42c,0x3e4cbe40,0x3e40be50,0x3d9fbe13,0x3e40be50,0x3d9fbe13,0x3d22a42c,0x3de7bd9f,0xbd222365,0xbde73d9f
.long 0x3e503e50,0x3e503e50,0x3e503e50,0x3e503e50,0xbe2dbe13,0xbe4cbe40,0x3e2d3e13,0x3e4c3e40,0x3d9fa42c,0x3e403e13,0x3d9fa42c,0x3e403e13,0x3d223e13,0xbe2dbd9f,0xbd22be13,0x3e2d3d9f
.long 0xbe13be50,0x3e13a42c,0xbe13be50,0x3e13a42c,0x3e4c3e13,0xbde73d9f,0xbe4cbe13,0x3de7bd9f,0xbe402365,0x3d9fbe13,0xbe402365,0x3d9fbe13,0x3de7be13,0xbd223e40,0xbde73e13,0x3d22be40
.long 0x23653e50,0xa42cbe50,0x23653e50,0xa42cbe50,0xbde7be13,0x3d223e40,0x3de73e13,0xbd22be40,0x3e40a42c,0xbd9fbe13,0x3e40a42c,0xbd9fbe13,0xbe4c3e13,0x3de73d9f,0x3e4cbe13,0xbde7bd9f
.long 0x3e13be50,0xbe132365,0x3e13be50,0xbe132365,0xbd223e13,0x3e2dbd9f,0x3d22be13,0xbe2d3d9f,0xbd9f2365,0xbe403e13,0xbd9f2365,0xbe403e13,0x3e2dbe13,0x3e4cbe40,0xbe2d3e13,0xbe4c3e40
.long 0x0,0x0,0x0,0x0,0xbd220000,0xbde7bd9f,0x3d22a3e5,0x3de73d9f,0xbd9f0000,0xbe40be13,0xbd9f0000,0xbe40be13,0xbde70000,0xbe4cbe40,0x3de7a3e5,0x3e4c3e40
.long 0xbe130000,0xbe13be50,0xbe130000,0xbe13be50,0xbe2d0000,0xbd22be40,0x3e2da3e5,0x3d223e40,0xbe400000,0x3d9fbe13,0xbe400000,0x3d9fbe13,0xbe4c0000,0x3e2dbd9f,0x3e4ca3e5,0xbe2d3d9f
.long 0xbe500000,0x3e50a3e5,0xbe500000,0x3e50a3e5,0xbe4c0000,0x3e2d3d9f,0x3e4ca3e5,0xbe2dbd9f,0xbe400000,0x3d9f3e13,0xbe400000,0x3d9f3e13,0xbe2d0000,0xbd223e40,0x3e2da3e5,0x3d22be40
.long 0xbe130000,0xbe133e50,0xbe130000,0xbe133e50,0xbde70000,0xbe4c3e40,0x3de7a3e5,0x3e4cbe40,0xbd9f0000,0xbe403e13,0xbd9f0000,0xbe403e13,0xbd220000,0xbde73d9f,0x3d22a3e5,0x3de7bd9f
.long 0x0,0x0,0x0,0x0,0xbe2dbe13,0xbe4cbe40,0x3e2d3e13,0x3e4c3e40,0xbe40be50,0xbd9fbe13,0xbe40be50,0xbd9fbe13,0xbd22be13,0x3e2d3d9f,0x3d223e13,0xbe2dbd9f
.long 0x3e13a3e5,0x3e133e50,0x3e13a3e5,0x3e133e50,0x3e4c3e13,0xbde73d9f,0xbe4cbe13,0x3de7bd9f,0x3d9f3e50,0xbe40be13,0x3d9f3e50,0xbe40be13,0xbde73e13,0x3d22be40,0x3de7be13,0xbd223e40
.long 0xbe500000,0x3e50a3e5,0xbe500000,0x3e50a3e5,0xbde7be13,0x3d223e40,0x3de73e13,0xbd22be40,0x3d9fbe50,0xbe403e13,0x3d9fbe50,0xbe403e13,0x3e4cbe13,0xbde7bd9f,0xbe4c3e13,0x3de73d9f
.long 0x3e13a3e5,0x3e13be50,0x3e13a3e5,0x3e13be50,0xbd223e13,0x3e2dbd9f,0x3d22be13,0xbe2d3d9f,0xbe403e50,0xbd9f3e13,0xbe403e50,0xbd9f3e13,0xbe2d3e13,0xbe4c3e40,0x3e2dbe13,0x3e4cbe40
.long 0x0,0x0,0x0,0x0,0xbe4cbe50,0xbe2dbe40,0x3e4c3e50,0x3e2d3e40,0x3d9fa3e5,0x3e403e13,0x3d9fa3e5,0x3e403e13,0x3e2d3e50,0xbd223d9f,0xbe2dbe50,0x3d22bd9f
.long 0xbe130000,0xbe13be50,0xbe130000,0xbe13be50,0xbde7be50,0x3e4c3d9f,0x3de73e50,0xbe4cbd9f,0x3e40a3e5,0xbd9f3e13,0x3e40a3e5,0xbd9f3e13,0x3d223e50,0xbde7be40,0xbd22be50,0x3de73e40
.long 0xbe500000,0x3e50a3e5,0xbe500000,0x3e50a3e5,0x3d22be50,0xbde73e40,0xbd223e50,0x3de7be40,0x3e40a3e5,0xbd9fbe13,0x3e40a3e5,0xbd9fbe13,0xbde73e50,0x3e4cbd9f,0x3de7be50,0xbe4c3d9f
.long 0xbe130000,0xbe133e50,0xbe130000,0xbe133e50,0x3e2dbe50,0xbd22bd9f,0xbe2d3e50,0x3d223d9f,0x3d9fa3e5,0x3e40be13,0x3d9fa3e5,0x3e40be13,0xbe4c3e50,0xbe2d3e40,0x3e4cbe50,0x3e2dbe40
.long 0x0,0x0,0x0,0x0,0xbde7be13,0xbd22bd9f,0x3de73e13,0x3d223d9f,0x3e403e50,0x3d9f3e13,0x3e403e50,0x3d9f3e13,0xbe4cbe13,0xbde7be40,0x3e4c3e13,0x3de73e40
.long 0x3e13a3e5,0x3e133e50,0x3e13a3e5,0x3e133e50,0xbd223e13,0xbe2dbe40,0x3d22be13,0x3e2d3e40,0xbd9fbe50,0x3e403e13,0xbd9fbe50,0x3e403e13,0x3e2d3e13,0xbe4cbd9f,0xbe2dbe13,0x3e4c3d9f
.long 0xbe500000,0x3e50a3e5,0xbe500000,0x3e50a3e5,0x3e2dbe13,0xbe4c3d9f,0xbe2d3e13,0x3e4cbd9f,0xbd9f3e50,0x3e40be13,0xbd9f3e50,0x3e40be13,0xbd22be13,0xbe2d3e40,0x3d223e13,0x3e2dbe40
.long 0x3e13a3e5,0x3e13be50,0x3e13a3e5,0x3e13be50,0xbe4c3e13,0xbde73e40,0x3e4cbe13,0x3de7be40,0x3e40be50,0x3d9fbe13,0x3e40be50,0x3d9fbe13,0xbde73e13,0xbd223d9f,0x3de7be13,0x3d22bd9f
.long 0x3b73,0xadd83b6a,0xb1d03b4f,0xb4533b21,0x3b73,0xae063b6a,0xb1fe3b4c,0xb4753b1c,0x3b73,0xae353b69,0xb22c3b4a,0xb4963b17,0x3b73,0xae633b68,0xb25a3b47,0xb4b83b11
.long 0x3b73,0xae923b68,0xb2883b45,0xb4d93b0c,0x3b73,0xaec03b67,0xb2b53b42,0xb4fa3b06,0x3b73,0xaeef3b66,0xb2e33b40,0xb51b3b00,0x3b73,0xaf1d3b66,0xb3103b3d,0xb53c3afa
.long 0x3b73,0xaf4c3b65,0xb33e3b3a,0xb55d3af3,0x3b73,0xaf7a3b64,0xb36b3b37,0xb57e3aed,0x3b73,0xafa93b63,0xb3983b34,0xb59e3ae7,0x3b73,0xafd73b63,0xb3c63b31,0xb5bf3ae0
.long 0x3b73,0xb0033b62,0xb3f33b2e,0xb5df3ad9,0x3b73,0xb01a3b61,0xb4103b2b,0xb5ff3ad2,0x3b73,0xb0313b60,0xb4263b28,0xb61f3acb,0x3b73,0xb0483b60,0xb43d3b25,0xb63f3ac4
.long 0xb5b43ae2,0xb7063a92,0xb8243a32,0xb8ba39c2,0xb5df3ad9,0xb73a3a84,0xb8413a1e,0xb8d939a8,0xb60a3ad0,0xb76d3a76,0xb85d3a0a,0xb8f8398d,0xb6353ac6,0xb79f3a67,0xb87a39f5,0xb9163971
.long 0xb65f3abc,0xb7d13a58,0xb89539e0,0xb9343955,0xb6893ab2,0xb8013a48,0xb8b139ca,0xb9513938,0xb6b33aa8,0xb81a3a38,0xb8cc39b3,0xb96d391b,0xb6dd3a9d,0xb8323a28,0xb8e7399d,0xb98938fd
.long 0xb7063a92,0xb84a3a17,0xb9013985,0xb9a438de,0xb72f3a87,0xb8623a06,0xb91b396d,0xb9bf38be,0xb7583a7c,0xb87a39f5,0xb9343955,0xb9d8389f,0xb7813a70,0xb89139e3,0xb94d393c,0xb9f1387e
.long 0xb7a93a64,0xb8a839d1,0xb9653923,0xba0a385d,0xb7d13a58,0xb8be39bf,0xb97d390a,0xba21383c,0xb7f93a4b,0xb8d539ac,0xb99538ef,0xba38381a,0xb8103a3f,0xb8eb3999,0xb9ac38d5,0xba4f37ef
.long 0xb9453945,0xb9c238ba,0xba323824,0xba923706,0xb9653923,0xb9e33891,0xba5237e5,0xbaaf3694,0xb9853901,0xba033867,0xba703781,0xbacb361f,0xb9a438de,0xba21383c,0xba8d371b,0xbae435a9
.long 0xb9c238ba,0xba3f3810,0xbaa836b3,0xbafc3531,0xb9e03895,0xba5b37c7,0xbac1364a,0xbb1134b8,0xb9fc3870,0xba76376d,0xbad935df,0xbb25343d,0xba17384a,0xba8f3710,0xbaef3573,0xbb363382
.long 0xba323824,0xbaa836b3,0xbb043505,0xbb453288,0xba4b37f9,0xbabf3654,0xbb173496,0xbb52318b,0xba6437a9,0xbad435f4,0xbb283426,0xbb5d308e,0xba7c3758,0xbae93593,0xbb37336b,0xbb662f1d
.long 0xba923706,0xbafc3531,0xbb453288,0xbb6c2d1d,0xbaa836b3,0xbb0d34ce,0xbb5131a2,0xbb712a37,0xbabc365f,0xbb1e346a,0xbb5b30bc,0xbb732463,0xbad0360a,0xbb2d3405,0xbb632fa9,0xbb73a350
.long 0xbae235b4,0xbb213453,0xbb4f31d0,0xbb6a2dd8,0xbafc3531,0xbb363382,0xbb5d308e,0xbb712a37,0xbb1334ad,0xbb47325a,0xbb682e92,0xbb731dda,0xbb283426,0xbb56312f,0xbb6f2c05,0xbb72a8c1
.long 0xbb3a333e,0xbb623003,0xbb7325da,0xbb6cad1d,0xbb4a322c,0xbb6b2da9,0xbb73a463,0xbb63afd7,0xbb573118,0xbb702a94,0xbb70ab4f,0xbb55b146,0xbb623003,0xbb732350,0xbb69ae35,0xbb44b29e
.long 0xbb6a2dd8,0xbb73a5da,0xbb5fb05f,0xbb2eb3f3,0xbb702b4f,0xbb6fabad,0xbb51b1a2,0xbb15b4a1,0xbb7325da,0xbb69ae35,0xbb40b2e3,0xbaf8b547,0xbb73a1da,0xbb60b048,0xbb2bb410,0xbad7b5ea
.long 0xbb71a9d9,0xbb53b174,0xbb13b4ad,0xbab2b689,0xbb6cad1d,0xbb44b29e,0xbaf8b547,0xba8ab725,0xbb65af4c,0xbb31b3c6,0xbad9b5df,0xba5eb7bd,0xbb5bb0bc,0xbb1cb475,0xbab7b674,0xba2fb828
.long 0xbb730000,0xbb6aadd8,0xbb4fb1d0,0xbb21b453,0xbb71a9d9,0xbb5eb077,0xbb37b36b,0xbafeb526,0xbb6aadd8,0xbb4cb1fe,0xbb1ab480,0xbad4b5f4,0xbb5fb05f,0xbb36b382,0xbaf8b547,0xbaa5b6be
.long 0xbb4fb1d0,0xbb1ab480,0xbad0b60a,0xba70b781,0xbb3ab33e,0xbafab53c,0xbaa2b6c8,0xba35b81f,0xbb21b453,0xbad4b5f4,0xba70b781,0xb9f5b87a,0xbb04b505,0xbaaab6a9,0xba38b81a,0xb9b0b8d0
.long 0xbae2b5b4,0xba7cb758,0xb9fcb870,0xb965b923,0xbabcb65f,0xba48b801,0xb9bbb8c3,0xb916b971,0xba92b706,0xba11b854,0xb975b912,0xb8c3b9bb,0xba64b7a9,0xb9d5b8a3,0xb92cb95d,0xb86bb9ff
.long 0xba32b824,0xb995b8ef,0xb8deb9a4,0xb810ba3f,0xb9fcb870,0xb951b938,0xb88cb9e7,0xb762ba79,0xb9c2b8ba,0xb90ab97d,0xb837ba25,0xb69ebaad,0xb985b901,0xb8beb9bf,0xb7bdba5e,0xb5d4badb
.long 0xbae2b5b4,0xba92b706,0xba32b824,0xb9c2b8ba,0xbab2b689,0xba55b7db,0xb9e7b88c,0xb969b91f,0xba7cb758,0xba11b854,0xb995b8ef,0xb90ab97d,0xba3fb810,0xb9c6b8b5,0xb93cb94d,0xb8a3b9d5
.long 0xb9fcb870,0xb975b912,0xb8deb9a4,0xb837ba25,0xb9b3b8cc,0xb91fb969,0xb87ab9f5,0xb78bba6d,0xb965b923,0xb8c3b9bb,0xb810ba3f,0xb69ebaad,0xb912b975,0xb862ba06,0xb744ba81,0xb5a9bae4
.long 0xb8bab9c2,0xb7f9ba4b,0xb65fbabc,0xb4adbb13,0xb85dba0a,0xb725ba8a,0xb573baef,0xb354bb39,0xb7f9ba4b,0xb64abac1,0xb480bb1a,0xb146bb55,0xb72fba87,0xb568baf1,0xb310bb3d,0xae63bb68
.long 0xb65fbabc,0xb480bb1a,0xb118bb57,0xa863bb72,0xb588baeb,0xb327bb3c,0xae35bb69,0x2806bb72,0xb4adbb13,0xb146bb55,0xa863bb72,0x2e35bb69,0xb398bb34,0xaec0bb67,0x2750bb72,0x312fbb56
.long 0xb945b945,0xb8bab9c2,0xb824ba32,0xb706ba92,0xb8deb9a4,0xb845ba1b,0xb744ba81,0xb5eabad7,0xb870b9fc,0xb795ba6a,0xb635bac6,0xb4c3bb0f,0xb7f9ba4b,0xb694baaf,0xb51bbb00,0xb327bb3c
.long 0xb706ba92,0xb588baeb,0xb3f3bb2e,0xb0bcbb5b,0xb60abad0,0xb475bb1c,0xb1a2bb51,0xac91bb6e,0xb505bb04,0xb2b5bb42,0xae92bb68,0x1ddabb73,0xb3f3bb2e,0xb077bb5e,0xa750bb72,0x2d4cbb6c
.long 0xb1d0bb4f,0xac62bb6e,0x29d9bb71,0x3118bb57,0xaf4cbb65,0x19dabb73,0x2fa9bb63,0x3382bb36,0xa9d9bb71,0x2cc0bb6d,0x322cbb4a,0x34efbb08,0x25dabb73,0x30a5bb5c,0x343dbb25,0x3615bacd
.long 0x2dd8bb6a,0x32e3bb40,0x355dbaf3,0x372fba87,0x3118bb57,0x348bbb18,0x3674bab7,0x381fba35,0x333ebb3a,0x359ebae7,0x3781ba70,0x389fb9d8,0x34adbb13,0x36a9baaa,0x3841ba1e,0x3916b971
.long 0xb5b4bae2,0xb453bb21,0xb1d0bb4f,0xadd8bb6a,0xb480bb1a,0xb215bb4b,0xae35bb69,0x99dabb73,0xb288bb45,0xaeefbb66,0xa1dabb73,0x2d7abb6b,0xb003bb62,0xa695bb73,0x2cc0bb6d,0x318bbb52
.long 0xa9d9bb71,0x2b4fbb70,0x3118bb57,0x3426bb28,0x2863bb72,0x3077bb5e,0x33c6bb31,0x357ebaed,0x2f4cbb65,0x3310bb3d,0x3531bafc,0x36c8baa2,0x322cbb4a,0x34cebb0d,0x3674bab7,0x3801ba48
.long 0x3453bb21,0x360abad0,0x37a9ba64,0x3895b9e0,0x3588baeb,0x373aba84,0x3867ba03,0x391fb969,0x36b3baa8,0x382dba2b,0x38efb995,0x399db8e7,0x37d1ba58,0x38b5b9c6,0x396db91b,0x3a0db859
.long 0x3870b9fc,0x3934b955,0x39e0b895,0x3a70b781,0x38efb995,0x39a8b8d9,0x3a45b806,0x3ac4b63f,0x3965b923,0x3a11b854,0x3a9db6dd,0x3b08b4ef,0x39d1b8a8,0x3a6db78b,0x3ae7b59e,0x3b3cb327
.long 0x3b73,0x3b73,0x3b73,0x3b73,0x2dd83b6a,0x2e063b6a,0x2e353b69,0x2e633b68,0x31d03b4f,0x31fe3b4c,0x322c3b4a,0x325a3b47,0x34533b21,0x34753b1c,0x34963b17,0x34b83b11
.long 0x35b43ae2,0x35df3ad9,0x360a3ad0,0x36353ac6,0x37063a92,0x373a3a84,0x376d3a76,0x379f3a67,0x38243a32,0x38413a1e,0x385d3a0a,0x387a39f5,0x38ba39c2,0x38d939a8,0x38f8398d,0x39163971
.long 0x39453945,0x39653923,0x39853901,0x39a438de,0x39c238ba,0x39e33891,0x3a033867,0x3a21383c,0x3a323824,0x3a5237e5,0x3a703781,0x3a8d371b,0x3a923706,0x3aaf3694,0x3acb361f,0x3ae435a9
.long 0x3ae235b4,0x3afc3531,0x3b1334ad,0x3b283426,0x3b213453,0x3b363382,0x3b47325a,0x3b56312f,0x3b4f31d0,0x3b5d308e,0x3b682e92,0x3b6f2c05,0x3b6a2dd8,0x3b712a37,0x3b731dda,0x3b72a8c1
.long 0x3b73,0x3b73,0x3b73,0x3b73,0x2e923b68,0x2ec03b67,0x2eef3b66,0x2f1d3b66,0x32883b45,0x32b53b42,0x32e33b40,0x33103b3d,0x34d93b0c,0x34fa3b06,0x351b3b00,0x353c3afa
.long 0x365f3abc,0x36893ab2,0x36b33aa8,0x36dd3a9d,0x37d13a58,0x38013a48,0x381a3a38,0x38323a28,0x389539e0,0x38b139ca,0x38cc39b3,0x38e7399d,0x39343955,0x39513938,0x396d391b,0x398938fd
.long 0x39c238ba,0x39e03895,0x39fc3870,0x3a17384a,0x3a3f3810,0x3a5b37c7,0x3a76376d,0x3a8f3710,0x3aa836b3,0x3ac1364a,0x3ad935df,0x3aef3573,0x3afc3531,0x3b1134b8,0x3b25343d,0x3b363382
.long 0x3b3a333e,0x3b4a322c,0x3b573118,0x3b623003,0x3b623003,0x3b6b2da9,0x3b702a94,0x3b732350,0x3b7325da,0x3b73a463,0x3b70ab4f,0x3b69ae35,0x3b6cad1d,0x3b63afd7,0x3b55b146,0x3b44b29e
.long 0x3b73,0x3b73,0x3b73,0x3b73,0x2f4c3b65,0x2f7a3b64,0x2fa93b63,0x2fd73b63,0x333e3b3a,0x336b3b37,0x33983b34,0x33c63b31,0x355d3af3,0x357e3aed,0x359e3ae7,0x35bf3ae0
.long 0x37063a92,0x372f3a87,0x37583a7c,0x37813a70,0x384a3a17,0x38623a06,0x387a39f5,0x389139e3,0x39013985,0x391b396d,0x39343955,0x394d393c,0x39a438de,0x39bf38be,0x39d8389f,0x39f1387e
.long 0x3a323824,0x3a4b37f9,0x3a6437a9,0x3a7c3758,0x3aa836b3,0x3abf3654,0x3ad435f4,0x3ae93593,0x3b043505,0x3b173496,0x3b283426,0x3b37336b,0x3b453288,0x3b52318b,0x3b5d308e,0x3b662f1d
.long 0x3b6a2dd8,0x3b702b4f,0x3b7325da,0x3b73a1da,0x3b73a5da,0x3b6fabad,0x3b69ae35,0x3b60b048,0x3b5fb05f,0x3b51b1a2,0x3b40b2e3,0x3b2bb410,0x3b2eb3f3,0x3b15b4a1,0x3af8b547,0x3ad7b5ea
.long 0x3b73,0x3b73,0x3b73,0x3b73,0x30033b62,0x301a3b61,0x30313b60,0x30483b60,0x33f33b2e,0x34103b2b,0x34263b28,0x343d3b25,0x35df3ad9,0x35ff3ad2,0x361f3acb,0x363f3ac4
.long 0x37a93a64,0x37d13a58,0x37f93a4b,0x38103a3f,0x38a839d1,0x38be39bf,0x38d539ac,0x38eb3999,0x39653923,0x397d390a,0x399538ef,0x39ac38d5,0x3a0a385d,0x3a21383c,0x3a38381a,0x3a4f37ef
.long 0x3a923706,0x3aa836b3,0x3abc365f,0x3ad0360a,0x3afc3531,0x3b0d34ce,0x3b1e346a,0x3b2d3405,0x3b453288,0x3b5131a2,0x3b5b30bc,0x3b632fa9,0x3b6c2d1d,0x3b712a37,0x3b732463,0x3b73a350
.long 0x3b71a9d9,0x3b6cad1d,0x3b65af4c,0x3b5bb0bc,0x3b53b174,0x3b44b29e,0x3b31b3c6,0x3b1cb475,0x3b13b4ad,0x3af8b547,0x3ad9b5df,0x3ab7b674,0x3ab2b689,0x3a8ab725,0x3a5eb7bd,0x3a2fb828
.long 0x3b730000,0x3b71a9d9,0x3b6aadd8,0x3b5fb05f,0x3b6aadd8,0x3b5eb077,0x3b4cb1fe,0x3b36b382,0x3b4fb1d0,0x3b37b36b,0x3b1ab480,0x3af8b547,0x3b21b453,0x3afeb526,0x3ad4b5f4,0x3aa5b6be
.long 0x3ae2b5b4,0x3ab2b689,0x3a7cb758,0x3a3fb810,0x3a92b706,0x3a55b7db,0x3a11b854,0x39c6b8b5,0x3a32b824,0x39e7b88c,0x3995b8ef,0x393cb94d,0x39c2b8ba,0x3969b91f,0x390ab97d,0x38a3b9d5
.long 0x3945b945,0x38deb9a4,0x3870b9fc,0x37f9ba4b,0x38bab9c2,0x3845ba1b,0x3795ba6a,0x3694baaf,0x3824ba32,0x3744ba81,0x3635bac6,0x351bbb00,0x3706ba92,0x35eabad7,0x34c3bb0f,0x3327bb3c
.long 0x35b4bae2,0x3480bb1a,0x3288bb45,0x3003bb62,0x3453bb21,0x3215bb4b,0x2eefbb66,0x2695bb73,0x31d0bb4f,0x2e35bb69,0x21dabb73,0xacc0bb6d,0x2dd8bb6a,0x19dabb73,0xad7abb6b,0xb18bbb52
.long 0x3b4fb1d0,0x3b3ab33e,0x3b21b453,0x3b04b505,0x3b1ab480,0x3afab53c,0x3ad4b5f4,0x3aaab6a9,0x3ad0b60a,0x3aa2b6c8,0x3a70b781,0x3a38b81a,0x3a70b781,0x3a35b81f,0x39f5b87a,0x39b0b8d0
.long 0x39fcb870,0x39b3b8cc,0x3965b923,0x3912b975,0x3975b912,0x391fb969,0x38c3b9bb,0x3862ba06,0x38deb9a4,0x387ab9f5,0x3810ba3f,0x3744ba81,0x3837ba25,0x378bba6d,0x369ebaad,0x35a9bae4
.long 0x3706ba92,0x360abad0,0x3505bb04,0x33f3bb2e,0x3588baeb,0x3475bb1c,0x32b5bb42,0x3077bb5e,0x33f3bb2e,0x31a2bb51,0x2e92bb68,0x2750bb72,0x30bcbb5b,0x2c91bb6e,0x9ddabb73,0xad4cbb6c
.long 0x29d9bb71,0xa863bb72,0xaf4cbb65,0xb22cbb4a,0xab4fbb70,0xb077bb5e,0xb310bb3d,0xb4cebb0d,0xb118bb57,0xb3c6bb31,0xb531bafc,0xb674bab7,0xb426bb28,0xb57ebaed,0xb6c8baa2,0xb801ba48
.long 0x3ae2b5b4,0x3abcb65f,0x3a92b706,0x3a64b7a9,0x3a7cb758,0x3a48b801,0x3a11b854,0x39d5b8a3,0x39fcb870,0x39bbb8c3,0x3975b912,0x392cb95d,0x3965b923,0x3916b971,0x38c3b9bb,0x386bb9ff
.long 0x38bab9c2,0x385dba0a,0x37f9ba4b,0x372fba87,0x37f9ba4b,0x3725ba8a,0x364abac1,0x3568baf1,0x365fbabc,0x3573baef,0x3480bb1a,0x3310bb3d,0x34adbb13,0x3354bb39,0x3146bb55,0x2e63bb68
.long 0x31d0bb4f,0x2f4cbb65,0x29d9bb71,0xa5dabb73,0x2c62bb6e,0x99dabb73,0xacc0bb6d,0xb0a5bb5c,0xa9d9bb71,0xafa9bb63,0xb22cbb4a,0xb43dbb25,0xb118bb57,0xb382bb36,0xb4efbb08,0xb615bacd
.long 0xb453bb21,0xb588baeb,0xb6b3baa8,0xb7d1ba58,0xb60abad0,0xb73aba84,0xb82dba2b,0xb8b5b9c6,0xb7a9ba64,0xb867ba03,0xb8efb995,0xb96db91b,0xb895b9e0,0xb91fb969,0xb99db8e7,0xba0db859
.long 0x3a32b824,0x39fcb870,0x39c2b8ba,0x3985b901,0x3995b8ef,0x3951b938,0x390ab97d,0x38beb9bf,0x38deb9a4,0x388cb9e7,0x3837ba25,0x37bdba5e,0x3810ba3f,0x3762ba79,0x369ebaad,0x35d4badb
.long 0x365fbabc,0x3588baeb,0x34adbb13,0x3398bb34,0x3480bb1a,0x3327bb3c,0x3146bb55,0x2ec0bb67,0x3118bb57,0x2e35bb69,0x2863bb72,0xa750bb72,0x2863bb72,0xa806bb72,0xae35bb69,0xb12fbb56
.long 0xadd8bb6a,0xb118bb57,0xb33ebb3a,0xb4adbb13,0xb2e3bb40,0xb48bbb18,0xb59ebae7,0xb6a9baaa,0xb55dbaf3,0xb674bab7,0xb781ba70,0xb841ba1e,0xb72fba87,0xb81fba35,0xb89fb9d8,0xb916b971
.long 0xb870b9fc,0xb8efb995,0xb965b923,0xb9d1b8a8,0xb934b955,0xb9a8b8d9,0xba11b854,0xba6db78b,0xb9e0b895,0xba45b806,0xba9db6dd,0xbae7b59e,0xba70b781,0xbac4b63f,0xbb08b4ef,0xbb3cb327
.long 0xa3c63def,0x2304bdef,0xa3c63def,0x2304bdef,0x3c3c3def,0xbd0bbdeb,0x3d623ddd,0xbd98bdc7,0x3cbb3def,0xbd85bddd,0x3dc73da9,0xbdebbd37,0x3d0b3def,0xbdb9bdc7,0x3dee3d37,0xbdd33cbb
.long 0x3d373def,0xbdddbda9,0x3ddd2304,0xbd373da9,0x3d623def,0xbdeebd85,0x3d98bd37,0x3d0b3deb,0x3d853def,0xbdebbd37,0x3cbbbda9,0x3dc73ddd,0x3d983def,0xbdd3bcbb,0xbd0bbddd,0x3dee3d85
.long 0x3da93def,0xbda9a3c6,0xbda9bdef,0x3da92304,0x3db93def,0xbd623cbb,0xbde5bddd,0x3c3cbd85,0x3dc73def,0xbcbb3d37,0xbdebbda9,0xbd85bddd,0x3dd33def,0x3c3c3d85,0xbdb9bd37,0xbde5bdeb
.long 0x3ddd3def,0x3d373da9,0xbd37a3c6,0xbdddbda9,0x3de53def,0x3d983dc7,0x3c3c3d37,0xbd62bcbb,0x3deb3def,0x3dc73ddd,0x3d853da9,0x3cbb3d37,0x3dee3def,0x3de53deb,0x3dd33ddd,0x3db93dc7
.long 0xa3c63def,0x2304bdef,0xa3c63def,0x2304bdef,0x3db93da9,0xbdd3bd85,0x3de53d37,0xbdeebcbb,0x3deb2304,0xbdc73d37,0x3d85bda9,0xbcbb3ddd,0x3d62bda9,0x3c3c3deb,0xbd98bddd,0x3de53d85
.long 0xbd37bdef,0x3ddd3da9,0xbddda3c6,0x3d37bda9,0xbde5bda9,0x3db9bcbb,0x3c3c3ddd,0xbdd3bdc7,0xbdc7a3c6,0xbcbbbddd,0x3deb3da9,0xbd853d37,0xbc3c3da9,0xbde5bdc7,0x3d62bd37,0x3db93deb
.long 0x3da93def,0xbda9a3c6,0xbda9bdef,0x3da92304,0x3dee3da9,0x3d0b3dc7,0xbdd3bd37,0xbd98bdeb,0x3d852304,0x3deb3ddd,0x3cbb3da9,0xbdc7bd37,0xbd0bbda9,0x3d983cbb,0x3dee3ddd,0x3d623dc7
.long 0xbdddbdef,0xbd37bda9,0x3d372304,0x3ddd3da9,0xbdd3bda9,0xbdeebdeb,0xbdb9bddd,0xbd0bbd85,0xbcbba3c6,0xbd85bd37,0xbdc7bda9,0xbdebbddd,0x3d983da9,0x3d623d85,0x3d0b3d37,0x3c3c3cbb
.long 0xa3c63def,0x2304bdef,0xa3c63def,0x2304bdef,0x3dee2304,0xbde53cbb,0x3dd3bd37,0xbdb93d85,0xbcbbbdef,0x3d853ddd,0xbdc7bda9,0x3deb3d37,0xbde5a3c6,0x3d98bd85,0xbc3c3ddd,0xbd62bdeb
.long 0x3d373def,0xbdddbda9,0x3ddd2304,0xbd373da9,0x3dd32304,0xbc3c3dc7,0xbdb9bddd,0x3de53cbb,0xbd85bdef,0x3deb3d37,0xbcbb3da9,0xbdc7bddd,0xbdb9a3c6,0xbd62bdeb,0x3de53d37,0x3c3c3dc7
.long 0x3da93def,0xbda9a3c6,0xbda9bdef,0x3da92304,0x3d982304,0x3dd33deb,0xbd0b3d37,0xbdeebdc7,0xbdc7bdef,0x3cbbbd37,0x3deb3da9,0x3d853ddd,0xbd62a3c6,0xbdeebdc7,0xbd98bddd,0x3d0bbcbb
.long 0x3ddd3def,0x3d373da9,0xbd37a3c6,0xbdddbda9,0x3d0b2304,0x3db93d85,0x3dee3ddd,0x3dd33deb,0xbdebbdef,0xbdc7bddd,0xbd85bda9,0xbcbbbd37,0xbc3ca3c6,0xbd0bbcbb,0xbd62bd37,0xbd98bd85
.long 0xa3c63def,0x2304bdef,0xa3c63def,0x2304bdef,0x3d98bda9,0xbd623dc7,0x3d0bbddd,0xbc3c3deb,0xbdeba3c6,0x3dc7bd37,0xbd853da9,0x3cbbbddd,0x3dd33da9,0xbdeebcbb,0x3db9bd37,0xbd0b3dc7
.long 0xbd37bdef,0x3ddd3da9,0xbddda3c6,0x3d37bda9,0xbd0b3da9,0xbd98bdeb,0x3dee3d37,0xbd623d85,0x3dc72304,0x3cbb3ddd,0xbdebbda9,0x3d85bd37,0xbdeebda9,0x3d0bbd85,0x3dd33ddd,0xbd983cbb
.long 0x3da93def,0xbda9a3c6,0xbda9bdef,0x3da92304,0xbc3cbda9,0x3de53d85,0x3d623ddd,0xbdb9bcbb,0xbd85a3c6,0xbdebbddd,0xbcbbbda9,0x3dc73d37,0x3de53da9,0x3db93deb,0xbc3c3d37,0xbdd3bd85
.long 0xbdddbdef,0xbd37bda9,0x3d372304,0x3ddd3da9,0x3d623da9,0xbc3c3cbb,0xbd98bd37,0xbde5bdc7,0x3cbb2304,0x3d853d37,0x3dc73da9,0x3deb3ddd,0xbdb9bda9,0xbdd3bdc7,0xbde5bddd,0xbdeebdeb
.long 0x3def0000,0xbdefa384,0x3def0000,0xbdefa384,0x3dee0000,0xbde53cbb,0x3dd3bd37,0xbdb93d85,0x3deb0000,0xbdc73d37,0x3d85bda9,0xbcbb3ddd,0x3de50000,0xbd983d85,0x3c3cbddd,0x3d623deb
.long 0x3ddd0000,0xbd373da9,0xbd37bdef,0x3ddd3da9,0x3dd30000,0xbc3c3dc7,0xbdb9bddd,0x3de53cbb,0x3dc70000,0x3cbb3ddd,0xbdebbda9,0x3d85bd37,0x3db90000,0x3d623deb,0xbde5bd37,0xbc3cbdc7
.long 0x3da90000,0x3da93def,0xbda9a384,0xbda9bdef,0x3d980000,0x3dd33deb,0xbd0b3d37,0xbdeebdc7,0x3d850000,0x3deb3ddd,0x3cbb3da9,0xbdc7bd37,0x3d620000,0x3dee3dc7,0x3d983ddd,0xbd0b3cbb
.long 0x3d370000,0x3ddd3da9,0x3ddd3def,0x3d373da9,0x3d0b0000,0x3db93d85,0x3dee3ddd,0x3dd33deb,0x3cbb0000,0x3d853d37,0x3dc73da9,0x3deb3ddd,0x3c3c0000,0x3d0b3cbb,0x3d623d37,0x3d983d85
.long 0x3def0000,0xbdefa384,0x3def0000,0xbdefa384,0x3d98bda9,0xbd623dc7,0x3d0bbddd,0xbc3c3deb,0xbcbbbdef,0x3d853ddd,0xbdc7bda9,0x3deb3d37,0xbdd3bda9,0x3dee3cbb,0xbdb93d37,0x3d0bbdc7
.long 0xbddda384,0x3d37bda9,0x3d373def,0xbdddbda9,0xbd0b3da9,0xbd98bdeb,0x3dee3d37,0xbd623d85,0x3d853def,0xbdebbd37,0x3cbbbda9,0x3dc73ddd,0x3dee3da9,0xbd0b3d85,0xbdd3bddd,0x3d98bcbb
.long 0x3da90000,0x3da93def,0xbda9a384,0xbda9bdef,0xbc3cbda9,0x3de53d85,0x3d623ddd,0xbdb9bcbb,0xbdc7bdef,0x3cbbbd37,0x3deb3da9,0x3d853ddd,0xbde5bda9,0xbdb9bdeb,0x3c3cbd37,0x3dd33d85
.long 0xbd37a384,0xbdddbda9,0xbdddbdef,0xbd37bda9,0x3d623da9,0xbc3c3cbb,0xbd98bd37,0xbde5bdc7,0x3deb3def,0x3dc73ddd,0x3d853da9,0x3cbb3d37,0x3db93da9,0x3dd33dc7,0x3de53ddd,0x3dee3deb
.long 0x3def0000,0xbdefa384,0x3def0000,0xbdefa384,0xbc3cbdef,0x3d0b3deb,0xbd62bddd,0x3d983dc7,0xbdeba384,0x3dc7bd37,0xbd853da9,0x3cbbbddd,0x3d0b3def,0xbdb9bdc7,0x3dee3d37,0xbdd33cbb
.long 0x3ddd0000,0xbd373da9,0xbd37bdef,0x3ddd3da9,0xbd62bdef,0x3dee3d85,0xbd983d37,0xbd0bbdeb,0xbdc7a384,0xbcbbbddd,0x3deb3da9,0xbd853d37,0x3d983def,0xbdd3bcbb,0xbd0bbddd,0x3dee3d85
.long 0x3da90000,0x3da93def,0xbda9a384,0xbda9bdef,0xbdb9bdef,0x3d62bcbb,0x3de53ddd,0xbc3c3d85,0xbd85a384,0xbdebbddd,0xbcbbbda9,0x3dc73d37,0x3dd33def,0x3c3c3d85,0xbdb9bd37,0xbde5bdeb
.long 0x3d370000,0x3ddd3da9,0x3ddd3def,0x3d373da9,0xbde5bdef,0xbd98bdc7,0xbc3cbd37,0x3d623cbb,0xbcbba384,0xbd85bd37,0xbdc7bda9,0xbdebbddd,0x3dee3def,0x3de53deb,0x3dd33ddd,0x3db93dc7
.long 0x3def0000,0xbdefa384,0x3def0000,0xbdefa384,0xbdb9bda9,0x3dd33d85,0xbde5bd37,0x3dee3cbb,0x3cbb3def,0xbd85bddd,0x3dc73da9,0xbdebbd37,0x3d62bda9,0x3c3c3deb,0xbd98bddd,0x3de53d85
.long 0xbddda384,0x3d37bda9,0x3d373def,0xbdddbda9,0x3de53da9,0xbdb93cbb,0xbc3cbddd,0x3dd33dc7,0xbd85bdef,0x3deb3d37,0xbcbb3da9,0xbdc7bddd,0xbc3c3da9,0xbde5bdc7,0x3d62bd37,0x3db93deb
.long 0x3da90000,0x3da93def,0xbda9a384,0xbda9bdef,0xbdeebda9,0xbd0bbdc7,0x3dd33d37,0x3d983deb,0x3dc73def,0xbcbb3d37,0xbdebbda9,0xbd85bddd,0xbd0bbda9,0x3d983cbb,0x3dee3ddd,0x3d623dc7
.long 0xbd37a384,0xbdddbda9,0xbdddbdef,0xbd37bda9,0x3dd33da9,0x3dee3deb,0x3db93ddd,0x3d0b3d85,0xbdebbdef,0xbdc7bddd,0xbd85bda9,0xbcbbbd37,0x3d983da9,0x3d623d85,0x3d0b3d37,0x3c3c3cbb
.long 0x3e503e50,0x3e503e50,0x3e503e50,0x3e503e50,0x3e4c3e50,0x3e2d3e40,0xbe4cbe50,0xbe2dbe40,0x3e403e50,0x3d9f3e13,0x3e403e50,0x3d9f3e13,0x3e2d3e50,0xbd223d9f,0xbe2dbe50,0x3d22bd9f
.long 0x3e133e50,0xbe132365,0x3e133e50,0xbe132365,0x3de73e50,0xbe4cbd9f,0xbde7be50,0x3e4c3d9f,0x3d9f3e50,0xbe40be13,0x3d9f3e50,0xbe40be13,0x3d223e50,0xbde7be40,0xbd22be50,0x3de73e40
.long 0x23653e50,0xa42cbe50,0x23653e50,0xa42cbe50,0xbd223e50,0x3de7be40,0x3d22be50,0xbde73e40,0xbd9f3e50,0x3e40be13,0xbd9f3e50,0x3e40be13,0xbde73e50,0x3e4cbd9f,0x3de7be50,0xbe4c3d9f
.long 0xbe133e50,0x3e13a42c,0xbe133e50,0x3e13a42c,0xbe2d3e50,0x3d223d9f,0x3e2dbe50,0xbd22bd9f,0xbe403e50,0xbd9f3e13,0xbe403e50,0xbd9f3e13,0xbe4c3e50,0xbe2d3e40,0x3e4cbe50,0x3e2dbe40
.long 0x3e503e50,0x3e503e50,0x3e503e50,0x3e503e50,0x3de73e13,0x3d223d9f,0xbde7be13,0xbd22bd9f,0xbd9f2365,0xbe40be13,0xbd9f2365,0xbe40be13,0xbe4cbe13,0xbde7be40,0x3e4c3e13,0x3de73e40
.long 0xbe13be50,0x3e13a42c,0xbe13be50,0x3e13a42c,0x3d22be13,0x3e2d3e40,0xbd223e13,0xbe2dbe40,0x3e40a42c,0xbd9f3e13,0x3e40a42c,0xbd9f3e13,0x3e2d3e13,0xbe4cbd9f,0xbe2dbe13,0x3e4c3d9f
.long 0x23653e50,0xa42cbe50,0x23653e50,0xa42cbe50,0xbe2d3e13,0x3e4cbd9f,0x3e2dbe13,0xbe4c3d9f,0xbe402365,0x3d9f3e13,0xbe402365,0x3d9f3e13,0xbd22be13,0xbe2d3e40,0x3d223e13,0x3e2dbe40
.long 0x3e13be50,0xbe132365,0x3e13be50,0xbe132365,0x3e4cbe13,0x3de7be40,0xbe4c3e13,0xbde73e40,0x3d9fa42c,0x3e40be13,0x3d9fa42c,0x3e40be13,0xbde73e13,0xbd223d9f,0x3de7be13,0x3d22bd9f
.long 0x3e503e50,0x3e503e50,0x3e503e50,0x3e503e50,0xbd222365,0xbde7bd9f,0x3d22a42c,0x3de73d9f,0xbe40be50,0xbd9fbe13,0xbe40be50,0xbd9fbe13,0x3de7a42c,0x3e4c3e40,0xbde72365,0xbe4cbe40
.long 0x3e133e50,0xbe132365,0x3e133e50,0xbe132365,0xbe2d2365,0xbd22be40,0x3e2da42c,0x3d223e40,0xbd9fbe50,0x3e403e13,0xbd9fbe50,0x3e403e13,0x3e4ca42c,0xbe2d3d9f,0xbe4c2365,0x3e2dbd9f
.long 0x23653e50,0xa42cbe50,0x23653e50,0xa42cbe50,0xbe4c2365,0x3e2d3d9f,0x3e4ca42c,0xbe2dbd9f,0x3d9fbe50,0xbe403e13,0x3d9fbe50,0xbe403e13,0x3e2da42c,0x3d22be40,0xbe2d2365,0xbd223e40
.long 0xbe133e50,0x3e13a42c,0xbe133e50,0x3e13a42c,0xbde72365,0xbe4c3e40,0x3de7a42c,0x3e4cbe40,0x3e40be50,0x3d9fbe13,0x3e40be50,0x3d9fbe13,0x3d22a42c,0x3de7bd9f,0xbd222365,0xbde73d9f
.long 0x3e503e50,0x3e503e50,0x3e503e50,0x3e503e50,0xbe2dbe13,0xbe4cbe40,0x3e2d3e13,0x3e4c3e40,0x3d9fa42c,0x3e403e13,0x3d9fa42c,0x3e403e13,0x3d223e13,0xbe2dbd9f,0xbd22be13,0x3e2d3d9f
.long 0xbe13be50,0x3e13a42c,0xbe13be50,0x3e13a42c,0x3e4c3e13,0xbde73d9f,0xbe4cbe13,0x3de7bd9f,0xbe402365,0x3d9fbe13,0xbe402365,0x3d9fbe13,0x3de7be13,0xbd223e40,0xbde73e13,0x3d22be40
.long 0x23653e50,0xa42cbe50,0x23653e50,0xa42cbe50,0xbde7be13,0x3d223e40,0x3de73e13,0xbd22be40,0x3e40a42c,0xbd9fbe13,0x3e40a42c,0xbd9fbe13,0xbe4c3e13,0x3de73d9f,0x3e4cbe13,0xbde7bd9f
.long 0x3e13be50,0xbe132365,0x3e13be50,0xbe132365,0xbd223e13,0x3e2dbd9f,0x3d22be13,0xbe2d3d9f,0xbd9f2365,0xbe403e13,0xbd9f2365,0xbe403e13,0x3e2dbe13,0x3e4cbe40,0xbe2d3e13,0xbe4c3e40
.long 0x0,0x0,0x0,0x0,0xbd220000,0xbde7bd9f,0x3d22a3e5,0x3de73d9f,0xbd9f0000,0xbe40be13,0xbd9f0000,0xbe40be13,0xbde70000,0xbe4cbe40,0x3de7a3e5,0x3e4c3e40
.long 0xbe130000,0xbe13be50,0xbe130000,0xbe13be50,0xbe2d0000,0xbd22be40,0x3e2da3e5,0x3d223e40,0xbe400000,0x3d9fbe13,0xbe400000,0x3d9fbe13,0xbe4c0000,0x3e2dbd9f,0x3e4ca3e5,0xbe2d3d9f
.long 0xbe500000,0x3e50a3e5,0xbe500000,0x3e50a3e5,0xbe4c0000,0x3e2d3d9f,0x3e4ca3e5,0xbe2dbd9f,0xbe400000,0x3d9f3e13,0xbe400000,0x3d9f3e13,0xbe2d0000,0xbd223e40,0x3e2da3e5,0x3d22be40
.long 0xbe130000,0xbe133e50,0xbe130000,0xbe133e50,0xbde70000,0xbe4c3e40,0x3de7a3e5,0x3e4cbe40,0xbd9f0000,0xbe403e13,0xbd9f0000,0xbe403e13,0xbd220000,0xbde73d9f,0x3d22a3e5,0x3de7bd9f
.long 0x0,0x0,0x0,0x0,0xbe2dbe13,0xbe4cbe40,0x3e2d3e13,0x3e4c3e40,0xbe40be50,0xbd9fbe13,0xbe40be50,0xbd9fbe13,0xbd22be13,0x3e2d3d9f,0x3d223e13,0xbe2dbd9f
.long 0x3e13a3e5,0x3e133e50,0x3e13a3e5,0x3e133e50,0x3e4c3e13,0xbde73d9f,0xbe4cbe13,0x3de7bd9f,0x3d9f3e50,0xbe40be13,0x3d9f3e50,0xbe40be13,0xbde73e13,0x3d22be40,0x3de7be13,0xbd223e40
.long 0xbe500000,0x3e50a3e5,0xbe500000,0x3e50a3e5,0xbde7be13,0x3d223e40,0x3de73e13,0xbd22be40,0x3d9fbe50,0xbe403e13,0x3d9fbe50,0xbe403e13,0x3e4cbe13,0xbde7bd9f,0xbe4c3e13,0x3de73d9f
.long 0x3e13a3e5,0x3e13be50,0x3e13a3e5,0x3e13be50,0xbd223e13,0x3e2dbd9f,0x3d22be13,0xbe2d3d9f,0xbe403e50,0xbd9f3e13,0xbe403e50,0xbd9f3e13,0xbe2d3e13,0xbe4c3e40,0x3e2dbe13,0x3e4cbe40
.long 0x0,0x0,0x0,0x0,0xbe4cbe50,0xbe2dbe40,0x3e4c3e50,0x3e2d3e40,0x3d9fa3e5,0x3e403e13,0x3d9fa3e5,0x3e403e13,0x3e2d3e50,0xbd223d9f,0xbe2dbe50,0x3d22bd9f
.long 0xbe130000,0xbe13be50,0xbe130000,0xbe13be50,0xbde7be50,0x3e4c3d9f,0x3de73e50,0xbe4cbd9f,0x3e40a3e5,0xbd9f3e13,0x3e40a3e5,0xbd9f3e13,0x3d223e50,0xbde7be40,0xbd22be50,0x3de73e40
.long 0xbe500000,0x3e50a3e5,0xbe500000,0x3e50a3e5,0x3d22be50,0xbde73e40,0xbd223e50,0x3de7be40,0x3e40a3e5,0xbd9fbe13,0x3e40a3e5,0xbd9fbe13,0xbde73e50,0x3e4cbd9f,0x3de7be50,0xbe4c3d9f
.long 0xbe130000,0xbe133e50,0xbe130000,0xbe133e50,0x3e2dbe50,0xbd22bd9f,0xbe2d3e50,0x3d223d9f,0x3d9fa3e5,0x3e40be13,0x3d9fa3e5,0x3e40be13,0xbe4c3e50,0xbe2d3e40,0x3e4cbe50,0x3e2dbe40
.long 0x0,0x0,0x0,0x0,0xbde7be13,0xbd22bd9f,0x3de73e13,0x3d223d9f,0x3e403e50,0x3d9f3e13,0x3e403e50,0x3d9f3e13,0xbe4cbe13,0xbde7be40,0x3e4c3e13,0x3de73e40
.long 0x3e13a3e5,0x3e133e50,0x3e13a3e5,0x3e133e50,0xbd223e13,0xbe2dbe40,0x3d22be13,0x3e2d3e40,0xbd9fbe50,0x3e403e13,0xbd9fbe50,0x3e403e13,0x3e2d3e13,0xbe4cbd9f,0xbe2dbe13,0x3e4c3d9f
.long 0xbe500000,0x3e50a3e5,0xbe500000,0x3e50a3e5,0x3e2dbe13,0xbe4c3d9f,0xbe2d3e13,0x3e4cbd9f,0xbd9f3e50,0x3e40be13,0xbd9f3e50,0x3e40be13,0xbd22be13,0xbe2d3e40,0x3d223e13,0x3e2dbe40
.long 0x3e13a3e5,0x3e13be50,0x3e13a3e5,0x3e13be50,0xbe4c3e13,0xbde73e40,0x3e4cbe13,0x3de7be40,0x3e40be50,0x3d9fbe13,0x3e40be50,0x3d9fbe13,0xbde73e13,0xbd223d9f,0x3de7be13,0x3d22bd9f
.long 0x3b73,0xb05f3b5f,0xb4533b21,0xb65f3abc,0x3b73,0xb0773b5e,0xb46a3b1e,0xb67f3ab5,0x3b73,0xb08e3b5d,0xb4803b1a,0xb69e3aad,0x3b73,0xb0a53b5c,0xb4963b17,0xb6be3aa5
.long 0x3b73,0xb0bc3b5b,0xb4ad3b13,0xb6dd3a9d,0x3b73,0xb0d33b5a,0xb4c33b0f,0xb6fc3a95,0x3b73,0xb0ea3b59,0xb4d93b0c,0xb71b3a8d,0x3b73,0xb1013b58,0xb4ef3b08,0xb73a3a84
.long 0x3b73,0xb1183b57,0xb5053b04,0xb7583a7c,0x3b73,0xb12f3b56,0xb51b3b00,0xb7773a73,0x3b73,0xb1463b55,0xb5313afc,0xb7953a6a,0x3b73,0xb15d3b54,0xb5473af8,0xb7b33a61
.long 0x3b73,0xb1743b53,0xb55d3af3,0xb7d13a58,0x3b73,0xb18b3b52,0xb5733aef,0xb7ef3a4f,0x3b73,0xb1a23b51,0xb5883aeb,0xb8063a45,0x3b73,0xb1b93b50,0xb59e3ae7,0xb8153a3c
.long 0xb8243a32,0xb9013985,0xb9c238ba,0xba6437a9,0xb8373a25,0xb9163971,0xb9d8389f,0xba793762,0xb84a3a17,0xb92c395d,0xb9ee3883,0xba8d371b,0xb85d3a0a,0xb9413949,0xba033867,0xbaa036d2
.long 0xb87039fc,0xb9553934,0xba17384a,0xbab23689,0xb88339ee,0xb969391f,0xba2b382d,0xbac4363f,0xb89539e0,0xb97d390a,0xba3f3810,0xbad435f4,0xb8a839d1,0xb99138f4,0xba5237e5,0xbae435a9
.long 0xb8ba39c2,0xb9a438de,0xba6437a9,0xbaf3355d,0xb8cc39b3,0xb9b738c7,0xba76376d,0xbb023510,0xb8de39a4,0xb9ca38b1,0xba87372f,0xbb0f34c3,0xb8ef3995,0xb9dc389a,0xba9836f2,0xbb1c3475
.long 0xb9013985,0xb9ee3883,0xbaa836b3,0xbb283426,0xb9123975,0xb9ff386b,0xbab73674,0xbb3333af,0xb9233965,0xba113854,0xbac63635,0xbb3d3310,0xb9343955,0xba21383c,0xbad435f4,0xbb463271
.long 0xbae235b4,0xbb3a333e,0xbb6a2dd8,0xbb71a9d9,0xbaf3355d,0xbb463271,0xbb6f2c05,0xbb6dacee,0xbb043505,0xbb5131a2,0xbb722863,0xbb66aeef,0xbb1334ad,0xbb5a30d3,0xbb731dda,0xbb5eb077
.long 0xbb213453,0xbb623003,0xbb73a5da,0xbb53b174,0xbb2e33f3,0xbb682e63,0xbb70aa94,0xbb46b271,0xbb3a333e,0xbb6d2cc0,0xbb6cad1d,0xbb37b36b,0xbb453288,0xbb712a37,0xbb66aeef,0xbb26b432
.long 0xbb4f31d0,0xbb7325da,0xbb5fb05f,0xbb13b4ad,0xbb573118,0xbb7399da,0xbb55b146,0xbafeb526,0xbb5f305f,0xbb72a750,0xbb4ab22c,0xbae7b59e,0xbb652f4c,0xbb70aaf2,0xbb3db310,0xbacdb615
.long 0xbb6a2dd8,0xbb6cad1d,0xbb2eb3f3,0xbab2b689,0xbb6e2c62,0xbb67aec0,0xbb1eb46a,0xba95b6fc,0xbb7129d9,0xbb60b031,0xbb0cb4d9,0xba76b76d,0xbb7325da,0xbb58b101,0xbaf8b547,0xba55b7db
.long 0xbb4fb1d0,0xbb04b505,0xba92b706,0xb9fcb870,0xbb40b2e3,0xbae9b593,0xba6ab795,0xb9c6b8b5,0xbb2eb3f3,0xbacbb61f,0xba3fb810,0xb98db8f8,0xbb1ab480,0xbaaab6a9,0xba11b854,0xb951b938
.long 0xbb04b505,0xba87b72f,0xb9e0b895,0xb912b975,0xbaebb588,0xba61b7b3,0xb9acb8d5,0xb8d0b9b0,0xbad0b60a,0xba38b81a,0xb975b912,0xb88cb9e7,0xbab2b689,0xba0db859,0xb93cb94d,0xb845ba1b
.long 0xba92b706,0xb9e0b895,0xb901b985,0xb7f9ba4b,0xba70b781,0xb9b0b8d0,0xb8c3b9bb,0xb762ba79,0xba4bb7f9,0xb97db90a,0xb883b9ee,0xb6c8baa2,0xba25b837,0xb949b941,0xb841ba1e,0xb62abac8
.long 0xb9fcb870,0xb912b975,0xb7f9ba4b,0xb588baeb,0xb9d1b8a8,0xb8d9b9a8,0xb76dba76,0xb4e4bb0a,0xb9a4b8de,0xb89fb9d8,0xb6ddba9d,0xb43dbb25,0xb975b912,0xb862ba06,0xb64abac1,0xb327bb3c
.long 0xb945b945,0xb870b9fc,0xb706ba92,0xb505bb04,0xb901b985,0xb81fba35,0xb64abac1,0xb432bb26,0xb8bab9c2,0xb795ba6a,0xb588baeb,0xb2b5bb42,0xb870b9fc,0xb6e7ba9a,0xb4c3bb0f,0xb101bb58
.long 0xb824ba32,0xb635bac6,0xb3f3bb2e,0xae92bb68,0xb7a9ba64,0xb57ebaed,0xb25abb47,0xaa37bb71,0xb706ba92,0xb4c3bb0f,0xb0bcbb5b,0x1ddabb73,0xb65fbabc,0xb405bb2d,0xae35bb69,0x2badbb6f
.long 0xb5b4bae2,0xb288bb45,0xa9d9bb71,0x2f4cbb65,0xb505bb04,0xb101bb58,0x1ddabb73,0x315dbb54,0xb453bb21,0xaeefbb66,0x2b4fbb70,0x3310bb3d,0xb33ebb3a,0xabadbb6f,0x2eefbb66,0x345fbb1f
.long 0xb1d0bb4f,0xa1dabb73,0x3118bb57,0x3531bafc,0xb05fbb5f,0x28c1bb72,0x32b5bb42,0x35ffbad2,0xadd8bb6a,0x2d7abb6b,0x3426bb28,0x36c8baa2,0xa9d9bb71,0x3048bb60,0x34efbb08,0x378bba6d
.long 0xb1d0bb4f,0xa9d9bb71,0x2dd8bb6a,0x333ebb3a,0xb003bb62,0x2350bb73,0x30eabb59,0x34a1bb15,0xac62bb6e,0x2cc0bb6d,0x32e3bb40,0x359ebae7,0xa1dabb73,0x3048bb60,0x346abb1e,0x3694baaf
.long 0x29d9bb71,0x322cbb4a,0x355dbaf3,0x3781ba70,0x2e92bb68,0x3405bb2d,0x364abac1,0x3832ba28,0x3118bb57,0x34efbb08,0x372fba87,0x389fb9d8,0x32e3bb40,0x35d4badb,0x3806ba45,0x3905b981
.long 0x3453bb21,0x36b3baa8,0x3870b9fc,0x3965b923,0x3531bafc,0x378bba6d,0x38d5b9ac,0x39bfb8be,0x360abad0,0x382dba2b,0x3934b955,0x3a11b854,0x36ddba9d,0x3891b9e3,0x398db8f8,0x3a5bb7c7
.long 0x37a9ba64,0x38efb995,0x39e0b895,0x3a9db6dd,0x3837ba25,0x3949b941,0x3a2bb82d,0x3ad7b5ea,0x3895b9e0,0x399db8e7,0x3a70b781,0x3b08b4ef,0x38efb995,0x39eab888,0x3aadb69e,0x3b30b3dc
.long 0x35b4bae2,0x37a9ba64,0x38bab9c2,0x3985b901,0x36b3baa8,0x384fba14,0x392cb95d,0x39eab888,0x37a9ba64,0x38c3b9bb,0x3995b8ef,0x3a45b806,0x384aba17,0x3930b959,0x39f5b87a,0x3a95b6fc
.long 0x38bab9c2,0x3995b8ef,0x3a4bb7f9,0x3ad9b5df,0x3923b965,0x39f1b87e,0x3a98b6f2,0x3b11b4b8,0x3985b901,0x3a45b806,0x3ad9b5df,0x3b3db310,0x39e0b895,0x3a8fb710,0x3b0fb4c3,0x3b5cb0a5
.long 0x3a32b824,0x3ad0b60a,0x3b3ab33e,0x3b6eac62,0x3a7cb758,0x3b06b4fa,0x3b59b0ea,0x3b732063,0x3abcb65f,0x3b31b3c6,0x3b6cad1d,0x3b6b2d7a,0x3af3b55d,0x3b52b18b,0x3b739dda,0x3b56312f
.long 0x3b21b453,0x3b68ae92,0x3b6e2c62,0x3b343398,0x3b45b288,0x3b72a806,0x3b5d308e,0x3b0634fa,0x3b5fb05f,0x3b72291e,0x3b4032e3,0x3acb361f,0x3b6eac62,0x3b662f1d,0x3b173496,0x3a84373a
.long 0x3a32b824,0x3abcb65f,0x3b21b453,0x3b5fb05f,0x3a87b72f,0x3afeb526,0x3b4cb1fe,0x3b71aa37,0x3ad0b60a,0x3b31b3c6,0x3b68ae92,0x3b72291e,0x3b0cb4d9,0x3b56b12f,0x3b73a463,0x3b61301a
.long 0x3b3ab33e,0x3b6cad1d,0x3b6e2c62,0x3b4032e3,0x3b5bb0bc,0x3b7319da,0x3b5930ea,0x3b0d34ce,0x3b6eac62,0x3b6b2d7a,0x3b343398,0x3acb361f,0x3b7321da,0x3b54315d,0x3b00351b,0x3a793762
.long 0x3b6a2dd8,0x3b2e33f3,0x3abc365f,0x3a17384a,0x3b533174,0x3afa353c,0x3a6a3795,0x39a838d9,0x3b2e33f3,0x3ab73674,0x3a0a385d,0x392c395d,0x3afc3531,0x3a67379f,0x399d38e7,0x38a339d5
.long 0x3abc365f,0x3a0a385d,0x39233965,0x38103a3f,0x3a703781,0x39a038e2,0x389f39d8,0x36e73a9a,0x3a17384a,0x392c395d,0x38103a3f,0x359e3ae7,0x39b338cc,0x38ac39cd,0x36f23a98,0x34483b23
.long 0x3b73,0x3b73,0x3b73,0x3b73,0x305f3b5f,0x30773b5e,0x308e3b5d,0x30a53b5c,0x34533b21,0x346a3b1e,0x34803b1a,0x34963b17,0x365f3abc,0x367f3ab5,0x369e3aad,0x36be3aa5
.long 0x38243a32,0x38373a25,0x384a3a17,0x385d3a0a,0x39013985,0x39163971,0x392c395d,0x39413949,0x39c238ba,0x39d8389f,0x39ee3883,0x3a033867,0x3a6437a9,0x3a793762,0x3a8d371b,0x3aa036d2
.long 0x3ae235b4,0x3af3355d,0x3b043505,0x3b1334ad,0x3b3a333e,0x3b463271,0x3b5131a2,0x3b5a30d3,0x3b6a2dd8,0x3b6f2c05,0x3b722863,0x3b731dda,0x3b71a9d9,0x3b6dacee,0x3b66aeef,0x3b5eb077
.long 0x3b4fb1d0,0x3b40b2e3,0x3b2eb3f3,0x3b1ab480,0x3b04b505,0x3ae9b593,0x3acbb61f,0x3aaab6a9,0x3a92b706,0x3a6ab795,0x3a3fb810,0x3a11b854,0x39fcb870,0x39c6b8b5,0x398db8f8,0x3951b938
.long 0x3b73,0x3b73,0x3b73,0x3b73,0x30bc3b5b,0x30d33b5a,0x30ea3b59,0x31013b58,0x34ad3b13,0x34c33b0f,0x34d93b0c,0x34ef3b08,0x36dd3a9d,0x36fc3a95,0x371b3a8d,0x373a3a84
.long 0x387039fc,0x388339ee,0x389539e0,0x38a839d1,0x39553934,0x3969391f,0x397d390a,0x399138f4,0x3a17384a,0x3a2b382d,0x3a3f3810,0x3a5237e5,0x3ab23689,0x3ac4363f,0x3ad435f4,0x3ae435a9
.long 0x3b213453,0x3b2e33f3,0x3b3a333e,0x3b453288,0x3b623003,0x3b682e63,0x3b6d2cc0,0x3b712a37,0x3b73a5da,0x3b70aa94,0x3b6cad1d,0x3b66aeef,0x3b53b174,0x3b46b271,0x3b37b36b,0x3b26b432
.long 0x3b04b505,0x3aebb588,0x3ad0b60a,0x3ab2b689,0x3a87b72f,0x3a61b7b3,0x3a38b81a,0x3a0db859,0x39e0b895,0x39acb8d5,0x3975b912,0x393cb94d,0x3912b975,0x38d0b9b0,0x388cb9e7,0x3845ba1b
.long 0x3b73,0x3b73,0x3b73,0x3b73,0x31183b57,0x312f3b56,0x31463b55,0x315d3b54,0x35053b04,0x351b3b00,0x35313afc,0x35473af8,0x37583a7c,0x37773a73,0x37953a6a,0x37b33a61
.long 0x38ba39c2,0x38cc39b3,0x38de39a4,0x38ef3995,0x39a438de,0x39b738c7,0x39ca38b1,0x39dc389a,0x3a6437a9,0x3a76376d,0x3a87372f,0x3a9836f2,0x3af3355d,0x3b023510,0x3b0f34c3,0x3b1c3475
.long 0x3b4f31d0,0x3b573118,0x3b5f305f,0x3b652f4c,0x3b7325da,0x3b7399da,0x3b72a750,0x3b70aaf2,0x3b5fb05f,0x3b55b146,0x3b4ab22c,0x3b3db310,0x3b13b4ad,0x3afeb526,0x3ae7b59e,0x3acdb615
.long 0x3a92b706,0x3a70b781,0x3a4bb7f9,0x3a25b837,0x39e0b895,0x39b0b8d0,0x397db90a,0x3949b941,0x3901b985,0x38c3b9bb,0x3883b9ee,0x3841ba1e,0x37f9ba4b,0x3762ba79,0x36c8baa2,0x362abac8
.long 0x3b73,0x3b73,0x3b73,0x3b73,0x31743b53,0x318b3b52,0x31a23b51,0x31b93b50,0x355d3af3,0x35733aef,0x35883aeb,0x359e3ae7,0x37d13a58,0x37ef3a4f,0x38063a45,0x38153a3c
.long 0x39013985,0x39123975,0x39233965,0x39343955,0x39ee3883,0x39ff386b,0x3a113854,0x3a21383c,0x3aa836b3,0x3ab73674,0x3ac63635,0x3ad435f4,0x3b283426,0x3b3333af,0x3b3d3310,0x3b463271
.long 0x3b6a2dd8,0x3b6e2c62,0x3b7129d9,0x3b7325da,0x3b6cad1d,0x3b67aec0,0x3b60b031,0x3b58b101,0x3b2eb3f3,0x3b1eb46a,0x3b0cb4d9,0x3af8b547,0x3ab2b689,0x3a95b6fc,0x3a76b76d,0x3a55b7db
.long 0x39fcb870,0x39d1b8a8,0x39a4b8de,0x3975b912,0x3912b975,0x38d9b9a8,0x389fb9d8,0x3862ba06,0x37f9ba4b,0x376dba76,0x36ddba9d,0x364abac1,0x3588baeb,0x34e4bb0a,0x343dbb25,0x3327bb3c
.long 0x3945b945,0x3901b985,0x38bab9c2,0x3870b9fc,0x3870b9fc,0x381fba35,0x3795ba6a,0x36e7ba9a,0x3706ba92,0x364abac1,0x3588baeb,0x34c3bb0f,0x3505bb04,0x3432bb26,0x32b5bb42,0x3101bb58
.long 0x31d0bb4f,0x3003bb62,0x2c62bb6e,0x21dabb73,0x29d9bb71,0xa350bb73,0xacc0bb6d,0xb048bb60,0xadd8bb6a,0xb0eabb59,0xb2e3bb40,0xb46abb1e,0xb33ebb3a,0xb4a1bb15,0xb59ebae7,0xb694baaf
.long 0xb5b4bae2,0xb6b3baa8,0xb7a9ba64,0xb84aba17,0xb7a9ba64,0xb84fba14,0xb8c3b9bb,0xb930b959,0xb8bab9c2,0xb92cb95d,0xb995b8ef,0xb9f5b87a,0xb985b901,0xb9eab888,0xba45b806,0xba95b6fc
.long 0xba32b824,0xba87b72f,0xbad0b60a,0xbb0cb4d9,0xbabcb65f,0xbafeb526,0xbb31b3c6,0xbb56b12f,0xbb21b453,0xbb4cb1fe,0xbb68ae92,0xbb73a463,0xbb5fb05f,0xbb71aa37,0xbb72291e,0xbb61301a
.long 0x3824ba32,0x37a9ba64,0x3706ba92,0x365fbabc,0x3635bac6,0x357ebaed,0x34c3bb0f,0x3405bb2d,0x33f3bb2e,0x325abb47,0x30bcbb5b,0x2e35bb69,0x2e92bb68,0x2a37bb71,0x9ddabb73,0xabadbb6f
.long 0xa9d9bb71,0xae92bb68,0xb118bb57,0xb2e3bb40,0xb22cbb4a,0xb405bb2d,0xb4efbb08,0xb5d4badb,0xb55dbaf3,0xb64abac1,0xb72fba87,0xb806ba45,0xb781ba70,0xb832ba28,0xb89fb9d8,0xb905b981
.long 0xb8bab9c2,0xb923b965,0xb985b901,0xb9e0b895,0xb995b8ef,0xb9f1b87e,0xba45b806,0xba8fb710,0xba4bb7f9,0xba98b6f2,0xbad9b5df,0xbb0fb4c3,0xbad9b5df,0xbb11b4b8,0xbb3db310,0xbb5cb0a5
.long 0xbb3ab33e,0xbb5bb0bc,0xbb6eac62,0xbb7321da,0xbb6cad1d,0xbb7319da,0xbb6b2d7a,0xbb54315d,0xbb6e2c62,0xbb5930ea,0xbb343398,0xbb00351b,0xbb4032e3,0xbb0d34ce,0xbacb361f,0xba793762
.long 0x35b4bae2,0x3505bb04,0x3453bb21,0x333ebb3a,0x3288bb45,0x3101bb58,0x2eefbb66,0x2badbb6f,0x29d9bb71,0x9ddabb73,0xab4fbb70,0xaeefbb66,0xaf4cbb65,0xb15dbb54,0xb310bb3d,0xb45fbb1f
.long 0xb453bb21,0xb531bafc,0xb60abad0,0xb6ddba9d,0xb6b3baa8,0xb78bba6d,0xb82dba2b,0xb891b9e3,0xb870b9fc,0xb8d5b9ac,0xb934b955,0xb98db8f8,0xb965b923,0xb9bfb8be,0xba11b854,0xba5bb7c7
.long 0xba32b824,0xba7cb758,0xbabcb65f,0xbaf3b55d,0xbad0b60a,0xbb06b4fa,0xbb31b3c6,0xbb52b18b,0xbb3ab33e,0xbb59b0ea,0xbb6cad1d,0xbb739dda,0xbb6eac62,0xbb732063,0xbb6b2d7a,0xbb56312f
.long 0xbb6a2dd8,0xbb533174,0xbb2e33f3,0xbafc3531,0xbb2e33f3,0xbafa353c,0xbab73674,0xba67379f,0xbabc365f,0xba6a3795,0xba0a385d,0xb99d38e7,0xba17384a,0xb9a838d9,0xb92c395d,0xb8a339d5
.long 0x31d0bb4f,0x305fbb5f,0x2dd8bb6a,0x29d9bb71,0x21dabb73,0xa8c1bb72,0xad7abb6b,0xb048bb60,0xb118bb57,0xb2b5bb42,0xb426bb28,0xb4efbb08,0xb531bafc,0xb5ffbad2,0xb6c8baa2,0xb78bba6d
.long 0xb7a9ba64,0xb837ba25,0xb895b9e0,0xb8efb995,0xb8efb995,0xb949b941,0xb99db8e7,0xb9eab888,0xb9e0b895,0xba2bb82d,0xba70b781,0xbaadb69e,0xba9db6dd,0xbad7b5ea,0xbb08b4ef,0xbb30b3dc
.long 0xbb21b453,0xbb45b288,0xbb5fb05f,0xbb6eac62,0xbb68ae92,0xbb72a806,0xbb72291e,0xbb662f1d,0xbb6e2c62,0xbb5d308e,0xbb4032e3,0xbb173496,0xbb343398,0xbb0634fa,0xbacb361f,0xba84373a
.long 0xbabc365f,0xba703781,0xba17384a,0xb9b338cc,0xba0a385d,0xb9a038e2,0xb92c395d,0xb8ac39cd,0xb9233965,0xb89f39d8,0xb8103a3f,0xb6f23a98,0xb8103a3f,0xb6e73a9a,0xb59e3ae7,0xb4483b23
.set qc0, 0x3d80
.set qc1, 0x3d80
.set qc2, 0x3d80
.set qc3, 0x3d80
.set qc4, 0x3d80
.set qc5, 0x3d80
.set qc6, 0x3d7f
.set qc7, 0x3d7f
.set qc8, 0x3d7f
.set qc9, 0x3d7e
.set qc10, 0x3d7e
.set qc11, 0x3d7e
.set qc12, 0x3d7d
.set qc13, 0x3d7d
.set qc14, 0x3d7c
.set qc15, 0x3d7c
.set qc16, 0x3d7b
.set qc17, 0x3d7a
.set qc18, 0x3d7a
.set qc19, 0x3d79
.set qc20, 0x3d78
.set qc21, 0x3d78
.set qc22, 0x3d77
.set qc23, 0x3d76
.set qc24, 0x3d75
.set qc25, 0x3d74
.set qc26, 0x3d73
.set qc27, 0x3d72
.set qc28, 0x3d71
.set qc29, 0x3d70
.set qc30, 0x3d6f
.set qc31, 0x3d6e
.set qc32, 0x3d6d
.set qc33, 0x3d6b
.set qc34, 0x3d6a
.set qc35, 0x3d69
.set qc36, 0x3d67
.set qc37, 0x3d66
.set qc38, 0x3d65
.set qc39, 0x3d63
.set qc40, 0x3d62
.set qc41, 0x3d60
.set qc42, 0x3d5f
.set qc43, 0x3d5d
.set qc44, 0x3d5c
.set qc45, 0x3d5a
.set qc46, 0x3d58
.set qc47, 0x3d57
.set qc48, 0x3d55
.set qc49, 0x3d53
.set qc50, 0x3d51
.set qc51, 0x3d4f
.set qc52, 0x3d4e
.set qc53, 0x3d4c
.set qc54, 0x3d4a
.set qc55, 0x3d48
.set qc56, 0x3d46
.set qc57, 0x3d44
.set qc58, 0x3d42
.set qc59, 0x3d40
.set qc60, 0x3d3e
.set qc61, 0x3d3c
.set qc62, 0x3d39
.set qc63, 0x3d37
.set qc64, 0x3d35
.set qc65, 0x3d33
.set qc66, 0x3d31
.set qc67, 0x3d2e
.set qc68, 0x3d2c
.set qc69, 0x3d2a
.set qc70, 0x3d27
.set qc71, 0x3d25
.set qc72, 0x3d22
.set qc73, 0x3d20
.set qc74, 0x3d1d
.set qc75, 0x3d1b
.set qc76, 0x3d18
.set qc77, 0x3d16
.set qc78, 0x3d13
.set qc79, 0x3d11
.set qc80, 0x3d0e
.set qc81, 0x3d0c
.set qc82, 0x3d09
.set qc83, 0x3d06
.set qc84, 0x3d04
.set qc85, 0x3d01
.set qc86, 0x3cfc
.set qc87, 0x3cf7
.set qc88, 0x3cf1
.set qc89, 0x3cec
.set qc90, 0x3ce6
.set qc91, 0x3ce1
.set qc92, 0x3cdb
.set qc93, 0x3cd5
.set qc94, 0x3ccf
.set qc95, 0x3cca
.set qc96, 0x3cc4
.set qc97, 0x3cbe
.set qc98, 0x3cb8
.set qc99, 0x3cb2
.set qc100, 0x3cac
.set qc101, 0x3ca7
.set qc102, 0x3ca1
.set qc103, 0x3c9b
.set qc104, 0x3c95
.set qc105, 0x3c8f
.set qc106, 0x3c89
.set qc107, 0x3c82
.set qc108, 0x3c79
.set qc109, 0x3c6d
.set qc110, 0x3c60
.set qc111, 0x3c54
.set qc112, 0x3c48
.set qc113, 0x3c3b
.set qc114, 0x3c2f
.set qc115, 0x3c23
.set qc116, 0x3c16
.set qc117, 0x3c0a
.set qc118, 0x3bfb
.set qc119, 0x3be2
.set qc120, 0x3bc9
.set qc121, 0x3bb0
.set qc122, 0x3b97
.set qc123, 0x3b7b
.set qc124, 0x3b49
.set qc125, 0x3b17
.set qc126, 0x3ac9
.set qc127, 0x3a49
.set qc128, 0x228d
.set qc129, 0xba49
.set qc130, 0xbac9
.set qc131, 0xbb17
.set qc132, 0xbb49
.set qc133, 0xbb7b
.set qc134, 0xbb97
.set qc135, 0xbbb0
.set qc136, 0xbbc9
.set qc137, 0xbbe2
.set qc138, 0xbbfb
.set qc139, 0xbc0a
.set qc140, 0xbc16
.set qc141, 0xbc23
.set qc142, 0xbc2f
.set qc143, 0xbc3b
.set qc144, 0xbc48
.set qc145, 0xbc54
.set qc146, 0xbc60
.set qc147, 0xbc6d
.set qc148, 0xbc79
.set qc149, 0xbc82
.set qc150, 0xbc89
.set qc151, 0xbc8f
.set qc152, 0xbc95
.set qc153, 0xbc9b
.set qc154, 0xbca1
.set qc155, 0xbca7
.set qc156, 0xbcac
.set qc157, 0xbcb2
.set qc158, 0xbcb8
.set qc159, 0xbcbe
.set qc160, 0xbcc4
.set qc161, 0xbcca
.set qc162, 0xbccf
.set qc163, 0xbcd5
.set qc164, 0xbcdb
.set qc165, 0xbce1
.set qc166, 0xbce6
.set qc167, 0xbcec
.set qc168, 0xbcf1
.set qc169, 0xbcf7
.set qc170, 0xbcfc
.set qc171, 0xbd01
.set qc172, 0xbd04
.set qc173, 0xbd06
.set qc174, 0xbd09
.set qc175, 0xbd0c
.set qc176, 0xbd0e
.set qc177, 0xbd11
.set qc178, 0xbd13
.set qc179, 0xbd16
.set qc180, 0xbd18
.set qc181, 0xbd1b
.set qc182, 0xbd1d
.set qc183, 0xbd20
.set qc184, 0xbd22
.set qc185, 0xbd25
.set qc186, 0xbd27
.set qc187, 0xbd2a
.set qc188, 0xbd2c
.set qc189, 0xbd2e
.set qc190, 0xbd31
.set qc191, 0xbd33
.set qc192, 0xbd35
.set qc193, 0xbd37
.set qc194, 0xbd39
.set qc195, 0xbd3c
.set qc196, 0xbd3e
.set qc197, 0xbd40
.set qc198, 0xbd42
.set qc199, 0xbd44
.set qc200, 0xbd46
.set qc201, 0xbd48
.set qc202, 0xbd4a
.set qc203, 0xbd4c
.set qc204, 0xbd4e
.set qc205, 0xbd4f
.set qc206, 0xbd51
.set qc207, 0xbd53
.set qc208, 0xbd55
.set qc209, 0xbd57
.set qc210, 0xbd58
.set qc211, 0xbd5a
.set qc212, 0xbd5c
.set qc213, 0xbd5d
.set qc214, 0xbd5f
.set qc215, 0xbd60
.set qc216, 0xbd62
.set qc217, 0xbd63
.set qc218, 0xbd65
.set qc219, 0xbd66
.set qc220, 0xbd67
.set qc221, 0xbd69
.set qc222, 0xbd6a
.set qc223, 0xbd6b
.set qc224, 0xbd6d
.set qc225, 0xbd6e
.set qc226, 0xbd6f
.set qc227, 0xbd70
.set qc228, 0xbd71
.set qc229, 0xbd72
.set qc230, 0xbd73
.set qc231, 0xbd74
.set qc232, 0xbd75
.set qc233, 0xbd76
.set qc234, 0xbd77
.set qc235, 0xbd78
.set qc236, 0xbd78
.set qc237, 0xbd79
.set qc238, 0xbd7a
.set qc239, 0xbd7a
.set qc240, 0xbd7b
.set qc241, 0xbd7c
.set qc242, 0xbd7c
.set qc243, 0xbd7d
.set qc244, 0xbd7d
.set qc245, 0xbd7e
.set qc246, 0xbd7e
.set qc247, 0xbd7e
.set qc248, 0xbd7f
.set qc249, 0xbd7f
.set qc250, 0xbd7f
.set qc251, 0xbd80
.set qc252, 0xbd80
.set qc253, 0xbd80
.set qc254, 0xbd80
.set qc255, 0xbd80
.set qc256, 0xbd80
.set qc257, 0xbd80
.set qc258, 0xbd80
.set qc259, 0xbd80
.set qc260, 0xbd80
.set qc261, 0xbd80
.set qc262, 0xbd7f
.set qc263, 0xbd7f
.set qc264, 0xbd7f
.set qc265, 0xbd7e
.set qc266, 0xbd7e
.set qc267, 0xbd7e
.set qc268, 0xbd7d
.set qc269, 0xbd7d
.set qc270, 0xbd7c
.set qc271, 0xbd7c
.set qc272, 0xbd7b
.set qc273, 0xbd7a
.set qc274, 0xbd7a
.set qc275, 0xbd79
.set qc276, 0xbd78
.set qc277, 0xbd78
.set qc278, 0xbd77
.set qc279, 0xbd76
.set qc280, 0xbd75
.set qc281, 0xbd74
.set qc282, 0xbd73
.set qc283, 0xbd72
.set qc284, 0xbd71
.set qc285, 0xbd70
.set qc286, 0xbd6f
.set qc287, 0xbd6e
.set qc288, 0xbd6d
.set qc289, 0xbd6b
.set qc290, 0xbd6a
.set qc291, 0xbd69
.set qc292, 0xbd67
.set qc293, 0xbd66
.set qc294, 0xbd65
.set qc295, 0xbd63
.set qc296, 0xbd62
.set qc297, 0xbd60
.set qc298, 0xbd5f
.set qc299, 0xbd5d
.set qc300, 0xbd5c
.set qc301, 0xbd5a
.set qc302, 0xbd58
.set qc303, 0xbd57
.set qc304, 0xbd55
.set qc305, 0xbd53
.set qc306, 0xbd51
.set qc307, 0xbd4f
.set qc308, 0xbd4e
.set qc309, 0xbd4c
.set qc310, 0xbd4a
.set qc311, 0xbd48
.set qc312, 0xbd46
.set qc313, 0xbd44
.set qc314, 0xbd42
.set qc315, 0xbd40
.set qc316, 0xbd3e
.set qc317, 0xbd3c
.set qc318, 0xbd39
.set qc319, 0xbd37
.set qc320, 0xbd35
.set qc321, 0xbd33
.set qc322, 0xbd31
.set qc323, 0xbd2e
.set qc324, 0xbd2c
.set qc325, 0xbd2a
.set qc326, 0xbd27
.set qc327, 0xbd25
.set qc328, 0xbd22
.set qc329, 0xbd20
.set qc330, 0xbd1d
.set qc331, 0xbd1b
.set qc332, 0xbd18
.set qc333, 0xbd16
.set qc334, 0xbd13
.set qc335, 0xbd11
.set qc336, 0xbd0e
.set qc337, 0xbd0c
.set qc338, 0xbd09
.set qc339, 0xbd06
.set qc340, 0xbd04
.set qc341, 0xbd01
.set qc342, 0xbcfc
.set qc343, 0xbcf7
.set qc344, 0xbcf1
.set qc345, 0xbcec
.set qc346, 0xbce6
.set qc347, 0xbce1
.set qc348, 0xbcdb
.set qc349, 0xbcd5
.set qc350, 0xbccf
.set qc351, 0xbcca
.set qc352, 0xbcc4
.set qc353, 0xbcbe
.set qc354, 0xbcb8
.set qc355, 0xbcb2
.set qc356, 0xbcac
.set qc357, 0xbca7
.set qc358, 0xbca1
.set qc359, 0xbc9b
.set qc360, 0xbc95
.set qc361, 0xbc8f
.set qc362, 0xbc89
.set qc363, 0xbc82
.set qc364, 0xbc79
.set qc365, 0xbc6d
.set qc366, 0xbc60
.set qc367, 0xbc54
.set qc368, 0xbc48
.set qc369, 0xbc3b
.set qc370, 0xbc2f
.set qc371, 0xbc23
.set qc372, 0xbc16
.set qc373, 0xbc0a
.set qc374, 0xbbfb
.set qc375, 0xbbe2
.set qc376, 0xbbc9
.set qc377, 0xbbb0
.set qc378, 0xbb97
.set qc379, 0xbb7b
.set qc380, 0xbb49
.set qc381, 0xbb17
.set qc382, 0xbac9
.set qc383, 0xba49
.set qc384, 0xa354
.set qc385, 0x3a49
.set qc386, 0x3ac9
.set qc387, 0x3b17
.set qc388, 0x3b49
.set qc389, 0x3b7b
.set qc390, 0x3b97
.set qc391, 0x3bb0
.set qc392, 0x3bc9
.set qc393, 0x3be2
.set qc394, 0x3bfb
.set qc395, 0x3c0a
.set qc396, 0x3c16
.set qc397, 0x3c23
.set qc398, 0x3c2f
.set qc399, 0x3c3b
.set qc400, 0x3c48
.set qc401, 0x3c54
.set qc402, 0x3c60
.set qc403, 0x3c6d
.set qc404, 0x3c79
.set qc405, 0x3c82
.set qc406, 0x3c89
.set qc407, 0x3c8f
.set qc408, 0x3c95
.set qc409, 0x3c9b
.set qc410, 0x3ca1
.set qc411, 0x3ca7
.set qc412, 0x3cac
.set qc413, 0x3cb2
.set qc414, 0x3cb8
.set qc415, 0x3cbe
.set qc416, 0x3cc4
.set qc417, 0x3cca
.set qc418, 0x3ccf
.set qc419, 0x3cd5
.set qc420, 0x3cdb
.set qc421, 0x3ce1
.set qc422, 0x3ce6
.set qc423, 0x3cec
.set qc424, 0x3cf1
.set qc425, 0x3cf7
.set qc426, 0x3cfc
.set qc427, 0x3d01
.set qc428, 0x3d04
.set qc429, 0x3d06
.set qc430, 0x3d09
.set qc431, 0x3d0c
.set qc432, 0x3d0e
.set qc433, 0x3d11
.set qc434, 0x3d13
.set qc435, 0x3d16
.set qc436, 0x3d18
.set qc437, 0x3d1b
.set qc438, 0x3d1d
.set qc439, 0x3d20
.set qc440, 0x3d22
.set qc441, 0x3d25
.set qc442, 0x3d27
.set qc443, 0x3d2a
.set qc444, 0x3d2c
.set qc445, 0x3d2e
.set qc446, 0x3d31
.set qc447, 0x3d33
.set qc448, 0x3d35
.set qc449, 0x3d37
.set qc450, 0x3d39
.set qc451, 0x3d3c
.set qc452, 0x3d3e
.set qc453, 0x3d40
.set qc454, 0x3d42
.set qc455, 0x3d44
.set qc456, 0x3d46
.set qc457, 0x3d48
.set qc458, 0x3d4a
.set qc459, 0x3d4c
.set qc460, 0x3d4e
.set qc461, 0x3d4f
.set qc462, 0x3d51
.set qc463, 0x3d53
.set qc464, 0x3d55
.set qc465, 0x3d57
.set qc466, 0x3d58
.set qc467, 0x3d5a
.set qc468, 0x3d5c
.set qc469, 0x3d5d
.set qc470, 0x3d5f
.set qc471, 0x3d60
.set qc472, 0x3d62
.set qc473, 0x3d63
.set qc474, 0x3d65
.set qc475, 0x3d66
.set qc476, 0x3d67
.set qc477, 0x3d69
.set qc478, 0x3d6a
.set qc479, 0x3d6b
.set qc480, 0x3d6d
.set qc481, 0x3d6e
.set qc482, 0x3d6f
.set qc483, 0x3d70
.set qc484, 0x3d71
.set qc485, 0x3d72
.set qc486, 0x3d73
.set qc487, 0x3d74
.set qc488, 0x3d75
.set qc489, 0x3d76
.set qc490, 0x3d77
.set qc491, 0x3d78
.set qc492, 0x3d78
.set qc493, 0x3d79
.set qc494, 0x3d7a
.set qc495, 0x3d7a
.set qc496, 0x3d7b
.set qc497, 0x3d7c
.set qc498, 0x3d7c
.set qc499, 0x3d7d
.set qc500, 0x3d7d
.set qc501, 0x3d7e
.set qc502, 0x3d7e
.set qc503, 0x3d7e
.set qc504, 0x3d7f
.set qc505, 0x3d7f
.set qc506, 0x3d7f
.set qc507, 0x3d80
.set qc508, 0x3d80
.set qc509, 0x3d80
.set qc510, 0x3d80
.set qc511, 0x3d80
.altmacro
.macro qp a, b
.long qc\a | (qc\b << 16)
.endm
.macro q4 d, k0, k1, k2, k3
.if \k0 == 256
.long 0x3d353d35 | ((\d & 1) << 15)
.else
qp %((\d*\k0)&511), %((\d*\k0+128)&511)
.endif
qp %((\d*\k1)&511), %((\d*\k1+128)&511)
qp %((\d*\k2)&511), %((\d*\k2+128)&511)
qp %((\d*\k3)&511), %((\d*\k3+128)&511)
.endm
.macro qrow k0, k1, k2, k3
.set qm, 0
.rept 16
q4 %(qb + 8*(qm>>2) + (qm&3)), \k0, \k1, \k2, \k3
.set qm, qm+1
.endr
.endm
.set qt, 0
.rept 32
.set qb, 32*(qt>>1) + 4*(qt&1)
qrow 256, 32, 64, 96
qrow 1, 33, 65, 97
qrow 2, 34, 66, 98
qrow 3, 35, 67, 99
qrow 4, 36, 68, 100
qrow 5, 37, 69, 101
qrow 6, 38, 70, 102
qrow 7, 39, 71, 103
qrow 8, 40, 72, 104
qrow 9, 41, 73, 105
qrow 10, 42, 74, 106
qrow 11, 43, 75, 107
qrow 12, 44, 76, 108
qrow 13, 45, 77, 109
qrow 14, 46, 78, 110
qrow 15, 47, 79, 111
qrow 128, 160, 192, 224
qrow 129, 161, 193, 225
qrow 130, 162, 194, 226
qrow 131, 163, 195, 227
qrow 132, 164, 196, 228
qrow 133, 165, 197, 229
qrow 134, 166, 198, 230
qrow 135, 167, 199, 231
qrow 136, 168, 200, 232
qrow 137, 169, 201, 233
qrow 138, 170, 202, 234
qrow 139, 171, 203, 235
qrow 140, 172, 204, 236
qrow 141, 173, 205, 237
qrow 142, 174, 206, 238
qrow 143, 175, 207, 239
qrow 16, 48, 80, 112
qrow 255, 223, 191, 159
qrow 254, 222, 190, 158
qrow 253, 221, 189, 157
qrow 252, 220, 188, 156
qrow 251, 219, 187, 155
qrow 250, 218, 186, 154
qrow 249, 217, 185, 153
qrow 248, 216, 184, 152
qrow 247, 215, 183, 151
qrow 246, 214, 182, 150
qrow 245, 213, 181, 149
qrow 244, 212, 180, 148
qrow 243, 211, 179, 147
qrow 242, 210, 178, 146
qrow 241, 209, 177, 145
qrow 144, 176, 208, 240
qrow 127, 95, 63, 31
qrow 126, 94, 62, 30
qrow 125, 93, 61, 29
qrow 124, 92, 60, 28
qrow 123, 91, 59, 27
qrow 122, 90, 58, 26
qrow 121, 89, 57, 25
qrow 120, 88, 56, 24
qrow 119, 87, 55, 23
qrow 118, 86, 54, 22
qrow 117, 85, 53, 21
qrow 116, 84, 52, 20
qrow 115, 83, 51, 19
qrow 114, 82, 50, 18
qrow 113, 81, 49, 17
.set qt, qt+1
.endr
.noaltmacro
```
